```python
import torch

def _softmax(x, axis=-1):
    return torch.softmax(x, dim=axis)

def _gelu(x):
    return torch.nn.functional.gelu(x, approximate='tanh')

def _silu(x):
    return torch.nn.functional.silu(x)

def _sigmoid(x):
    return torch.sigmoid(x)

def _layernorm(x, axis=-1, eps=1e-05):
    m = x.mean(dim=axis, keepdim=True)
    v = x.var(dim=axis, keepdim=True, unbiased=False)
    return (x - m) / torch.sqrt(v + eps)

def _scatter_add(tgt, idx, src, axis=0):
    return tgt.clone().index_add_(axis, idx, src)

def _segment_sum(src, seg, n):
    out = torch.zeros((n,) + src.shape[1:], dtype=src.dtype)
    return out.index_add_(0, seg, src)

def _pad(x, pw):
    flat = tuple((v for pair in reversed(pw) for v in pair))
    return torch.nn.functional.pad(x, flat)
kernel_name = 'sequential_preLN__memory_aug_recurrent_mem_tr__dense_activation_gelu__prompt'

def setup_inputs():

    _w = lambda a: (lambda t: t.to(torch.bfloat16) if t.is_floating_point() else t)(torch.as_tensor(a))

    def _A_setup():
        B, S, Dm = (1, 2048, 448)
        H, Dh = (16, 256)
        M, seg = (8, 32)
        seg = min(seg, S)
        S = S // seg * seg
        return {'x': _w((lambda *s: torch.randn(*s, dtype=torch.bfloat16) * 0.05)(B, S, Dm)), 'mem0': _w((lambda *s: torch.randn(*s, dtype=torch.bfloat16) * 0.2)(B, M, Dm)), 'Wq': _w((lambda *s: torch.randn(*s, dtype=torch.bfloat16) * 1.6)(Dm, H, Dh) * Dm ** (-0.5)), 'Wk': _w((lambda *s: torch.randn(*s, dtype=torch.bfloat16) * 1.6)(Dm, H, Dh) * Dm ** (-0.5)), 'Wv': _w((lambda *s: torch.randn(*s, dtype=torch.bfloat16) * 0.2)(Dm, H, Dh) * Dm ** (-0.5)), 'Wo': _w((lambda *s: torch.randn(*s, dtype=torch.bfloat16) * 0.2)(H, Dh, Dm) * (H * Dh) ** (-0.5)), 'seg_len': seg}
    _A_in = _A_setup()

    def _B_setup():
        B, S, D, F = (1, 2048, 448, 1792)
        return {'x': _w((lambda *s: torch.randn(*s, dtype=torch.bfloat16) * 0.05)(B, S, D)), 'w1': _w((lambda *s: torch.randn(*s, dtype=torch.bfloat16) * 0.4)(D, F) * D ** (-0.5)), 'b1': _w((lambda *s: torch.randn(*s, dtype=torch.bfloat16) * 12.8)(F) * 0.01), 'w2': _w((lambda *s: torch.randn(*s, dtype=torch.bfloat16) * 0.2)(F, D) * F ** (-0.5)), 'b2': _w((lambda *s: torch.randn(*s, dtype=torch.bfloat16) * 1.6)(D) * 0.01)}
    _B_in = _B_setup()
    return {'A_x': _A_in['x'], 'A_mem0': _A_in['mem0'], 'A_Wq': _A_in['Wq'], 'A_Wk': _A_in['Wk'], 'A_Wv': _A_in['Wv'], 'A_Wo': _A_in['Wo'], 'A_seg_len': _A_in['seg_len'], 'B_x': _B_in['x'], 'B_w1': _B_in['w1'], 'B_b1': _B_in['b1'], 'B_w2': _B_in['w2'], 'B_b2': _B_in['b2']}

def reference(A_x, A_mem0, A_Wq, A_Wk, A_Wv, A_Wo, A_seg_len, B_x, B_w1, B_b1, B_w2, B_b2):

    def _A_ref(x, mem0, Wq, Wk, Wv, Wo, seg_len):
        B, S, Dm = x.shape
        H, Dh = (Wq.shape[1], Wq.shape[2])
        M = mem0.shape[1]
        scale = Dh ** (-0.5)
        n_seg = S // seg_len
        L = M + seg_len
        idx = torch.arange(L)
        mask = (idx[:, None] < M) | (idx[:, None] >= idx[None, :])
        mem = mem0
        outs = []
        for s in range(n_seg):
            xs = x[:, s * seg_len:(s + 1) * seg_len, :].clone()
            h = torch.concatenate([mem, xs], axis=1)
            q = torch.einsum('btd,dhe->bhte', h, Wq)
            k = torch.einsum('btd,dhe->bhte', h, Wk)
            v = torch.einsum('btd,dhe->bhte', h, Wv)
            scores = torch.einsum('bhqe,bhke->bhqk', q, k) * scale
            scores = torch.where(mask[None, None], scores, -1000000000.0)
            p = _softmax(scores, axis=-1)
            o = torch.einsum('bhqk,bhke->bhqe', p, v)
            o = torch.einsum('bhte,hed->btd', o, Wo)
            mem = o[:, :M, :].clone()
            outs.append(o[:, M:, :])
        return torch.concatenate(outs, axis=1)

    def _B_ref(x, w1, b1, w2, b2):
        h = torch.einsum('bsd,df->bsf', x, w1) + b1
        h = _gelu(h)
        return torch.einsum('bsf,fd->bsd', h, w2) + b2
    x = A_x
    h = x + _A_ref(_layernorm(x, axis=-1), A_mem0, A_Wq, A_Wk, A_Wv, A_Wo, A_seg_len)
    h2 = h + _B_ref(_layernorm(h, axis=-1), B_w1, B_b1, B_w2, B_b2)
    return h2
```

```asm
; @launch grid=(256,1,1) block=(256,1,1) lds=132096
.amdgcn_target "amdgcn-amd-amdhsa--gfx950"
.text
.globl sequential_preLN__memory_aug_recurrent_mem_tr__dense_activation_gelu__prompt_kernel
.p2align 8
.type sequential_preLN__memory_aug_recurrent_mem_tr__dense_activation_gelu__prompt_kernel,@function
sequential_preLN__memory_aug_recurrent_mem_tr__dense_activation_gelu__prompt_kernel:
  s_cmp_ge_u32 s2, 256
  s_cbranch_scc1 L_exit
  s_load_dwordx2 s[40:41], s[0:1], 112
  s_load_dwordx2 s[42:43], s[0:1], 104
  s_load_dwordx4 s[44:47], s[0:1], 16
  s_load_dwordx4 s[48:51], s[0:1], 32
  v_lshrrev_b32 v1, 6, v0
  v_and_b32 v0, 63, v0
  v_readfirstlane_b32 s3, v1
  s_getreg_b32 s7, hwreg(HW_REG_XCC_ID, 0, 4)
  s_mov_b32 s6, 0
  s_mov_b32 s5, 0
  v_and_b32 v1, 15, v0
  v_lshrrev_b32 v2, 4, v0
  v_lshlrev_b32 v3, 4, v0
  v_mov_b32 v252, 1
  v_mov_b32 v253, 0
  s_and_b32 s17, s7, 4
  s_lshl_b32 s17, s17, 5
  s_andn2_b32 s19, s7, 4
  s_lshl_b32 s19, s19, 2
  s_add_u32 s17, s17, s19
  s_and_b32 s28, s2, 7
  s_lshr_b32 s29, s2, 3
  s_cmp_eq_u32 s28, 0
  s_cbranch_scc1 L_prep_none
  s_sub_u32 s34, s28, 1
  s_lshl_b32 s28, s34, 5
  s_add_u32 s28, s28, s29
  s_cmp_ge_u32 s29, 28
  s_cbranch_scc1 L_prep_rest
  s_mul_i32 s30, s29, 37
  s_lshr_b32 s30, s30, 8
  s_mul_i32 s31, s30, 7
  s_sub_u32 s31, s29, s31
  s_lshl_b32 s35, s34, 2
  s_add_u32 s30, s30, s35
  s_mul_i32 s35, s30, 37
  s_lshr_b32 s35, s35, 8
  s_mul_i32 s32, s35, 7
  s_sub_u32 s30, s30, s32
  s_lshl_b32 s32, s35, 2
  s_add_u32 s32, s32, s30
  s_mul_i32 s35, s35, 3
  s_add_u32 s35, s35, s30
  s_sub_u32 s35, s35, 4
  s_cmp_lt_u32 s30, 4
  s_cselect_b32 s32, s32, s35
  s_cselect_b32 s33, 1, 0
  s_branch L_prep_task
L_prep_rest:
  s_sub_u32 s30, s29, 28
  s_lshr_b32 s35, s34, 1
  s_add_u32 s32, s35, 12
  s_and_b32 s33, s34, 1
  s_lshl_b32 s31, s33, 2
  s_add_u32 s31, s31, s30
  s_add_u32 s35, s35, 4
  s_cmp_eq_u32 s31, 7
  s_cselect_b32 s32, 15, s32
  s_cselect_b32 s31, s35, s31
  s_mov_b32 s33, 0
L_prep_task:
  s_lshl_b32 s16, s33, 4
  s_add_u32 s16, s16, s32
  s_mul_i32 s16, s16, 7
  s_add_u32 s16, s16, s31
  v_lshrrev_b32 v4, 5, v0
  v_and_b32 v5, 31, v0
  s_lshl_b32 s34, s32, 9
  v_and_b32 v7, 3, v1
  v_add_u32 v6, 0, v4
  v_xor_b32 v6, v6, v5
  v_lshlrev_b32 v6, 4, v6
  v_lshl_add_u32 v6, v4, 13, v6
  s_add_u32 s35, s34, 0
  v_add_u32 v208, s35, v6
  v_add_u32 v6, 2, v4
  v_xor_b32 v6, v6, v5
  v_lshlrev_b32 v6, 4, v6
  v_lshl_add_u32 v6, v4, 13, v6
  s_add_u32 s35, s34, 16384
  v_add_u32 v209, s35, v6
  v_add_u32 v6, 4, v4
  v_xor_b32 v6, v6, v5
  v_lshlrev_b32 v6, 4, v6
  v_lshl_add_u32 v6, v4, 13, v6
  s_add_u32 s35, s34, 65536
  v_add_u32 v210, s35, v6
  v_add_u32 v6, 6, v4
  v_xor_b32 v6, v6, v5
  v_lshlrev_b32 v6, 4, v6
  v_lshl_add_u32 v6, v4, 13, v6
  s_add_u32 s35, s34, 81920
  v_add_u32 v211, s35, v6
  v_add_u32 v6, 8, v4
  v_xor_b32 v6, v6, v5
  v_lshlrev_b32 v6, 4, v6
  v_lshl_add_u32 v6, v4, 13, v6
  s_add_u32 s35, s34, 131072
  v_add_u32 v212, s35, v6
  v_add_u32 v6, 10, v4
  v_xor_b32 v6, v6, v5
  v_lshlrev_b32 v6, 4, v6
  v_lshl_add_u32 v6, v4, 13, v6
  s_add_u32 s35, s34, 147456
  v_add_u32 v213, s35, v6
  v_add_u32 v6, 12, v4
  v_xor_b32 v6, v6, v5
  v_lshlrev_b32 v6, 4, v6
  v_lshl_add_u32 v6, v4, 13, v6
  s_add_u32 s35, s34, 196608
  v_add_u32 v214, s35, v6
  v_add_u32 v6, 14, v4
  v_xor_b32 v6, v6, v5
  v_lshlrev_b32 v6, 4, v6
  v_lshl_add_u32 v6, v4, 13, v6
  s_add_u32 s35, s34, 212992
  v_add_u32 v215, s35, v6
  v_add_u32 v6, 0, v2
  v_xor_b32 v6, v6, v1
  v_lshlrev_b32 v6, 4, v6
  v_lshl_add_u32 v216, v1, 9, v6
  v_add_u32 v6, 4, v2
  v_xor_b32 v6, v6, v1
  v_lshlrev_b32 v6, 4, v6
  v_lshl_add_u32 v217, v1, 9, v6
  v_add_u32 v6, 8, v2
  v_xor_b32 v6, v6, v1
  v_lshlrev_b32 v6, 4, v6
  v_lshl_add_u32 v218, v1, 9, v6
  v_add_u32 v6, 12, v2
  v_xor_b32 v6, v6, v1
  v_lshlrev_b32 v6, 4, v6
  v_lshl_add_u32 v219, v1, 9, v6
  s_mul_i32 s61, s3, 24576
  s_add_u32 s61, s61, 32768
  v_add_u32 v220, s61, v216
  v_add_u32 v221, s61, v217
  v_add_u32 v222, s61, v218
  v_add_u32 v223, s61, v219
  s_mul_i32 s36, s32, 401408
  s_mul_i32 s37, s33, 6422528
  s_add_u32 s36, s36, s37
  s_mul_i32 s39, s3, 7
  s_lshl_b32 s58, s3, 13
  s_cmp_eq_u32 s33, 0
  s_cbranch_scc0 L_prep_b
  s_add_u32 s56, s31, 0
  s_sub_u32 s57, s56, 7
  s_cmp_ge_u32 s56, 7
  s_cselect_b32 s56, s57, s56
  s_add_u32 s64, s56, s39
  s_add_u32 s56, s31, 1
  s_sub_u32 s57, s56, 7
  s_cmp_ge_u32 s56, 7
  s_cselect_b32 s56, s57, s56
  s_add_u32 s65, s56, s39
  s_add_u32 s56, s31, 2
  s_sub_u32 s57, s56, 7
  s_cmp_ge_u32 s56, 7
  s_cselect_b32 s56, s57, s56
  s_add_u32 s66, s56, s39
  s_add_u32 s56, s31, 3
  s_sub_u32 s57, s56, 7
  s_cmp_ge_u32 s56, 7
  s_cselect_b32 s56, s57, s56
  s_add_u32 s67, s56, s39
  s_add_u32 s56, s31, 4
  s_sub_u32 s57, s56, 7
  s_cmp_ge_u32 s56, 7
  s_cselect_b32 s56, s57, s56
  s_add_u32 s68, s56, s39
  s_add_u32 s56, s31, 5
  s_sub_u32 s57, s56, 7
  s_cmp_ge_u32 s56, 7
  s_cselect_b32 s56, s57, s56
  s_add_u32 s69, s56, s39
  s_add_u32 s56, s31, 6
  s_sub_u32 s57, s56, 7
  s_cmp_ge_u32 s56, 7
  s_cselect_b32 s56, s57, s56
  s_add_u32 s70, s56, s39
  s_waitcnt lgkmcnt(0)
  s_mov_b32 s8, s40
  s_and_b32 s9, s41, 0xffff
  s_mov_b32 s10, 268435456
  s_mov_b32 s11, 0x20000
  s_mov_b32 s12, s42
  s_and_b32 s13, s43, 0xffff
  s_mov_b32 s14, 256
  s_mov_b32 s15, 0x20000
  s_or_b32 s19, s2, s3
  s_cmp_eq_u32 s19, 0
  s_cbranch_scc0 L_nonce_1
  s_memrealtime s[74:75]
  s_waitcnt lgkmcnt(0)
  s_lshl_b32 s74, s74, 4
  s_and_b32 s75, s7, 7
  s_or_b32 s74, s74, s75
  s_or_b32 s74, s74, 8
  v_mov_b32 v10, s74
  buffer_store_dword v10, v253, s[12:15], 0 offen offset:192 sc1
L_nonce_1:
  s_mov_b32 s20, s44
  s_and_b32 s21, s45, 0xffff
  s_mov_b32 s22, 3670016
  s_mov_b32 s23, 0x20000
  s_mov_b32 s24, s46
  s_and_b32 s25, s47, 0xffff
  s_mov_b32 s26, 3670016
  s_mov_b32 s27, 0x20000
  s_lshr_b32 s56, s3, 1
  s_lshl_b32 s56, s56, 18
  s_and_b32 s57, s3, 1
  s_lshl_b32 s57, s57, 15
  s_add_u32 s56, s56, s57
  s_lshl_b32 s57, s31, 19
  s_add_u32 s56, s56, s57
  s_add_u32 s62, s58, 0
  s_mov_b32 m0, s62
  s_nop 0
  buffer_load_dwordx4 v208, s[20:23], s56 offen lds
  s_add_u32 s62, s58, 1024
  s_mov_b32 m0, s62
  s_nop 0
  buffer_load_dwordx4 v209, s[20:23], s56 offen lds
  s_add_u32 s62, s58, 2048
  s_mov_b32 m0, s62
  s_nop 0
  buffer_load_dwordx4 v210, s[20:23], s56 offen lds
  s_add_u32 s62, s58, 3072
  s_mov_b32 m0, s62
  s_nop 0
  buffer_load_dwordx4 v211, s[20:23], s56 offen lds
  s_add_u32 s62, s58, 4096
  s_mov_b32 m0, s62
  s_nop 0
  buffer_load_dwordx4 v212, s[20:23], s56 offen lds
  s_add_u32 s62, s58, 5120
  s_mov_b32 m0, s62
  s_nop 0
  buffer_load_dwordx4 v213, s[20:23], s56 offen lds
  s_add_u32 s62, s58, 6144
  s_mov_b32 m0, s62
  s_nop 0
  buffer_load_dwordx4 v214, s[20:23], s56 offen lds
  s_add_u32 s62, s58, 7168
  s_mov_b32 m0, s62
  s_nop 0
  buffer_load_dwordx4 v215, s[20:23], s56 offen lds
  s_lshr_b32 s57, s64, 1
  s_lshl_b32 s57, s57, 18
  s_and_b32 s56, s64, 1
  s_lshl_b32 s56, s56, 15
  s_add_u32 s56, s56, s57
  s_add_u32 s63, s61, 0
  s_add_u32 s62, s63, 0
  s_mov_b32 m0, s62
  s_nop 0
  buffer_load_dwordx4 v208, s[24:27], s56 offen lds
  s_add_u32 s62, s63, 1024
  s_mov_b32 m0, s62
  s_nop 0
  buffer_load_dwordx4 v209, s[24:27], s56 offen lds
  s_add_u32 s62, s63, 2048
  s_mov_b32 m0, s62
  s_nop 0
  buffer_load_dwordx4 v210, s[24:27], s56 offen lds
  s_add_u32 s62, s63, 3072
  s_mov_b32 m0, s62
  s_nop 0
  buffer_load_dwordx4 v211, s[24:27], s56 offen lds
  s_add_u32 s62, s63, 4096
  s_mov_b32 m0, s62
  s_nop 0
  buffer_load_dwordx4 v212, s[24:27], s56 offen lds
  s_add_u32 s62, s63, 5120
  s_mov_b32 m0, s62
  s_nop 0
  buffer_load_dwordx4 v213, s[24:27], s56 offen lds
  s_add_u32 s62, s63, 6144
  s_mov_b32 m0, s62
  s_nop 0
  buffer_load_dwordx4 v214, s[24:27], s56 offen lds
  s_add_u32 s62, s63, 7168
  s_mov_b32 m0, s62
  s_nop 0
  buffer_load_dwordx4 v215, s[24:27], s56 offen lds
  s_cmp_eq_u32 s3, 0
  s_cbranch_scc0 L_rank_2
  s_mov_b64 exec, 1
  buffer_atomic_add v252, v253, s[12:15], s17 offen sc0 sc1
  s_mov_b64 exec, -1
L_rank_2:
  s_waitcnt vmcnt(8)
  s_barrier
  ds_read_b128 v[16:19], v216 offset:0
  ds_read_b128 v[48:51], v216 offset:8192
  ds_read_b128 v[80:83], v216 offset:16384
  ds_read_b128 v[112:115], v216 offset:24576
  ds_read_b128 v[20:23], v217 offset:0
  ds_read_b128 v[52:55], v217 offset:8192
  ds_read_b128 v[84:87], v217 offset:16384
  ds_read_b128 v[116:119], v217 offset:24576
  ds_read_b128 v[24:27], v218 offset:0
  ds_read_b128 v[56:59], v218 offset:8192
  ds_read_b128 v[88:91], v218 offset:16384
  ds_read_b128 v[120:123], v218 offset:24576
  ds_read_b128 v[28:31], v219 offset:0
  ds_read_b128 v[60:63], v219 offset:8192
  ds_read_b128 v[92:95], v219 offset:16384
  s_waitcnt lgkmcnt(14)
  ds_read_b128 v[124:127], v219 offset:24576
  s_waitcnt lgkmcnt(14)
  ds_read_b128 v[32:35], v216 offset:256
  s_waitcnt lgkmcnt(14)
  ds_read_b128 v[64:67], v216 offset:8448
  s_waitcnt lgkmcnt(14)
  ds_read_b128 v[96:99], v216 offset:16640
  s_waitcnt lgkmcnt(14)
  ds_read_b128 v[128:131], v216 offset:24832
  s_waitcnt lgkmcnt(14)
  ds_read_b128 v[36:39], v217 offset:256
  s_waitcnt lgkmcnt(14)
  ds_read_b128 v[68:71], v217 offset:8448
  s_waitcnt lgkmcnt(14)
  ds_read_b128 v[100:103], v217 offset:16640
  s_waitcnt lgkmcnt(14)
  ds_read_b128 v[132:135], v217 offset:24832
  s_waitcnt lgkmcnt(14)
  ds_read_b128 v[40:43], v218 offset:256
  s_waitcnt lgkmcnt(14)
  ds_read_b128 v[72:75], v218 offset:8448
  s_waitcnt lgkmcnt(14)
  ds_read_b128 v[104:107], v218 offset:16640
  s_waitcnt lgkmcnt(14)
  ds_read_b128 v[136:139], v218 offset:24832
  s_waitcnt lgkmcnt(14)
  ds_read_b128 v[44:47], v219 offset:256
  s_waitcnt lgkmcnt(14)
  ds_read_b128 v[76:79], v219 offset:8448
  s_waitcnt lgkmcnt(14)
  ds_read_b128 v[108:111], v219 offset:16640
  s_waitcnt lgkmcnt(14)
  ds_read_b128 v[140:143], v219 offset:24832
  s_mov_b32 s38, 0x3db8aa3b
  s_lshl_b32 s57, s31, 11
  s_add_u32 s36, s36, s57
  s_waitcnt lgkmcnt(0)
  v_mov_b32 v12, s38
  v_mov_b32 v13, s38
  s_waitcnt vmcnt(0)
  ds_read_b128 a[0:3], v220 offset:0
  ds_read_b128 a[4:7], v221 offset:0
  ds_read_b128 a[8:11], v222 offset:0
  ds_read_b128 a[12:15], v223 offset:0
  ds_read_b128 a[16:19], v220 offset:256
  ds_read_b128 a[20:23], v221 offset:256
  ds_read_b128 a[24:27], v222 offset:256
  ds_read_b128 a[28:31], v223 offset:256
  s_lshr_b32 s57, s65, 1
  s_lshl_b32 s57, s57, 18
  s_and_b32 s56, s65, 1
  s_lshl_b32 s56, s56, 15
  s_add_u32 s56, s56, s57
  s_add_u32 s63, s61, 8192
  s_add_u32 s62, s63, 0
  s_mov_b32 m0, s62
  s_nop 0
  buffer_load_dwordx4 v208, s[24:27], s56 offen lds
  s_add_u32 s62, s63, 1024
  s_mov_b32 m0, s62
  s_nop 0
  buffer_load_dwordx4 v209, s[24:27], s56 offen lds
  s_add_u32 s62, s63, 2048
  s_mov_b32 m0, s62
  s_nop 0
  buffer_load_dwordx4 v210, s[24:27], s56 offen lds
  s_add_u32 s62, s63, 3072
  s_mov_b32 m0, s62
  s_nop 0
  buffer_load_dwordx4 v211, s[24:27], s56 offen lds
  s_add_u32 s62, s63, 4096
  s_mov_b32 m0, s62
  s_nop 0
  buffer_load_dwordx4 v212, s[24:27], s56 offen lds
  s_add_u32 s62, s63, 5120
  s_mov_b32 m0, s62
  s_nop 0
  buffer_load_dwordx4 v213, s[24:27], s56 offen lds
  s_add_u32 s62, s63, 6144
  s_mov_b32 m0, s62
  s_nop 0
  buffer_load_dwordx4 v214, s[24:27], s56 offen lds
  s_add_u32 s62, s63, 7168
  s_mov_b32 m0, s62
  s_nop 0
  buffer_load_dwordx4 v215, s[24:27], s56 offen lds
  s_waitcnt lgkmcnt(0)
  v_mfma_f32_16x16x32_bf16 v[144:147], v[16:19], a[0:3], 0
  s_lshr_b32 s57, s66, 1
  s_lshl_b32 s57, s57, 18
  s_and_b32 s56, s66, 1
  s_lshl_b32 s56, s56, 15
  s_add_u32 s56, s56, s57
  s_add_u32 s63, s61, 16384
  s_add_u32 s62, s63, 0
  s_mov_b32 m0, s62
  s_nop 0
  buffer_load_dwordx4 v208, s[24:27], s56 offen lds
  v_mfma_f32_16x16x32_bf16 v[148:151], v[48:51], a[0:3], 0
  v_mfma_f32_16x16x32_bf16 v[152:155], v[80:83], a[0:3], 0
  v_mfma_f32_16x16x32_bf16 v[156:159], v[112:115], a[0:3], 0
  s_add_u32 s62, s63, 1024
  s_mov_b32 m0, s62
  s_nop 0
  buffer_load_dwordx4 v209, s[24:27], s56 offen lds
  v_mfma_f32_16x16x32_bf16 v[144:147], v[20:23], a[4:7], v[144:147]
  v_mfma_f32_16x16x32_bf16 v[148:151], v[52:55], a[4:7], v[148:151]
  v_mfma_f32_16x16x32_bf16 v[152:155], v[84:87], a[4:7], v[152:155]
  s_add_u32 s62, s63, 2048
  s_mov_b32 m0, s62
  s_nop 0
  buffer_load_dwordx4 v210, s[24:27], s56 offen lds
  v_mfma_f32_16x16x32_bf16 v[156:159], v[116:119], a[4:7], v[156:159]
  v_mfma_f32_16x16x32_bf16 v[144:147], v[24:27], a[8:11], v[144:147]
  v_mfma_f32_16x16x32_bf16 v[148:151], v[56:59], a[8:11], v[148:151]
  s_add_u32 s62, s63, 3072
  s_mov_b32 m0, s62
  s_nop 0
  buffer_load_dwordx4 v211, s[24:27], s56 offen lds
  v_mfma_f32_16x16x32_bf16 v[152:155], v[88:91], a[8:11], v[152:155]
  v_mfma_f32_16x16x32_bf16 v[156:159], v[120:123], a[8:11], v[156:159]
  v_mfma_f32_16x16x32_bf16 v[144:147], v[28:31], a[12:15], v[144:147]
  s_add_u32 s62, s63, 4096
  s_mov_b32 m0, s62
  s_nop 0
  buffer_load_dwordx4 v212, s[24:27], s56 offen lds
  v_mfma_f32_16x16x32_bf16 v[148:151], v[60:63], a[12:15], v[148:151]
  v_mfma_f32_16x16x32_bf16 v[152:155], v[92:95], a[12:15], v[152:155]
  v_mfma_f32_16x16x32_bf16 v[156:159], v[124:127], a[12:15], v[156:159]
  s_add_u32 s62, s63, 5120
  s_mov_b32 m0, s62
  s_nop 0
  buffer_load_dwordx4 v213, s[24:27], s56 offen lds
  v_mfma_f32_16x16x32_bf16 v[144:147], v[32:35], a[16:19], v[144:147]
  v_mfma_f32_16x16x32_bf16 v[148:151], v[64:67], a[16:19], v[148:151]
  v_mfma_f32_16x16x32_bf16 v[152:155], v[96:99], a[16:19], v[152:155]
  s_add_u32 s62, s63, 6144
  s_mov_b32 m0, s62
  s_nop 0
  buffer_load_dwordx4 v214, s[24:27], s56 offen lds
  v_mfma_f32_16x16x32_bf16 v[156:159], v[128:131], a[16:19], v[156:159]
  v_mfma_f32_16x16x32_bf16 v[144:147], v[36:39], a[20:23], v[144:147]
  v_mfma_f32_16x16x32_bf16 v[148:151], v[68:71], a[20:23], v[148:151]
  s_add_u32 s62, s63, 7168
  s_mov_b32 m0, s62
  s_nop 0
  buffer_load_dwordx4 v215, s[24:27], s56 offen lds
  v_mfma_f32_16x16x32_bf16 v[152:155], v[100:103], a[20:23], v[152:155]
  v_mfma_f32_16x16x32_bf16 v[156:159], v[132:135], a[20:23], v[156:159]
  s_waitcnt vmcnt(8)
  ds_read_b128 a[32:35], v220 offset:8192
  v_mfma_f32_16x16x32_bf16 v[144:147], v[40:43], a[24:27], v[144:147]
  ds_read_b128 a[36:39], v221 offset:8192
  v_mfma_f32_16x16x32_bf16 v[148:151], v[72:75], a[24:27], v[148:151]
  ds_read_b128 a[40:43], v222 offset:8192
  v_mfma_f32_16x16x32_bf16 v[152:155], v[104:107], a[24:27], v[152:155]
  ds_read_b128 a[44:47], v223 offset:8192
  v_mfma_f32_16x16x32_bf16 v[156:159], v[136:139], a[24:27], v[156:159]
  ds_read_b128 a[48:51], v220 offset:8448
  v_mfma_f32_16x16x32_bf16 v[144:147], v[44:47], a[28:31], v[144:147]
  ds_read_b128 a[52:55], v221 offset:8448
  v_mfma_f32_16x16x32_bf16 v[148:151], v[76:79], a[28:31], v[148:151]
  ds_read_b128 a[56:59], v222 offset:8448
  v_mfma_f32_16x16x32_bf16 v[152:155], v[108:111], a[28:31], v[152:155]
  ds_read_b128 a[60:63], v223 offset:8448
  v_mfma_f32_16x16x32_bf16 v[156:159], v[140:143], a[28:31], v[156:159]
  s_waitcnt lgkmcnt(0)
  v_mfma_f32_16x16x32_bf16 v[160:163], v[16:19], a[32:35], 0
  s_lshr_b32 s57, s67, 1
  s_lshl_b32 s57, s57, 18
  s_and_b32 s56, s67, 1
  s_lshl_b32 s56, s56, 15
  s_add_u32 s56, s56, s57
  s_add_u32 s63, s61, 0
  s_add_u32 s62, s63, 0
  s_mov_b32 m0, s62
  s_nop 0
  buffer_load_dwordx4 v208, s[24:27], s56 offen lds
  v_mfma_f32_16x16x32_bf16 v[164:167], v[48:51], a[32:35], 0
  v_mfma_f32_16x16x32_bf16 v[168:171], v[80:83], a[32:35], 0
  v_mfma_f32_16x16x32_bf16 v[172:175], v[112:115], a[32:35], 0
  s_add_u32 s62, s63, 1024
  s_mov_b32 m0, s62
  s_nop 0
  buffer_load_dwordx4 v209, s[24:27], s56 offen lds
  v_mfma_f32_16x16x32_bf16 v[160:163], v[20:23], a[36:39], v[160:163]
  v_pk_mul_f32 v[144:145], v[144:145], v[12:13]
  v_mfma_f32_16x16x32_bf16 v[164:167], v[52:55], a[36:39], v[164:167]
  v_pk_mul_f32 v[146:147], v[146:147], v[12:13]
  v_mfma_f32_16x16x32_bf16 v[168:171], v[84:87], a[36:39], v[168:171]
  s_add_u32 s62, s63, 2048
  s_mov_b32 m0, s62
  s_nop 0
  buffer_load_dwordx4 v210, s[24:27], s56 offen lds
  v_mfma_f32_16x16x32_bf16 v[172:175], v[116:119], a[36:39], v[172:175]
  v_pk_mul_f32 v[148:149], v[148:149], v[12:13]
  v_mfma_f32_16x16x32_bf16 v[160:163], v[24:27], a[40:43], v[160:163]
  v_pk_mul_f32 v[150:151], v[150:151], v[12:13]
  v_mfma_f32_16x16x32_bf16 v[164:167], v[56:59], a[40:43], v[164:167]
  s_add_u32 s62, s63, 3072
  s_mov_b32 m0, s62
  s_nop 0
  buffer_load_dwordx4 v211, s[24:27], s56 offen lds
  v_mfma_f32_16x16x32_bf16 v[168:171], v[88:91], a[40:43], v[168:171]
  v_pk_mul_f32 v[152:153], v[152:153], v[12:13]
  v_mfma_f32_16x16x32_bf16 v[172:175], v[120:123], a[40:43], v[172:175]
  v_pk_mul_f32 v[154:155], v[154:155], v[12:13]
  v_mfma_f32_16x16x32_bf16 v[160:163], v[28:31], a[44:47], v[160:163]
  s_add_u32 s62, s63, 4096
  s_mov_b32 m0, s62
  s_nop 0
  buffer_load_dwordx4 v212, s[24:27], s56 offen lds
  v_mfma_f32_16x16x32_bf16 v[164:167], v[60:63], a[44:47], v[164:167]
  v_pk_mul_f32 v[156:157], v[156:157], v[12:13]
  v_mfma_f32_16x16x32_bf16 v[168:171], v[92:95], a[44:47], v[168:171]
  v_pk_mul_f32 v[158:159], v[158:159], v[12:13]
  v_mfma_f32_16x16x32_bf16 v[172:175], v[124:127], a[44:47], v[172:175]
  s_add_u32 s62, s63, 5120
  s_mov_b32 m0, s62
  s_nop 0
  buffer_load_dwordx4 v213, s[24:27], s56 offen lds
  v_mfma_f32_16x16x32_bf16 v[160:163], v[32:35], a[48:51], v[160:163]
  v_cvt_pk_bf16_f32 v176, v144, v145
  v_mfma_f32_16x16x32_bf16 v[164:167], v[64:67], a[48:51], v[164:167]
  v_cvt_pk_bf16_f32 v177, v146, v147
  v_mfma_f32_16x16x32_bf16 v[168:171], v[96:99], a[48:51], v[168:171]
  s_add_u32 s62, s63, 6144
  s_mov_b32 m0, s62
  s_nop 0
  buffer_load_dwordx4 v214, s[24:27], s56 offen lds
  v_mfma_f32_16x16x32_bf16 v[172:175], v[128:131], a[48:51], v[172:175]
  v_cvt_pk_bf16_f32 v178, v148, v149
  v_mfma_f32_16x16x32_bf16 v[160:163], v[36:39], a[52:55], v[160:163]
  v_cvt_pk_bf16_f32 v179, v150, v151
  v_mfma_f32_16x16x32_bf16 v[164:167], v[68:71], a[52:55], v[164:167]
  s_add_u32 s62, s63, 7168
  s_mov_b32 m0, s62
  s_nop 0
  buffer_load_dwordx4 v215, s[24:27], s56 offen lds
  v_mfma_f32_16x16x32_bf16 v[168:171], v[100:103], a[52:55], v[168:171]
  v_cvt_pk_bf16_f32 v180, v152, v153
  v_mfma_f32_16x16x32_bf16 v[172:175], v[132:135], a[52:55], v[172:175]
  v_cvt_pk_bf16_f32 v181, v154, v155
  s_waitcnt vmcnt(8)
  ds_read_b128 a[0:3], v220 offset:16384
  v_mfma_f32_16x16x32_bf16 v[160:163], v[40:43], a[56:59], v[160:163]
  v_cvt_pk_bf16_f32 v182, v156, v157
  ds_read_b128 a[4:7], v221 offset:16384
  v_mfma_f32_16x16x32_bf16 v[164:167], v[72:75], a[56:59], v[164:167]
  v_cvt_pk_bf16_f32 v183, v158, v159
  ds_read_b128 a[8:11], v222 offset:16384
  v_mfma_f32_16x16x32_bf16 v[168:171], v[104:107], a[56:59], v[168:171]
  ds_read_b128 a[12:15], v223 offset:16384
  v_mfma_f32_16x16x32_bf16 v[172:175], v[136:139], a[56:59], v[172:175]
  ds_read_b128 a[16:19], v220 offset:16640
  v_mfma_f32_16x16x32_bf16 v[160:163], v[44:47], a[60:63], v[160:163]
  ds_read_b128 a[20:23], v221 offset:16640
  v_mfma_f32_16x16x32_bf16 v[164:167], v[76:79], a[60:63], v[164:167]
  ds_read_b128 a[24:27], v222 offset:16640
  v_mfma_f32_16x16x32_bf16 v[168:171], v[108:111], a[60:63], v[168:171]
  ds_read_b128 a[28:31], v223 offset:16640
  v_mfma_f32_16x16x32_bf16 v[172:175], v[140:143], a[60:63], v[172:175]
  s_waitcnt lgkmcnt(0)
  v_mfma_f32_16x16x32_bf16 v[144:147], v[16:19], a[0:3], 0
  s_lshr_b32 s57, s68, 1
  s_lshl_b32 s57, s57, 18
  s_and_b32 s56, s68, 1
  s_lshl_b32 s56, s56, 15
  s_add_u32 s56, s56, s57
  s_add_u32 s63, s61, 8192
  s_add_u32 s62, s63, 0
  s_mov_b32 m0, s62
  s_nop 0
  buffer_load_dwordx4 v208, s[24:27], s56 offen lds
  v_mfma_f32_16x16x32_bf16 v[148:151], v[48:51], a[0:3], 0
  v_mfma_f32_16x16x32_bf16 v[152:155], v[80:83], a[0:3], 0
  v_mfma_f32_16x16x32_bf16 v[156:159], v[112:115], a[0:3], 0
  s_add_u32 s62, s63, 1024
  s_mov_b32 m0, s62
  s_nop 0
  buffer_load_dwordx4 v209, s[24:27], s56 offen lds
  v_mfma_f32_16x16x32_bf16 v[144:147], v[20:23], a[4:7], v[144:147]
  v_pk_mul_f32 v[160:161], v[160:161], v[12:13]
  v_mfma_f32_16x16x32_bf16 v[148:151], v[52:55], a[4:7], v[148:151]
  v_pk_mul_f32 v[162:163], v[162:163], v[12:13]
  v_mfma_f32_16x16x32_bf16 v[152:155], v[84:87], a[4:7], v[152:155]
  s_add_u32 s62, s63, 2048
  s_mov_b32 m0, s62
  s_nop 0
  buffer_load_dwordx4 v210, s[24:27], s56 offen lds
  v_mfma_f32_16x16x32_bf16 v[156:159], v[116:119], a[4:7], v[156:159]
  v_pk_mul_f32 v[164:165], v[164:165], v[12:13]
  v_mfma_f32_16x16x32_bf16 v[144:147], v[24:27], a[8:11], v[144:147]
  v_pk_mul_f32 v[166:167], v[166:167], v[12:13]
  v_mfma_f32_16x16x32_bf16 v[148:151], v[56:59], a[8:11], v[148:151]
  s_add_u32 s62, s63, 3072
  s_mov_b32 m0, s62
  s_nop 0
  buffer_load_dwordx4 v211, s[24:27], s56 offen lds
  v_mfma_f32_16x16x32_bf16 v[152:155], v[88:91], a[8:11], v[152:155]
  v_pk_mul_f32 v[168:169], v[168:169], v[12:13]
  v_mfma_f32_16x16x32_bf16 v[156:159], v[120:123], a[8:11], v[156:159]
  v_pk_mul_f32 v[170:171], v[170:171], v[12:13]
  v_mfma_f32_16x16x32_bf16 v[144:147], v[28:31], a[12:15], v[144:147]
  s_add_u32 s62, s63, 4096
  s_mov_b32 m0, s62
  s_nop 0
  buffer_load_dwordx4 v212, s[24:27], s56 offen lds
  v_mfma_f32_16x16x32_bf16 v[148:151], v[60:63], a[12:15], v[148:151]
  v_pk_mul_f32 v[172:173], v[172:173], v[12:13]
  v_mfma_f32_16x16x32_bf16 v[152:155], v[92:95], a[12:15], v[152:155]
  v_pk_mul_f32 v[174:175], v[174:175], v[12:13]
  v_mfma_f32_16x16x32_bf16 v[156:159], v[124:127], a[12:15], v[156:159]
  s_add_u32 s62, s63, 5120
  s_mov_b32 m0, s62
  s_nop 0
  buffer_load_dwordx4 v213, s[24:27], s56 offen lds
  v_mfma_f32_16x16x32_bf16 v[144:147], v[32:35], a[16:19], v[144:147]
  v_cvt_pk_bf16_f32 v184, v160, v161
  v_mfma_f32_16x16x32_bf16 v[148:151], v[64:67], a[16:19], v[148:151]
  v_cvt_pk_bf16_f32 v185, v162, v163
  v_mfma_f32_16x16x32_bf16 v[152:155], v[96:99], a[16:19], v[152:155]
  s_add_u32 s62, s63, 6144
  s_mov_b32 m0, s62
  s_nop 0
  buffer_load_dwordx4 v214, s[24:27], s56 offen lds
  v_mfma_f32_16x16x32_bf16 v[156:159], v[128:131], a[16:19], v[156:159]
  v_cvt_pk_bf16_f32 v186, v164, v165
  v_mfma_f32_16x16x32_bf16 v[144:147], v[36:39], a[20:23], v[144:147]
  v_cvt_pk_bf16_f32 v187, v166, v167
  v_mfma_f32_16x16x32_bf16 v[148:151], v[68:71], a[20:23], v[148:151]
  s_add_u32 s62, s63, 7168
  s_mov_b32 m0, s62
  s_nop 0
  buffer_load_dwordx4 v215, s[24:27], s56 offen lds
  v_mfma_f32_16x16x32_bf16 v[152:155], v[100:103], a[20:23], v[152:155]
  v_cvt_pk_bf16_f32 v188, v168, v169
  v_mfma_f32_16x16x32_bf16 v[156:159], v[132:135], a[20:23], v[156:159]
  v_cvt_pk_bf16_f32 v189, v170, v171
  s_waitcnt vmcnt(8)
  ds_read_b128 a[32:35], v220 offset:0
  v_mfma_f32_16x16x32_bf16 v[144:147], v[40:43], a[24:27], v[144:147]
  v_cvt_pk_bf16_f32 v190, v172, v173
  ds_read_b128 a[36:39], v221 offset:0
  v_mfma_f32_16x16x32_bf16 v[148:151], v[72:75], a[24:27], v[148:151]
  v_cvt_pk_bf16_f32 v191, v174, v175
  ds_read_b128 a[40:43], v222 offset:0
  v_mfma_f32_16x16x32_bf16 v[152:155], v[104:107], a[24:27], v[152:155]
  ds_read_b128 a[44:47], v223 offset:0
  v_mfma_f32_16x16x32_bf16 v[156:159], v[136:139], a[24:27], v[156:159]
  ds_read_b128 a[48:51], v220 offset:256
  v_mfma_f32_16x16x32_bf16 v[144:147], v[44:47], a[28:31], v[144:147]
  ds_read_b128 a[52:55], v221 offset:256
  v_mfma_f32_16x16x32_bf16 v[148:151], v[76:79], a[28:31], v[148:151]
  ds_read_b128 a[56:59], v222 offset:256
  v_mfma_f32_16x16x32_bf16 v[152:155], v[108:111], a[28:31], v[152:155]
  ds_read_b128 a[60:63], v223 offset:256
  v_mfma_f32_16x16x32_bf16 v[156:159], v[140:143], a[28:31], v[156:159]
  s_waitcnt lgkmcnt(0)
  v_mfma_f32_16x16x32_bf16 v[160:163], v[16:19], a[32:35], 0
  s_lshr_b32 s57, s69, 1
  s_lshl_b32 s57, s57, 18
  s_and_b32 s56, s69, 1
  s_lshl_b32 s56, s56, 15
  s_add_u32 s56, s56, s57
  s_add_u32 s63, s61, 16384
  s_add_u32 s62, s63, 0
  s_mov_b32 m0, s62
  s_nop 0
  buffer_load_dwordx4 v208, s[24:27], s56 offen lds
  v_mfma_f32_16x16x32_bf16 v[164:167], v[48:51], a[32:35], 0
  v_mfma_f32_16x16x32_bf16 v[168:171], v[80:83], a[32:35], 0
  v_mfma_f32_16x16x32_bf16 v[172:175], v[112:115], a[32:35], 0
  s_add_u32 s62, s63, 1024
  s_mov_b32 m0, s62
  s_nop 0
  buffer_load_dwordx4 v209, s[24:27], s56 offen lds
  v_mfma_f32_16x16x32_bf16 v[160:163], v[20:23], a[36:39], v[160:163]
  v_pk_mul_f32 v[144:145], v[144:145], v[12:13]
  v_mfma_f32_16x16x32_bf16 v[164:167], v[52:55], a[36:39], v[164:167]
  v_pk_mul_f32 v[146:147], v[146:147], v[12:13]
  v_mfma_f32_16x16x32_bf16 v[168:171], v[84:87], a[36:39], v[168:171]
  s_add_u32 s62, s63, 2048
  s_mov_b32 m0, s62
  s_nop 0
  buffer_load_dwordx4 v210, s[24:27], s56 offen lds
  v_mfma_f32_16x16x32_bf16 v[172:175], v[116:119], a[36:39], v[172:175]
  v_pk_mul_f32 v[148:149], v[148:149], v[12:13]
  v_mfma_f32_16x16x32_bf16 v[160:163], v[24:27], a[40:43], v[160:163]
  v_pk_mul_f32 v[150:151], v[150:151], v[12:13]
  v_mfma_f32_16x16x32_bf16 v[164:167], v[56:59], a[40:43], v[164:167]
  s_add_u32 s62, s63, 3072
  s_mov_b32 m0, s62
  s_nop 0
  buffer_load_dwordx4 v211, s[24:27], s56 offen lds
  v_mfma_f32_16x16x32_bf16 v[168:171], v[88:91], a[40:43], v[168:171]
  v_pk_mul_f32 v[152:153], v[152:153], v[12:13]
  v_mfma_f32_16x16x32_bf16 v[172:175], v[120:123], a[40:43], v[172:175]
  v_pk_mul_f32 v[154:155], v[154:155], v[12:13]
  v_mfma_f32_16x16x32_bf16 v[160:163], v[28:31], a[44:47], v[160:163]
  s_add_u32 s62, s63, 4096
  s_mov_b32 m0, s62
  s_nop 0
  buffer_load_dwordx4 v212, s[24:27], s56 offen lds
  v_mfma_f32_16x16x32_bf16 v[164:167], v[60:63], a[44:47], v[164:167]
  v_pk_mul_f32 v[156:157], v[156:157], v[12:13]
  v_mfma_f32_16x16x32_bf16 v[168:171], v[92:95], a[44:47], v[168:171]
  v_pk_mul_f32 v[158:159], v[158:159], v[12:13]
  v_mfma_f32_16x16x32_bf16 v[172:175], v[124:127], a[44:47], v[172:175]
  s_add_u32 s62, s63, 5120
  s_mov_b32 m0, s62
  s_nop 0
  buffer_load_dwordx4 v213, s[24:27], s56 offen lds
  v_mfma_f32_16x16x32_bf16 v[160:163], v[32:35], a[48:51], v[160:163]
  v_cvt_pk_bf16_f32 v192, v144, v145
  v_mfma_f32_16x16x32_bf16 v[164:167], v[64:67], a[48:51], v[164:167]
  v_cvt_pk_bf16_f32 v193, v146, v147
  v_mfma_f32_16x16x32_bf16 v[168:171], v[96:99], a[48:51], v[168:171]
  s_add_u32 s62, s63, 6144
  s_mov_b32 m0, s62
  s_nop 0
  buffer_load_dwordx4 v214, s[24:27], s56 offen lds
  v_mfma_f32_16x16x32_bf16 v[172:175], v[128:131], a[48:51], v[172:175]
  v_cvt_pk_bf16_f32 v194, v148, v149
  v_mfma_f32_16x16x32_bf16 v[160:163], v[36:39], a[52:55], v[160:163]
  v_cvt_pk_bf16_f32 v195, v150, v151
  v_mfma_f32_16x16x32_bf16 v[164:167], v[68:71], a[52:55], v[164:167]
  s_add_u32 s62, s63, 7168
  s_mov_b32 m0, s62
  s_nop 0
  buffer_load_dwordx4 v215, s[24:27], s56 offen lds
  v_mfma_f32_16x16x32_bf16 v[168:171], v[100:103], a[52:55], v[168:171]
  v_cvt_pk_bf16_f32 v196, v152, v153
  v_mfma_f32_16x16x32_bf16 v[172:175], v[132:135], a[52:55], v[172:175]
  v_cvt_pk_bf16_f32 v197, v154, v155
  s_waitcnt vmcnt(8)
  ds_read_b128 a[0:3], v220 offset:8192
  v_mfma_f32_16x16x32_bf16 v[160:163], v[40:43], a[56:59], v[160:163]
  v_cvt_pk_bf16_f32 v198, v156, v157
  ds_read_b128 a[4:7], v221 offset:8192
  v_mfma_f32_16x16x32_bf16 v[164:167], v[72:75], a[56:59], v[164:167]
  v_cvt_pk_bf16_f32 v199, v158, v159
  ds_read_b128 a[8:11], v222 offset:8192
  v_mfma_f32_16x16x32_bf16 v[168:171], v[104:107], a[56:59], v[168:171]
  ds_read_b128 a[12:15], v223 offset:8192
  v_mfma_f32_16x16x32_bf16 v[172:175], v[136:139], a[56:59], v[172:175]
  ds_read_b128 a[16:19], v220 offset:8448
  v_mfma_f32_16x16x32_bf16 v[160:163], v[44:47], a[60:63], v[160:163]
  ds_read_b128 a[20:23], v221 offset:8448
  v_mfma_f32_16x16x32_bf16 v[164:167], v[76:79], a[60:63], v[164:167]
  ds_read_b128 a[24:27], v222 offset:8448
  v_mfma_f32_16x16x32_bf16 v[168:171], v[108:111], a[60:63], v[168:171]
  ds_read_b128 a[28:31], v223 offset:8448
  v_mfma_f32_16x16x32_bf16 v[172:175], v[140:143], a[60:63], v[172:175]
  s_waitcnt lgkmcnt(0)
  v_mfma_f32_16x16x32_bf16 v[144:147], v[16:19], a[0:3], 0
  s_lshr_b32 s57, s70, 1
  s_lshl_b32 s57, s57, 18
  s_and_b32 s56, s70, 1
  s_lshl_b32 s56, s56, 15
  s_add_u32 s56, s56, s57
  s_add_u32 s63, s61, 0
  s_add_u32 s62, s63, 0
  s_mov_b32 m0, s62
  s_nop 0
  buffer_load_dwordx4 v208, s[24:27], s56 offen lds
  v_mfma_f32_16x16x32_bf16 v[148:151], v[48:51], a[0:3], 0
  v_mfma_f32_16x16x32_bf16 v[152:155], v[80:83], a[0:3], 0
  s_lshl_b32 s59, s3, 10
  v_add_u32 v9, s59, v3
  v_mov_b32 v248, -1
  v_mov_b32 v249, -1
  v_mov_b32 v250, -1
  v_mov_b32 v251, -1
  s_add_u32 s59, s28, 0
  s_cmp_ge_u32 s59, 410
  s_cbranch_scc1 L_pz_4
  s_mov_b32 s73, 45883392
  s_cmp_ge_u32 s59, 126
  s_cselect_b32 s73, 45891584, s73
  s_lshl_b32 s59, s59, 12
  s_add_u32 s59, s59, s73
  buffer_store_dwordx4 v[248:251], v9, s[8:11], s59 offen sc1
L_pz_4:
  s_add_u32 s59, s28, 224
  s_cmp_ge_u32 s59, 410
  s_cbranch_scc1 L_pz_5
  s_mov_b32 s73, 45891584
  s_lshl_b32 s59, s59, 12
  s_add_u32 s59, s59, s73
  buffer_store_dwordx4 v[248:251], v9, s[8:11], s59 offen sc1
L_pz_5:
  v_mfma_f32_16x16x32_bf16 v[156:159], v[112:115], a[0:3], 0
  s_add_u32 s62, s63, 1024
  s_mov_b32 m0, s62
  s_nop 0
  buffer_load_dwordx4 v209, s[24:27], s56 offen lds
  v_mfma_f32_16x16x32_bf16 v[144:147], v[20:23], a[4:7], v[144:147]
  v_pk_mul_f32 v[160:161], v[160:161], v[12:13]
  v_mfma_f32_16x16x32_bf16 v[148:151], v[52:55], a[4:7], v[148:151]
  v_pk_mul_f32 v[162:163], v[162:163], v[12:13]
  v_mfma_f32_16x16x32_bf16 v[152:155], v[84:87], a[4:7], v[152:155]
  s_add_u32 s62, s63, 2048
  s_mov_b32 m0, s62
  s_nop 0
  buffer_load_dwordx4 v210, s[24:27], s56 offen lds
  s_mul_i32 s59, s64, 14336
  s_add_u32 s59, s59, s36
  buffer_store_dwordx4 v[176:179], v3, s[8:11], s59 offen offset:0 sc1
  buffer_store_dwordx4 v[180:183], v3, s[8:11], s59 offen offset:1024 sc1
  v_mfma_f32_16x16x32_bf16 v[156:159], v[116:119], a[4:7], v[156:159]
  v_pk_mul_f32 v[164:165], v[164:165], v[12:13]
  v_mfma_f32_16x16x32_bf16 v[144:147], v[24:27], a[8:11], v[144:147]
  v_pk_mul_f32 v[166:167], v[166:167], v[12:13]
  v_mfma_f32_16x16x32_bf16 v[148:151], v[56:59], a[8:11], v[148:151]
  s_add_u32 s62, s63, 3072
  s_mov_b32 m0, s62
  s_nop 0
  buffer_load_dwordx4 v211, s[24:27], s56 offen lds
  v_mfma_f32_16x16x32_bf16 v[152:155], v[88:91], a[8:11], v[152:155]
  v_pk_mul_f32 v[168:169], v[168:169], v[12:13]
  v_mfma_f32_16x16x32_bf16 v[156:159], v[120:123], a[8:11], v[156:159]
  v_pk_mul_f32 v[170:171], v[170:171], v[12:13]
  v_mfma_f32_16x16x32_bf16 v[144:147], v[28:31], a[12:15], v[144:147]
  s_add_u32 s62, s63, 4096
  s_mov_b32 m0, s62
  s_nop 0
  buffer_load_dwordx4 v212, s[24:27], s56 offen lds
  s_mul_i32 s59, s65, 14336
  s_add_u32 s59, s59, s36
  buffer_store_dwordx4 v[184:187], v3, s[8:11], s59 offen offset:0 sc1
  buffer_store_dwordx4 v[188:191], v3, s[8:11], s59 offen offset:1024 sc1
  v_mfma_f32_16x16x32_bf16 v[148:151], v[60:63], a[12:15], v[148:151]
  v_pk_mul_f32 v[172:173], v[172:173], v[12:13]
  v_mfma_f32_16x16x32_bf16 v[152:155], v[92:95], a[12:15], v[152:155]
  v_pk_mul_f32 v[174:175], v[174:175], v[12:13]
  v_mfma_f32_16x16x32_bf16 v[156:159], v[124:127], a[12:15], v[156:159]
  s_add_u32 s62, s63, 5120
  s_mov_b32 m0, s62
  s_nop 0
  buffer_load_dwordx4 v213, s[24:27], s56 offen lds
  v_mfma_f32_16x16x32_bf16 v[144:147], v[32:35], a[16:19], v[144:147]
  v_cvt_pk_bf16_f32 v200, v160, v161
  v_mfma_f32_16x16x32_bf16 v[148:151], v[64:67], a[16:19], v[148:151]
  v_cvt_pk_bf16_f32 v201, v162, v163
  v_mfma_f32_16x16x32_bf16 v[152:155], v[96:99], a[16:19], v[152:155]
  s_add_u32 s62, s63, 6144
  s_mov_b32 m0, s62
  s_nop 0
  buffer_load_dwordx4 v214, s[24:27], s56 offen lds
  s_mul_i32 s59, s66, 14336
  s_add_u32 s59, s59, s36
  buffer_store_dwordx4 v[192:195], v3, s[8:11], s59 offen offset:0 sc1
  buffer_store_dwordx4 v[196:199], v3, s[8:11], s59 offen offset:1024 sc1
  v_mfma_f32_16x16x32_bf16 v[156:159], v[128:131], a[16:19], v[156:159]
  v_cvt_pk_bf16_f32 v202, v164, v165
  v_mfma_f32_16x16x32_bf16 v[144:147], v[36:39], a[20:23], v[144:147]
  v_cvt_pk_bf16_f32 v203, v166, v167
  v_mfma_f32_16x16x32_bf16 v[148:151], v[68:71], a[20:23], v[148:151]
  s_add_u32 s62, s63, 7168
  s_mov_b32 m0, s62
  s_nop 0
  buffer_load_dwordx4 v215, s[24:27], s56 offen lds
  v_mfma_f32_16x16x32_bf16 v[152:155], v[100:103], a[20:23], v[152:155]
  v_cvt_pk_bf16_f32 v204, v168, v169
  v_mfma_f32_16x16x32_bf16 v[156:159], v[132:135], a[20:23], v[156:159]
  v_cvt_pk_bf16_f32 v205, v170, v171
  s_waitcnt vmcnt(14)
  ds_read_b128 a[32:35], v220 offset:16384
  v_mfma_f32_16x16x32_bf16 v[144:147], v[40:43], a[24:27], v[144:147]
  v_cvt_pk_bf16_f32 v206, v172, v173
  ds_read_b128 a[36:39], v221 offset:16384
  v_mfma_f32_16x16x32_bf16 v[148:151], v[72:75], a[24:27], v[148:151]
  v_cvt_pk_bf16_f32 v207, v174, v175
  ds_read_b128 a[40:43], v222 offset:16384
  v_mfma_f32_16x16x32_bf16 v[152:155], v[104:107], a[24:27], v[152:155]
  ds_read_b128 a[44:47], v223 offset:16384
  v_mfma_f32_16x16x32_bf16 v[156:159], v[136:139], a[24:27], v[156:159]
  ds_read_b128 a[48:51], v220 offset:16640
  v_mfma_f32_16x16x32_bf16 v[144:147], v[44:47], a[28:31], v[144:147]
  ds_read_b128 a[52:55], v221 offset:16640
  v_mfma_f32_16x16x32_bf16 v[148:151], v[76:79], a[28:31], v[148:151]
  ds_read_b128 a[56:59], v222 offset:16640
  v_mfma_f32_16x16x32_bf16 v[152:155], v[108:111], a[28:31], v[152:155]
  ds_read_b128 a[60:63], v223 offset:16640
  v_mfma_f32_16x16x32_bf16 v[156:159], v[140:143], a[28:31], v[156:159]
  s_mul_i32 s59, s67, 14336
  s_add_u32 s59, s59, s36
  buffer_store_dwordx4 v[200:203], v3, s[8:11], s59 offen offset:0 sc1
  buffer_store_dwordx4 v[204:207], v3, s[8:11], s59 offen offset:1024 sc1
  s_waitcnt lgkmcnt(0)
  v_mfma_f32_16x16x32_bf16 v[160:163], v[16:19], a[32:35], 0
  v_mfma_f32_16x16x32_bf16 v[164:167], v[48:51], a[32:35], 0
  v_mfma_f32_16x16x32_bf16 v[168:171], v[80:83], a[32:35], 0
  v_mfma_f32_16x16x32_bf16 v[172:175], v[112:115], a[32:35], 0
  v_mfma_f32_16x16x32_bf16 v[160:163], v[20:23], a[36:39], v[160:163]
  v_pk_mul_f32 v[144:145], v[144:145], v[12:13]
  v_mfma_f32_16x16x32_bf16 v[164:167], v[52:55], a[36:39], v[164:167]
  v_pk_mul_f32 v[146:147], v[146:147], v[12:13]
  v_mfma_f32_16x16x32_bf16 v[168:171], v[84:87], a[36:39], v[168:171]
  v_pk_mul_f32 v[148:149], v[148:149], v[12:13]
  v_mfma_f32_16x16x32_bf16 v[172:175], v[116:119], a[36:39], v[172:175]
  v_pk_mul_f32 v[150:151], v[150:151], v[12:13]
  v_mfma_f32_16x16x32_bf16 v[160:163], v[24:27], a[40:43], v[160:163]
  v_pk_mul_f32 v[152:153], v[152:153], v[12:13]
  v_mfma_f32_16x16x32_bf16 v[164:167], v[56:59], a[40:43], v[164:167]
  v_pk_mul_f32 v[154:155], v[154:155], v[12:13]
  v_mfma_f32_16x16x32_bf16 v[168:171], v[88:91], a[40:43], v[168:171]
  v_pk_mul_f32 v[156:157], v[156:157], v[12:13]
  v_mfma_f32_16x16x32_bf16 v[172:175], v[120:123], a[40:43], v[172:175]
  v_pk_mul_f32 v[158:159], v[158:159], v[12:13]
  v_mfma_f32_16x16x32_bf16 v[160:163], v[28:31], a[44:47], v[160:163]
  v_cvt_pk_bf16_f32 v224, v144, v145
  v_mfma_f32_16x16x32_bf16 v[164:167], v[60:63], a[44:47], v[164:167]
  v_cvt_pk_bf16_f32 v225, v146, v147
  v_mfma_f32_16x16x32_bf16 v[168:171], v[92:95], a[44:47], v[168:171]
  v_cvt_pk_bf16_f32 v226, v148, v149
  v_mfma_f32_16x16x32_bf16 v[172:175], v[124:127], a[44:47], v[172:175]
  v_cvt_pk_bf16_f32 v227, v150, v151
  v_mfma_f32_16x16x32_bf16 v[160:163], v[32:35], a[48:51], v[160:163]
  v_cvt_pk_bf16_f32 v228, v152, v153
  v_mfma_f32_16x16x32_bf16 v[164:167], v[64:67], a[48:51], v[164:167]
  v_cvt_pk_bf16_f32 v229, v154, v155
  v_mfma_f32_16x16x32_bf16 v[168:171], v[96:99], a[48:51], v[168:171]
  v_cvt_pk_bf16_f32 v230, v156, v157
  v_mfma_f32_16x16x32_bf16 v[172:175], v[128:131], a[48:51], v[172:175]
  v_cvt_pk_bf16_f32 v231, v158, v159
  v_mfma_f32_16x16x32_bf16 v[160:163], v[36:39], a[52:55], v[160:163]
  v_mfma_f32_16x16x32_bf16 v[164:167], v[68:71], a[52:55], v[164:167]
  v_mfma_f32_16x16x32_bf16 v[168:171], v[100:103], a[52:55], v[168:171]
  v_mfma_f32_16x16x32_bf16 v[172:175], v[132:135], a[52:55], v[172:175]
  s_waitcnt vmcnt(2)
  ds_read_b128 a[0:3], v220 offset:0
  v_mfma_f32_16x16x32_bf16 v[160:163], v[40:43], a[56:59], v[160:163]
  ds_read_b128 a[4:7], v221 offset:0
  v_mfma_f32_16x16x32_bf16 v[164:167], v[72:75], a[56:59], v[164:167]
  ds_read_b128 a[8:11], v222 offset:0
  v_mfma_f32_16x16x32_bf16 v[168:171], v[104:107], a[56:59], v[168:171]
  ds_read_b128 a[12:15], v223 offset:0
  v_mfma_f32_16x16x32_bf16 v[172:175], v[136:139], a[56:59], v[172:175]
  ds_read_b128 a[16:19], v220 offset:256
  v_mfma_f32_16x16x32_bf16 v[160:163], v[44:47], a[60:63], v[160:163]
  ds_read_b128 a[20:23], v221 offset:256
  v_mfma_f32_16x16x32_bf16 v[164:167], v[76:79], a[60:63], v[164:167]
  ds_read_b128 a[24:27], v222 offset:256
  v_mfma_f32_16x16x32_bf16 v[168:171], v[108:111], a[60:63], v[168:171]
  ds_read_b128 a[28:31], v223 offset:256
  v_mfma_f32_16x16x32_bf16 v[172:175], v[140:143], a[60:63], v[172:175]
  s_mul_i32 s59, s68, 14336
  s_add_u32 s59, s59, s36
  buffer_store_dwordx4 v[224:227], v3, s[8:11], s59 offen offset:0 sc1
  buffer_store_dwordx4 v[228:231], v3, s[8:11], s59 offen offset:1024 sc1
  s_waitcnt lgkmcnt(0)
  v_mfma_f32_16x16x32_bf16 v[144:147], v[16:19], a[0:3], 0
  v_mfma_f32_16x16x32_bf16 v[148:151], v[48:51], a[0:3], 0
  v_mfma_f32_16x16x32_bf16 v[152:155], v[80:83], a[0:3], 0
  v_mfma_f32_16x16x32_bf16 v[156:159], v[112:115], a[0:3], 0
  v_mfma_f32_16x16x32_bf16 v[144:147], v[20:23], a[4:7], v[144:147]
  v_pk_mul_f32 v[160:161], v[160:161], v[12:13]
  v_mfma_f32_16x16x32_bf16 v[148:151], v[52:55], a[4:7], v[148:151]
  v_pk_mul_f32 v[162:163], v[162:163], v[12:13]
  v_mfma_f32_16x16x32_bf16 v[152:155], v[84:87], a[4:7], v[152:155]
  v_pk_mul_f32 v[164:165], v[164:165], v[12:13]
  v_mfma_f32_16x16x32_bf16 v[156:159], v[116:119], a[4:7], v[156:159]
  v_pk_mul_f32 v[166:167], v[166:167], v[12:13]
  v_mfma_f32_16x16x32_bf16 v[144:147], v[24:27], a[8:11], v[144:147]
  v_pk_mul_f32 v[168:169], v[168:169], v[12:13]
  v_mfma_f32_16x16x32_bf16 v[148:151], v[56:59], a[8:11], v[148:151]
  v_pk_mul_f32 v[170:171], v[170:171], v[12:13]
  v_mfma_f32_16x16x32_bf16 v[152:155], v[88:91], a[8:11], v[152:155]
  v_pk_mul_f32 v[172:173], v[172:173], v[12:13]
  v_mfma_f32_16x16x32_bf16 v[156:159], v[120:123], a[8:11], v[156:159]
  v_pk_mul_f32 v[174:175], v[174:175], v[12:13]
  v_mfma_f32_16x16x32_bf16 v[144:147], v[28:31], a[12:15], v[144:147]
  v_cvt_pk_bf16_f32 v232, v160, v161
  v_mfma_f32_16x16x32_bf16 v[148:151], v[60:63], a[12:15], v[148:151]
  v_cvt_pk_bf16_f32 v233, v162, v163
  v_mfma_f32_16x16x32_bf16 v[152:155], v[92:95], a[12:15], v[152:155]
  v_cvt_pk_bf16_f32 v234, v164, v165
  v_mfma_f32_16x16x32_bf16 v[156:159], v[124:127], a[12:15], v[156:159]
  v_cvt_pk_bf16_f32 v235, v166, v167
  v_mfma_f32_16x16x32_bf16 v[144:147], v[32:35], a[16:19], v[144:147]
  v_cvt_pk_bf16_f32 v236, v168, v169
  v_mfma_f32_16x16x32_bf16 v[148:151], v[64:67], a[16:19], v[148:151]
  v_cvt_pk_bf16_f32 v237, v170, v171
  v_mfma_f32_16x16x32_bf16 v[152:155], v[96:99], a[16:19], v[152:155]
  v_cvt_pk_bf16_f32 v238, v172, v173
  v_mfma_f32_16x16x32_bf16 v[156:159], v[128:131], a[16:19], v[156:159]
  v_cvt_pk_bf16_f32 v239, v174, v175
  v_mfma_f32_16x16x32_bf16 v[144:147], v[36:39], a[20:23], v[144:147]
  v_mfma_f32_16x16x32_bf16 v[148:151], v[68:71], a[20:23], v[148:151]
  v_mfma_f32_16x16x32_bf16 v[152:155], v[100:103], a[20:23], v[152:155]
  v_mfma_f32_16x16x32_bf16 v[156:159], v[132:135], a[20:23], v[156:159]
  v_mfma_f32_16x16x32_bf16 v[144:147], v[40:43], a[24:27], v[144:147]
  v_mfma_f32_16x16x32_bf16 v[148:151], v[72:75], a[24:27], v[148:151]
  v_mfma_f32_16x16x32_bf16 v[152:155], v[104:107], a[24:27], v[152:155]
  v_mfma_f32_16x16x32_bf16 v[156:159], v[136:139], a[24:27], v[156:159]
  v_mfma_f32_16x16x32_bf16 v[144:147], v[44:47], a[28:31], v[144:147]
  v_mfma_f32_16x16x32_bf16 v[148:151], v[76:79], a[28:31], v[148:151]
  v_mfma_f32_16x16x32_bf16 v[152:155], v[108:111], a[28:31], v[152:155]
  v_mfma_f32_16x16x32_bf16 v[156:159], v[140:143], a[28:31], v[156:159]
  s_mul_i32 s59, s69, 14336
  s_add_u32 s59, s59, s36
  buffer_store_dwordx4 v[232:235], v3, s[8:11], s59 offen offset:0 sc1
  buffer_store_dwordx4 v[236:239], v3, s[8:11], s59 offen offset:1024 sc1
  s_nop 0
  v_pk_mul_f32 v[144:145], v[144:145], v[12:13]
  v_pk_mul_f32 v[146:147], v[146:147], v[12:13]
  v_pk_mul_f32 v[148:149], v[148:149], v[12:13]
  v_pk_mul_f32 v[150:151], v[150:151], v[12:13]
  v_pk_mul_f32 v[152:153], v[152:153], v[12:13]
  v_pk_mul_f32 v[154:155], v[154:155], v[12:13]
  v_pk_mul_f32 v[156:157], v[156:157], v[12:13]
  v_pk_mul_f32 v[158:159], v[158:159], v[12:13]
  v_cvt_pk_bf16_f32 v240, v144, v145
  v_cvt_pk_bf16_f32 v241, v146, v147
  v_cvt_pk_bf16_f32 v242, v148, v149
  v_cvt_pk_bf16_f32 v243, v150, v151
  v_cvt_pk_bf16_f32 v244, v152, v153
  v_cvt_pk_bf16_f32 v245, v154, v155
  v_cvt_pk_bf16_f32 v246, v156, v157
  v_cvt_pk_bf16_f32 v247, v158, v159
  s_mul_i32 s59, s70, 14336
  s_add_u32 s59, s59, s36
  buffer_store_dwordx4 v[240:243], v3, s[8:11], s59 offen offset:0 sc1
  buffer_store_dwordx4 v[244:247], v3, s[8:11], s59 offen offset:1024 sc1
  s_branch L_prep_done
L_prep_b:
  s_mul_i32 s59, s3, 3
  s_min_u32 s60, s3, 2
  s_add_u32 s59, s59, s60
  s_cmp_lt_u32 s3, 2
  s_cselect_b32 s73, 4, 3
  s_sub_u32 s56, s31, s73
  s_cmp_ge_u32 s31, s73
  s_cselect_b32 s60, s56, s31
  s_sub_u32 s56, s60, s73
  s_cmp_ge_u32 s60, s73
  s_cselect_b32 s60, s56, s60
  s_add_u32 s56, s60, 0
  s_sub_u32 s57, s56, s73
  s_cmp_ge_u32 s56, s73
  s_cselect_b32 s56, s57, s56
  s_add_u32 s56, s56, s59
  s_lshl_b32 s64, s56, 1
  s_add_u32 s65, s64, 1
  s_add_u32 s56, s60, 1
  s_sub_u32 s57, s56, s73
  s_cmp_ge_u32 s56, s73
  s_cselect_b32 s56, s57, s56
  s_add_u32 s56, s56, s59
  s_lshl_b32 s66, s56, 1
  s_add_u32 s67, s66, 1
  s_add_u32 s56, s60, 2
  s_sub_u32 s57, s56, s73
  s_cmp_ge_u32 s56, s73
  s_cselect_b32 s56, s57, s56
  s_add_u32 s56, s56, s59
  s_lshl_b32 s68, s56, 1
  s_add_u32 s69, s68, 1
  s_add_u32 s56, s60, 3
  s_sub_u32 s57, s56, s73
  s_cmp_ge_u32 s56, s73
  s_cselect_b32 s56, s57, s56
  s_add_u32 s56, s56, s59
  s_lshl_b32 s70, s56, 1
  s_add_u32 s71, s70, 1
  v_lshrrev_b32 v6, 2, v0
  v_mul_u32_u24 v6, 896, v6
  v_lshl_add_u32 v6, v7, 4, v6
  s_waitcnt lgkmcnt(0)
  s_mov_b32 s8, s40
  s_and_b32 s9, s41, 0xffff
  s_mov_b32 s10, 268435456
  s_mov_b32 s11, 0x20000
  s_mov_b32 s12, s42
  s_and_b32 s13, s43, 0xffff
  s_mov_b32 s14, 256
  s_mov_b32 s15, 0x20000
  s_or_b32 s19, s2, s3
  s_cmp_eq_u32 s19, 0
  s_cbranch_scc0 L_nonce_6
  s_memrealtime s[74:75]
  s_waitcnt lgkmcnt(0)
  s_lshl_b32 s74, s74, 4
  s_and_b32 s75, s7, 7
  s_or_b32 s74, s74, s75
  s_or_b32 s74, s74, 8
  v_mov_b32 v10, s74
  buffer_store_dword v10, v253, s[12:15], 0 offen offset:192 sc1
L_nonce_6:
  s_mov_b32 s20, s50
  s_and_b32 s21, s51, 0xffff
  s_mov_b32 s22, 3670016
  s_mov_b32 s23, 0x20000
  s_mov_b32 s24, s48
  s_and_b32 s25, s49, 0xffff
  s_mov_b32 s26, 3670016
  s_mov_b32 s27, 0x20000
  v_lshrrev_b32 v8, 2, v1
  v_lshlrev_b32 v8, 6, v8
  v_lshl_add_u32 v8, v7, 4, v8
  v_lshl_add_u32 v8, v2, 9, v8
  s_mul_i32 s56, s32, 229376
  s_lshl_b32 s57, s31, 7
  s_add_u32 s56, s56, s57
  s_lshr_b32 s57, s3, 1
  s_lshl_b32 s57, s57, 6
  s_add_u32 s56, s56, s57
  s_and_b32 s57, s3, 1
  s_mul_i32 s57, s57, 114688
  s_add_u32 s56, s56, s57
  s_mov_b32 s57, s58
  s_mov_b32 m0, s57
  s_add_u32 s57, s57, 1024
  buffer_load_dwordx4 v6, s[20:23], s56 offen lds
  s_add_u32 s56, s56, 14336
  s_mov_b32 m0, s57
  s_add_u32 s57, s57, 1024
  buffer_load_dwordx4 v6, s[20:23], s56 offen lds
  s_add_u32 s56, s56, 14336
  s_mov_b32 m0, s57
  s_add_u32 s57, s57, 1024
  buffer_load_dwordx4 v6, s[20:23], s56 offen lds
  s_add_u32 s56, s56, 14336
  s_mov_b32 m0, s57
  s_add_u32 s57, s57, 1024
  buffer_load_dwordx4 v6, s[20:23], s56 offen lds
  s_add_u32 s56, s56, 14336
  s_mov_b32 m0, s57
  s_add_u32 s57, s57, 1024
  buffer_load_dwordx4 v6, s[20:23], s56 offen lds
  s_add_u32 s56, s56, 14336
  s_mov_b32 m0, s57
  s_add_u32 s57, s57, 1024
  buffer_load_dwordx4 v6, s[20:23], s56 offen lds
  s_add_u32 s56, s56, 14336
  s_mov_b32 m0, s57
  s_add_u32 s57, s57, 1024
  buffer_load_dwordx4 v6, s[20:23], s56 offen lds
  s_add_u32 s56, s56, 14336
  s_mov_b32 m0, s57
  s_add_u32 s57, s57, 1024
  buffer_load_dwordx4 v6, s[20:23], s56 offen lds
  s_add_u32 s56, s56, 14336
  s_lshr_b32 s57, s64, 1
  s_lshl_b32 s57, s57, 18
  s_and_b32 s56, s64, 1
  s_lshl_b32 s56, s56, 15
  s_add_u32 s56, s56, s57
  s_add_u32 s63, s61, 0
  s_add_u32 s62, s63, 0
  s_mov_b32 m0, s62
  s_nop 0
  buffer_load_dwordx4 v208, s[24:27], s56 offen lds
  s_add_u32 s62, s63, 1024
  s_mov_b32 m0, s62
  s_nop 0
  buffer_load_dwordx4 v209, s[24:27], s56 offen lds
  s_add_u32 s62, s63, 2048
  s_mov_b32 m0, s62
  s_nop 0
  buffer_load_dwordx4 v210, s[24:27], s56 offen lds
  s_add_u32 s62, s63, 3072
  s_mov_b32 m0, s62
  s_nop 0
  buffer_load_dwordx4 v211, s[24:27], s56 offen lds
  s_add_u32 s62, s63, 4096
  s_mov_b32 m0, s62
  s_nop 0
  buffer_load_dwordx4 v212, s[24:27], s56 offen lds
  s_add_u32 s62, s63, 5120
  s_mov_b32 m0, s62
  s_nop 0
  buffer_load_dwordx4 v213, s[24:27], s56 offen lds
  s_add_u32 s62, s63, 6144
  s_mov_b32 m0, s62
  s_nop 0
  buffer_load_dwordx4 v214, s[24:27], s56 offen lds
  s_add_u32 s62, s63, 7168
  s_mov_b32 m0, s62
  s_nop 0
  buffer_load_dwordx4 v215, s[24:27], s56 offen lds
  s_cmp_eq_u32 s3, 0
  s_cbranch_scc0 L_rank_7
  s_mov_b64 exec, 1
  buffer_atomic_add v252, v253, s[12:15], s17 offen sc0 sc1
  s_mov_b64 exec, -1
L_rank_7:
  s_waitcnt vmcnt(8)
  s_barrier
  ds_read_b64_tr_b16 v[16:17], v8 offset:0
  ds_read_b64_tr_b16 v[18:19], v8 offset:256
  ds_read_b64_tr_b16 v[48:49], v8 offset:8
  ds_read_b64_tr_b16 v[50:51], v8 offset:264
  ds_read_b64_tr_b16 v[80:81], v8 offset:16384
  ds_read_b64_tr_b16 v[82:83], v8 offset:16640
  ds_read_b64_tr_b16 v[112:113], v8 offset:16392
  ds_read_b64_tr_b16 v[114:115], v8 offset:16648
  ds_read_b64_tr_b16 v[20:21], v8 offset:2048
  ds_read_b64_tr_b16 v[22:23], v8 offset:2304
  ds_read_b64_tr_b16 v[52:53], v8 offset:2056
  ds_read_b64_tr_b16 v[54:55], v8 offset:2312
  ds_read_b64_tr_b16 v[84:85], v8 offset:18432
  ds_read_b64_tr_b16 v[86:87], v8 offset:18688
  ds_read_b64_tr_b16 v[116:117], v8 offset:18440
  s_waitcnt lgkmcnt(14)
  ds_read_b64_tr_b16 v[118:119], v8 offset:18696
  s_waitcnt lgkmcnt(14)
  ds_read_b64_tr_b16 v[24:25], v8 offset:4096
  s_waitcnt lgkmcnt(14)
  ds_read_b64_tr_b16 v[26:27], v8 offset:4352
  s_waitcnt lgkmcnt(14)
  ds_read_b64_tr_b16 v[56:57], v8 offset:4104
  s_waitcnt lgkmcnt(14)
  ds_read_b64_tr_b16 v[58:59], v8 offset:4360
  s_waitcnt lgkmcnt(14)
  ds_read_b64_tr_b16 v[88:89], v8 offset:20480
  s_waitcnt lgkmcnt(14)
  ds_read_b64_tr_b16 v[90:91], v8 offset:20736
  s_waitcnt lgkmcnt(14)
  ds_read_b64_tr_b16 v[120:121], v8 offset:20488
  s_waitcnt lgkmcnt(14)
  ds_read_b64_tr_b16 v[122:123], v8 offset:20744
  s_waitcnt lgkmcnt(14)
  ds_read_b64_tr_b16 v[28:29], v8 offset:6144
  s_waitcnt lgkmcnt(14)
  ds_read_b64_tr_b16 v[30:31], v8 offset:6400
  s_waitcnt lgkmcnt(14)
  ds_read_b64_tr_b16 v[60:61], v8 offset:6152
  s_waitcnt lgkmcnt(14)
  ds_read_b64_tr_b16 v[62:63], v8 offset:6408
  s_waitcnt lgkmcnt(14)
  ds_read_b64_tr_b16 v[92:93], v8 offset:22528
  s_waitcnt lgkmcnt(14)
  ds_read_b64_tr_b16 v[94:95], v8 offset:22784
  s_waitcnt lgkmcnt(14)
  ds_read_b64_tr_b16 v[124:125], v8 offset:22536
  s_waitcnt lgkmcnt(14)
  ds_read_b64_tr_b16 v[126:127], v8 offset:22792
  s_waitcnt lgkmcnt(14)
  ds_read_b64_tr_b16 v[32:33], v8 offset:8192
  s_waitcnt lgkmcnt(14)
  ds_read_b64_tr_b16 v[34:35], v8 offset:8448
  s_waitcnt lgkmcnt(14)
  ds_read_b64_tr_b16 v[64:65], v8 offset:8200
  s_waitcnt lgkmcnt(14)
  ds_read_b64_tr_b16 v[66:67], v8 offset:8456
  s_waitcnt lgkmcnt(14)
  ds_read_b64_tr_b16 v[96:97], v8 offset:24576
  s_waitcnt lgkmcnt(14)
  ds_read_b64_tr_b16 v[98:99], v8 offset:24832
  s_waitcnt lgkmcnt(14)
  ds_read_b64_tr_b16 v[128:129], v8 offset:24584
  s_waitcnt lgkmcnt(14)
  ds_read_b64_tr_b16 v[130:131], v8 offset:24840
  s_waitcnt lgkmcnt(14)
  ds_read_b64_tr_b16 v[36:37], v8 offset:10240
  s_waitcnt lgkmcnt(14)
  ds_read_b64_tr_b16 v[38:39], v8 offset:10496
  s_waitcnt lgkmcnt(14)
  ds_read_b64_tr_b16 v[68:69], v8 offset:10248
  s_waitcnt lgkmcnt(14)
  ds_read_b64_tr_b16 v[70:71], v8 offset:10504
  s_waitcnt lgkmcnt(14)
  ds_read_b64_tr_b16 v[100:101], v8 offset:26624
  s_waitcnt lgkmcnt(14)
  ds_read_b64_tr_b16 v[102:103], v8 offset:26880
  s_waitcnt lgkmcnt(14)
  ds_read_b64_tr_b16 v[132:133], v8 offset:26632
  s_waitcnt lgkmcnt(14)
  ds_read_b64_tr_b16 v[134:135], v8 offset:26888
  s_waitcnt lgkmcnt(14)
  ds_read_b64_tr_b16 v[40:41], v8 offset:12288
  s_waitcnt lgkmcnt(14)
  ds_read_b64_tr_b16 v[42:43], v8 offset:12544
  s_waitcnt lgkmcnt(14)
  ds_read_b64_tr_b16 v[72:73], v8 offset:12296
  s_waitcnt lgkmcnt(14)
  ds_read_b64_tr_b16 v[74:75], v8 offset:12552
  s_waitcnt lgkmcnt(14)
  ds_read_b64_tr_b16 v[104:105], v8 offset:28672
  s_waitcnt lgkmcnt(14)
  ds_read_b64_tr_b16 v[106:107], v8 offset:28928
  s_waitcnt lgkmcnt(14)
  ds_read_b64_tr_b16 v[136:137], v8 offset:28680
  s_waitcnt lgkmcnt(14)
  ds_read_b64_tr_b16 v[138:139], v8 offset:28936
  s_waitcnt lgkmcnt(14)
  ds_read_b64_tr_b16 v[44:45], v8 offset:14336
  s_waitcnt lgkmcnt(14)
  ds_read_b64_tr_b16 v[46:47], v8 offset:14592
  s_waitcnt lgkmcnt(14)
  ds_read_b64_tr_b16 v[76:77], v8 offset:14344
  s_waitcnt lgkmcnt(14)
  ds_read_b64_tr_b16 v[78:79], v8 offset:14600
  s_waitcnt lgkmcnt(14)
  ds_read_b64_tr_b16 v[108:109], v8 offset:30720
  s_waitcnt lgkmcnt(14)
  ds_read_b64_tr_b16 v[110:111], v8 offset:30976
  s_waitcnt lgkmcnt(14)
  ds_read_b64_tr_b16 v[140:141], v8 offset:30728
  s_waitcnt lgkmcnt(14)
  ds_read_b64_tr_b16 v[142:143], v8 offset:30984
  s_mul_i32 s57, s31, 57344
  s_add_u32 s36, s36, s57
  s_waitcnt lgkmcnt(0)
  s_waitcnt vmcnt(0)
  ds_read_b128 a[0:3], v220 offset:0
  ds_read_b128 a[4:7], v221 offset:0
  ds_read_b128 a[8:11], v222 offset:0
  ds_read_b128 a[12:15], v223 offset:0
  ds_read_b128 a[16:19], v220 offset:256
  ds_read_b128 a[20:23], v221 offset:256
  ds_read_b128 a[24:27], v222 offset:256
  ds_read_b128 a[28:31], v223 offset:256
  s_lshr_b32 s57, s65, 1
  s_lshl_b32 s57, s57, 18
  s_and_b32 s56, s65, 1
  s_lshl_b32 s56, s56, 15
  s_add_u32 s56, s56, s57
  s_add_u32 s63, s61, 8192
  s_add_u32 s62, s63, 0
  s_mov_b32 m0, s62
  s_nop 0
  buffer_load_dwordx4 v208, s[24:27], s56 offen lds
  s_add_u32 s62, s63, 1024
  s_mov_b32 m0, s62
  s_nop 0
  buffer_load_dwordx4 v209, s[24:27], s56 offen lds
  s_add_u32 s62, s63, 2048
  s_mov_b32 m0, s62
  s_nop 0
  buffer_load_dwordx4 v210, s[24:27], s56 offen lds
  s_add_u32 s62, s63, 3072
  s_mov_b32 m0, s62
  s_nop 0
  buffer_load_dwordx4 v211, s[24:27], s56 offen lds
  s_add_u32 s62, s63, 4096
  s_mov_b32 m0, s62
  s_nop 0
  buffer_load_dwordx4 v212, s[24:27], s56 offen lds
  s_add_u32 s62, s63, 5120
  s_mov_b32 m0, s62
  s_nop 0
  buffer_load_dwordx4 v213, s[24:27], s56 offen lds
  s_add_u32 s62, s63, 6144
  s_mov_b32 m0, s62
  s_nop 0
  buffer_load_dwordx4 v214, s[24:27], s56 offen lds
  s_add_u32 s62, s63, 7168
  s_mov_b32 m0, s62
  s_nop 0
  buffer_load_dwordx4 v215, s[24:27], s56 offen lds
  s_waitcnt lgkmcnt(0)
  v_mfma_f32_16x16x32_bf16 v[144:147], a[0:3], v[16:19], 0
  s_lshr_b32 s57, s66, 1
  s_lshl_b32 s57, s57, 18
  s_and_b32 s56, s66, 1
  s_lshl_b32 s56, s56, 15
  s_add_u32 s56, s56, s57
  s_add_u32 s63, s61, 16384
  s_add_u32 s62, s63, 0
  s_mov_b32 m0, s62
  s_nop 0
  buffer_load_dwordx4 v208, s[24:27], s56 offen lds
  v_mfma_f32_16x16x32_bf16 v[148:151], a[0:3], v[48:51], 0
  v_mfma_f32_16x16x32_bf16 v[152:155], a[0:3], v[80:83], 0
  v_mfma_f32_16x16x32_bf16 v[156:159], a[0:3], v[112:115], 0
  s_add_u32 s62, s63, 1024
  s_mov_b32 m0, s62
  s_nop 0
  buffer_load_dwordx4 v209, s[24:27], s56 offen lds
  v_mfma_f32_16x16x32_bf16 v[144:147], a[4:7], v[20:23], v[144:147]
  v_mfma_f32_16x16x32_bf16 v[148:151], a[4:7], v[52:55], v[148:151]
  v_mfma_f32_16x16x32_bf16 v[152:155], a[4:7], v[84:87], v[152:155]
  s_add_u32 s62, s63, 2048
  s_mov_b32 m0, s62
  s_nop 0
  buffer_load_dwordx4 v210, s[24:27], s56 offen lds
  v_mfma_f32_16x16x32_bf16 v[156:159], a[4:7], v[116:119], v[156:159]
  v_mfma_f32_16x16x32_bf16 v[144:147], a[8:11], v[24:27], v[144:147]
  v_mfma_f32_16x16x32_bf16 v[148:151], a[8:11], v[56:59], v[148:151]
  s_add_u32 s62, s63, 3072
  s_mov_b32 m0, s62
  s_nop 0
  buffer_load_dwordx4 v211, s[24:27], s56 offen lds
  v_mfma_f32_16x16x32_bf16 v[152:155], a[8:11], v[88:91], v[152:155]
  v_mfma_f32_16x16x32_bf16 v[156:159], a[8:11], v[120:123], v[156:159]
  v_mfma_f32_16x16x32_bf16 v[144:147], a[12:15], v[28:31], v[144:147]
  s_add_u32 s62, s63, 4096
  s_mov_b32 m0, s62
  s_nop 0
  buffer_load_dwordx4 v212, s[24:27], s56 offen lds
  v_mfma_f32_16x16x32_bf16 v[148:151], a[12:15], v[60:63], v[148:151]
  v_mfma_f32_16x16x32_bf16 v[152:155], a[12:15], v[92:95], v[152:155]
  v_mfma_f32_16x16x32_bf16 v[156:159], a[12:15], v[124:127], v[156:159]
  s_add_u32 s62, s63, 5120
  s_mov_b32 m0, s62
  s_nop 0
  buffer_load_dwordx4 v213, s[24:27], s56 offen lds
  v_mfma_f32_16x16x32_bf16 v[144:147], a[16:19], v[32:35], v[144:147]
  v_mfma_f32_16x16x32_bf16 v[148:151], a[16:19], v[64:67], v[148:151]
  v_mfma_f32_16x16x32_bf16 v[152:155], a[16:19], v[96:99], v[152:155]
  s_add_u32 s62, s63, 6144
  s_mov_b32 m0, s62
  s_nop 0
  buffer_load_dwordx4 v214, s[24:27], s56 offen lds
  v_mfma_f32_16x16x32_bf16 v[156:159], a[16:19], v[128:131], v[156:159]
  v_mfma_f32_16x16x32_bf16 v[144:147], a[20:23], v[36:39], v[144:147]
  v_mfma_f32_16x16x32_bf16 v[148:151], a[20:23], v[68:71], v[148:151]
  s_add_u32 s62, s63, 7168
  s_mov_b32 m0, s62
  s_nop 0
  buffer_load_dwordx4 v215, s[24:27], s56 offen lds
  v_mfma_f32_16x16x32_bf16 v[152:155], a[20:23], v[100:103], v[152:155]
  v_mfma_f32_16x16x32_bf16 v[156:159], a[20:23], v[132:135], v[156:159]
  s_waitcnt vmcnt(8)
  ds_read_b128 a[32:35], v220 offset:8192
  v_mfma_f32_16x16x32_bf16 v[144:147], a[24:27], v[40:43], v[144:147]
  ds_read_b128 a[36:39], v221 offset:8192
  v_mfma_f32_16x16x32_bf16 v[148:151], a[24:27], v[72:75], v[148:151]
  ds_read_b128 a[40:43], v222 offset:8192
  v_mfma_f32_16x16x32_bf16 v[152:155], a[24:27], v[104:107], v[152:155]
  ds_read_b128 a[44:47], v223 offset:8192
  v_mfma_f32_16x16x32_bf16 v[156:159], a[24:27], v[136:139], v[156:159]
  ds_read_b128 a[48:51], v220 offset:8448
  v_mfma_f32_16x16x32_bf16 v[144:147], a[28:31], v[44:47], v[144:147]
  ds_read_b128 a[52:55], v221 offset:8448
  v_mfma_f32_16x16x32_bf16 v[148:151], a[28:31], v[76:79], v[148:151]
  ds_read_b128 a[56:59], v222 offset:8448
  v_mfma_f32_16x16x32_bf16 v[152:155], a[28:31], v[108:111], v[152:155]
  ds_read_b128 a[60:63], v223 offset:8448
  v_mfma_f32_16x16x32_bf16 v[156:159], a[28:31], v[140:143], v[156:159]
  s_waitcnt lgkmcnt(0)
  v_mfma_f32_16x16x32_bf16 v[160:163], a[32:35], v[16:19], 0
  s_lshr_b32 s57, s67, 1
  s_lshl_b32 s57, s57, 18
  s_and_b32 s56, s67, 1
  s_lshl_b32 s56, s56, 15
  s_add_u32 s56, s56, s57
  s_add_u32 s63, s61, 0
  s_add_u32 s62, s63, 0
  s_mov_b32 m0, s62
  s_nop 0
  buffer_load_dwordx4 v208, s[24:27], s56 offen lds
  v_mfma_f32_16x16x32_bf16 v[164:167], a[32:35], v[48:51], 0
  v_mfma_f32_16x16x32_bf16 v[168:171], a[32:35], v[80:83], 0
  v_mfma_f32_16x16x32_bf16 v[172:175], a[32:35], v[112:115], 0
  s_add_u32 s62, s63, 1024
  s_mov_b32 m0, s62
  s_nop 0
  buffer_load_dwordx4 v209, s[24:27], s56 offen lds
  v_mfma_f32_16x16x32_bf16 v[160:163], a[36:39], v[20:23], v[160:163]
  v_cvt_pk_bf16_f32 v176, v144, v145
  v_mfma_f32_16x16x32_bf16 v[164:167], a[36:39], v[52:55], v[164:167]
  v_cvt_pk_bf16_f32 v177, v146, v147
  v_mfma_f32_16x16x32_bf16 v[168:171], a[36:39], v[84:87], v[168:171]
  s_add_u32 s62, s63, 2048
  s_mov_b32 m0, s62
  s_nop 0
  buffer_load_dwordx4 v210, s[24:27], s56 offen lds
  v_mfma_f32_16x16x32_bf16 v[172:175], a[36:39], v[116:119], v[172:175]
  v_cvt_pk_bf16_f32 v180, v148, v149
  v_mfma_f32_16x16x32_bf16 v[160:163], a[40:43], v[24:27], v[160:163]
  v_cvt_pk_bf16_f32 v181, v150, v151
  v_mfma_f32_16x16x32_bf16 v[164:167], a[40:43], v[56:59], v[164:167]
  s_add_u32 s62, s63, 3072
  s_mov_b32 m0, s62
  s_nop 0
  buffer_load_dwordx4 v211, s[24:27], s56 offen lds
  v_mfma_f32_16x16x32_bf16 v[168:171], a[40:43], v[88:91], v[168:171]
  v_cvt_pk_bf16_f32 v184, v152, v153
  v_mfma_f32_16x16x32_bf16 v[172:175], a[40:43], v[120:123], v[172:175]
  v_cvt_pk_bf16_f32 v185, v154, v155
  v_mfma_f32_16x16x32_bf16 v[160:163], a[44:47], v[28:31], v[160:163]
  s_add_u32 s62, s63, 4096
  s_mov_b32 m0, s62
  s_nop 0
  buffer_load_dwordx4 v212, s[24:27], s56 offen lds
  v_mfma_f32_16x16x32_bf16 v[164:167], a[44:47], v[60:63], v[164:167]
  v_cvt_pk_bf16_f32 v188, v156, v157
  v_mfma_f32_16x16x32_bf16 v[168:171], a[44:47], v[92:95], v[168:171]
  v_cvt_pk_bf16_f32 v189, v158, v159
  v_mfma_f32_16x16x32_bf16 v[172:175], a[44:47], v[124:127], v[172:175]
  s_add_u32 s62, s63, 5120
  s_mov_b32 m0, s62
  s_nop 0
  buffer_load_dwordx4 v213, s[24:27], s56 offen lds
  v_mfma_f32_16x16x32_bf16 v[160:163], a[48:51], v[32:35], v[160:163]
  v_mfma_f32_16x16x32_bf16 v[164:167], a[48:51], v[64:67], v[164:167]
  v_mfma_f32_16x16x32_bf16 v[168:171], a[48:51], v[96:99], v[168:171]
  s_add_u32 s62, s63, 6144
  s_mov_b32 m0, s62
  s_nop 0
  buffer_load_dwordx4 v214, s[24:27], s56 offen lds
  v_mfma_f32_16x16x32_bf16 v[172:175], a[48:51], v[128:131], v[172:175]
  v_mfma_f32_16x16x32_bf16 v[160:163], a[52:55], v[36:39], v[160:163]
  v_mfma_f32_16x16x32_bf16 v[164:167], a[52:55], v[68:71], v[164:167]
  s_add_u32 s62, s63, 7168
  s_mov_b32 m0, s62
  s_nop 0
  buffer_load_dwordx4 v215, s[24:27], s56 offen lds
  v_mfma_f32_16x16x32_bf16 v[168:171], a[52:55], v[100:103], v[168:171]
  v_mfma_f32_16x16x32_bf16 v[172:175], a[52:55], v[132:135], v[172:175]
  s_waitcnt vmcnt(8)
  ds_read_b128 a[0:3], v220 offset:16384
  v_mfma_f32_16x16x32_bf16 v[160:163], a[56:59], v[40:43], v[160:163]
  ds_read_b128 a[4:7], v221 offset:16384
  v_mfma_f32_16x16x32_bf16 v[164:167], a[56:59], v[72:75], v[164:167]
  ds_read_b128 a[8:11], v222 offset:16384
  v_mfma_f32_16x16x32_bf16 v[168:171], a[56:59], v[104:107], v[168:171]
  ds_read_b128 a[12:15], v223 offset:16384
  v_mfma_f32_16x16x32_bf16 v[172:175], a[56:59], v[136:139], v[172:175]
  ds_read_b128 a[16:19], v220 offset:16640
  v_mfma_f32_16x16x32_bf16 v[160:163], a[60:63], v[44:47], v[160:163]
  ds_read_b128 a[20:23], v221 offset:16640
  v_mfma_f32_16x16x32_bf16 v[164:167], a[60:63], v[76:79], v[164:167]
  ds_read_b128 a[24:27], v222 offset:16640
  v_mfma_f32_16x16x32_bf16 v[168:171], a[60:63], v[108:111], v[168:171]
  ds_read_b128 a[28:31], v223 offset:16640
  v_mfma_f32_16x16x32_bf16 v[172:175], a[60:63], v[140:143], v[172:175]
  s_waitcnt lgkmcnt(0)
  v_mfma_f32_16x16x32_bf16 v[144:147], a[0:3], v[16:19], 0
  s_lshr_b32 s57, s68, 1
  s_lshl_b32 s57, s57, 18
  s_and_b32 s56, s68, 1
  s_lshl_b32 s56, s56, 15
  s_add_u32 s56, s56, s57
  s_add_u32 s63, s61, 8192
  s_add_u32 s62, s63, 0
  s_mov_b32 m0, s62
  s_nop 0
  buffer_load_dwordx4 v208, s[24:27], s56 offen lds
  v_mfma_f32_16x16x32_bf16 v[148:151], a[0:3], v[48:51], 0
  v_mfma_f32_16x16x32_bf16 v[152:155], a[0:3], v[80:83], 0
  v_mfma_f32_16x16x32_bf16 v[156:159], a[0:3], v[112:115], 0
  s_add_u32 s62, s63, 1024
  s_mov_b32 m0, s62
  s_nop 0
  buffer_load_dwordx4 v209, s[24:27], s56 offen lds
  v_mfma_f32_16x16x32_bf16 v[144:147], a[4:7], v[20:23], v[144:147]
  v_cvt_pk_bf16_f32 v178, v160, v161
  v_mfma_f32_16x16x32_bf16 v[148:151], a[4:7], v[52:55], v[148:151]
  v_cvt_pk_bf16_f32 v179, v162, v163
  v_mfma_f32_16x16x32_bf16 v[152:155], a[4:7], v[84:87], v[152:155]
  s_add_u32 s62, s63, 2048
  s_mov_b32 m0, s62
  s_nop 0
  buffer_load_dwordx4 v210, s[24:27], s56 offen lds
  v_mfma_f32_16x16x32_bf16 v[156:159], a[4:7], v[116:119], v[156:159]
  v_cvt_pk_bf16_f32 v182, v164, v165
  v_mfma_f32_16x16x32_bf16 v[144:147], a[8:11], v[24:27], v[144:147]
  v_cvt_pk_bf16_f32 v183, v166, v167
  v_mfma_f32_16x16x32_bf16 v[148:151], a[8:11], v[56:59], v[148:151]
  s_add_u32 s62, s63, 3072
  s_mov_b32 m0, s62
  s_nop 0
  buffer_load_dwordx4 v211, s[24:27], s56 offen lds
  v_mfma_f32_16x16x32_bf16 v[152:155], a[8:11], v[88:91], v[152:155]
  v_cvt_pk_bf16_f32 v186, v168, v169
  v_mfma_f32_16x16x32_bf16 v[156:159], a[8:11], v[120:123], v[156:159]
  v_cvt_pk_bf16_f32 v187, v170, v171
  v_mfma_f32_16x16x32_bf16 v[144:147], a[12:15], v[28:31], v[144:147]
  s_add_u32 s62, s63, 4096
  s_mov_b32 m0, s62
  s_nop 0
  buffer_load_dwordx4 v212, s[24:27], s56 offen lds
  v_mfma_f32_16x16x32_bf16 v[148:151], a[12:15], v[60:63], v[148:151]
  v_cvt_pk_bf16_f32 v190, v172, v173
  v_mfma_f32_16x16x32_bf16 v[152:155], a[12:15], v[92:95], v[152:155]
  v_cvt_pk_bf16_f32 v191, v174, v175
  v_mfma_f32_16x16x32_bf16 v[156:159], a[12:15], v[124:127], v[156:159]
  s_add_u32 s62, s63, 5120
  s_mov_b32 m0, s62
  s_nop 0
  buffer_load_dwordx4 v213, s[24:27], s56 offen lds
  v_mfma_f32_16x16x32_bf16 v[144:147], a[16:19], v[32:35], v[144:147]
  v_mfma_f32_16x16x32_bf16 v[148:151], a[16:19], v[64:67], v[148:151]
  v_mfma_f32_16x16x32_bf16 v[152:155], a[16:19], v[96:99], v[152:155]
  s_add_u32 s62, s63, 6144
  s_mov_b32 m0, s62
  s_nop 0
  buffer_load_dwordx4 v214, s[24:27], s56 offen lds
  v_mfma_f32_16x16x32_bf16 v[156:159], a[16:19], v[128:131], v[156:159]
  v_mfma_f32_16x16x32_bf16 v[144:147], a[20:23], v[36:39], v[144:147]
  v_mfma_f32_16x16x32_bf16 v[148:151], a[20:23], v[68:71], v[148:151]
  s_add_u32 s62, s63, 7168
  s_mov_b32 m0, s62
  s_nop 0
  buffer_load_dwordx4 v215, s[24:27], s56 offen lds
  v_mfma_f32_16x16x32_bf16 v[152:155], a[20:23], v[100:103], v[152:155]
  v_mfma_f32_16x16x32_bf16 v[156:159], a[20:23], v[132:135], v[156:159]
  s_waitcnt vmcnt(8)
  ds_read_b128 a[32:35], v220 offset:0
  v_mfma_f32_16x16x32_bf16 v[144:147], a[24:27], v[40:43], v[144:147]
  ds_read_b128 a[36:39], v221 offset:0
  v_mfma_f32_16x16x32_bf16 v[148:151], a[24:27], v[72:75], v[148:151]
  ds_read_b128 a[40:43], v222 offset:0
  v_mfma_f32_16x16x32_bf16 v[152:155], a[24:27], v[104:107], v[152:155]
  ds_read_b128 a[44:47], v223 offset:0
  v_mfma_f32_16x16x32_bf16 v[156:159], a[24:27], v[136:139], v[156:159]
  ds_read_b128 a[48:51], v220 offset:256
  v_mfma_f32_16x16x32_bf16 v[144:147], a[28:31], v[44:47], v[144:147]
  ds_read_b128 a[52:55], v221 offset:256
  v_mfma_f32_16x16x32_bf16 v[148:151], a[28:31], v[76:79], v[148:151]
  ds_read_b128 a[56:59], v222 offset:256
  v_mfma_f32_16x16x32_bf16 v[152:155], a[28:31], v[108:111], v[152:155]
  ds_read_b128 a[60:63], v223 offset:256
  v_mfma_f32_16x16x32_bf16 v[156:159], a[28:31], v[140:143], v[156:159]
  s_waitcnt lgkmcnt(0)
  v_mfma_f32_16x16x32_bf16 v[160:163], a[32:35], v[16:19], 0
  s_lshr_b32 s57, s69, 1
  s_lshl_b32 s57, s57, 18
  s_and_b32 s56, s69, 1
  s_lshl_b32 s56, s56, 15
  s_add_u32 s56, s56, s57
  s_add_u32 s63, s61, 16384
  s_add_u32 s62, s63, 0
  s_mov_b32 m0, s62
  s_nop 0
  buffer_load_dwordx4 v208, s[24:27], s56 offen lds
  v_mfma_f32_16x16x32_bf16 v[164:167], a[32:35], v[48:51], 0
  v_mfma_f32_16x16x32_bf16 v[168:171], a[32:35], v[80:83], 0
  v_mfma_f32_16x16x32_bf16 v[172:175], a[32:35], v[112:115], 0
  s_add_u32 s62, s63, 1024
  s_mov_b32 m0, s62
  s_nop 0
  buffer_load_dwordx4 v209, s[24:27], s56 offen lds
  v_mfma_f32_16x16x32_bf16 v[160:163], a[36:39], v[20:23], v[160:163]
  v_cvt_pk_bf16_f32 v192, v144, v145
  v_mfma_f32_16x16x32_bf16 v[164:167], a[36:39], v[52:55], v[164:167]
  v_cvt_pk_bf16_f32 v193, v146, v147
  v_mfma_f32_16x16x32_bf16 v[168:171], a[36:39], v[84:87], v[168:171]
  s_add_u32 s62, s63, 2048
  s_mov_b32 m0, s62
  s_nop 0
  buffer_load_dwordx4 v210, s[24:27], s56 offen lds
  v_mfma_f32_16x16x32_bf16 v[172:175], a[36:39], v[116:119], v[172:175]
  v_cvt_pk_bf16_f32 v196, v148, v149
  v_mfma_f32_16x16x32_bf16 v[160:163], a[40:43], v[24:27], v[160:163]
  v_cvt_pk_bf16_f32 v197, v150, v151
  v_mfma_f32_16x16x32_bf16 v[164:167], a[40:43], v[56:59], v[164:167]
  s_add_u32 s62, s63, 3072
  s_mov_b32 m0, s62
  s_nop 0
  buffer_load_dwordx4 v211, s[24:27], s56 offen lds
  v_mfma_f32_16x16x32_bf16 v[168:171], a[40:43], v[88:91], v[168:171]
  v_cvt_pk_bf16_f32 v200, v152, v153
  v_mfma_f32_16x16x32_bf16 v[172:175], a[40:43], v[120:123], v[172:175]
  v_cvt_pk_bf16_f32 v201, v154, v155
  v_mfma_f32_16x16x32_bf16 v[160:163], a[44:47], v[28:31], v[160:163]
  s_add_u32 s62, s63, 4096
  s_mov_b32 m0, s62
  s_nop 0
  buffer_load_dwordx4 v212, s[24:27], s56 offen lds
  v_mfma_f32_16x16x32_bf16 v[164:167], a[44:47], v[60:63], v[164:167]
  v_cvt_pk_bf16_f32 v204, v156, v157
  v_mfma_f32_16x16x32_bf16 v[168:171], a[44:47], v[92:95], v[168:171]
  v_cvt_pk_bf16_f32 v205, v158, v159
  v_mfma_f32_16x16x32_bf16 v[172:175], a[44:47], v[124:127], v[172:175]
  s_add_u32 s62, s63, 5120
  s_mov_b32 m0, s62
  s_nop 0
  buffer_load_dwordx4 v213, s[24:27], s56 offen lds
  v_mfma_f32_16x16x32_bf16 v[160:163], a[48:51], v[32:35], v[160:163]
  v_mfma_f32_16x16x32_bf16 v[164:167], a[48:51], v[64:67], v[164:167]
  v_mfma_f32_16x16x32_bf16 v[168:171], a[48:51], v[96:99], v[168:171]
  s_add_u32 s62, s63, 6144
  s_mov_b32 m0, s62
  s_nop 0
  buffer_load_dwordx4 v214, s[24:27], s56 offen lds
  v_mfma_f32_16x16x32_bf16 v[172:175], a[48:51], v[128:131], v[172:175]
  v_mfma_f32_16x16x32_bf16 v[160:163], a[52:55], v[36:39], v[160:163]
  v_mfma_f32_16x16x32_bf16 v[164:167], a[52:55], v[68:71], v[164:167]
  s_add_u32 s62, s63, 7168
  s_mov_b32 m0, s62
  s_nop 0
  buffer_load_dwordx4 v215, s[24:27], s56 offen lds
  v_mfma_f32_16x16x32_bf16 v[168:171], a[52:55], v[100:103], v[168:171]
  v_mfma_f32_16x16x32_bf16 v[172:175], a[52:55], v[132:135], v[172:175]
  s_waitcnt vmcnt(8)
  ds_read_b128 a[0:3], v220 offset:8192
  v_mfma_f32_16x16x32_bf16 v[160:163], a[56:59], v[40:43], v[160:163]
  ds_read_b128 a[4:7], v221 offset:8192
  v_mfma_f32_16x16x32_bf16 v[164:167], a[56:59], v[72:75], v[164:167]
  ds_read_b128 a[8:11], v222 offset:8192
  v_mfma_f32_16x16x32_bf16 v[168:171], a[56:59], v[104:107], v[168:171]
  ds_read_b128 a[12:15], v223 offset:8192
  v_mfma_f32_16x16x32_bf16 v[172:175], a[56:59], v[136:139], v[172:175]
  ds_read_b128 a[16:19], v220 offset:8448
  v_mfma_f32_16x16x32_bf16 v[160:163], a[60:63], v[44:47], v[160:163]
  ds_read_b128 a[20:23], v221 offset:8448
  v_mfma_f32_16x16x32_bf16 v[164:167], a[60:63], v[76:79], v[164:167]
  ds_read_b128 a[24:27], v222 offset:8448
  v_mfma_f32_16x16x32_bf16 v[168:171], a[60:63], v[108:111], v[168:171]
  ds_read_b128 a[28:31], v223 offset:8448
  v_mfma_f32_16x16x32_bf16 v[172:175], a[60:63], v[140:143], v[172:175]
  s_waitcnt lgkmcnt(0)
  v_mfma_f32_16x16x32_bf16 v[144:147], a[0:3], v[16:19], 0
  s_lshr_b32 s57, s70, 1
  s_lshl_b32 s57, s57, 18
  s_and_b32 s56, s70, 1
  s_lshl_b32 s56, s56, 15
  s_add_u32 s56, s56, s57
  s_add_u32 s63, s61, 0
  s_add_u32 s62, s63, 0
  s_mov_b32 m0, s62
  s_nop 0
  buffer_load_dwordx4 v208, s[24:27], s56 offen lds
  v_mfma_f32_16x16x32_bf16 v[148:151], a[0:3], v[48:51], 0
  v_mfma_f32_16x16x32_bf16 v[152:155], a[0:3], v[80:83], 0
  s_lshl_b32 s59, s3, 10
  v_add_u32 v9, s59, v3
  v_mov_b32 v248, -1
  v_mov_b32 v249, -1
  v_mov_b32 v250, -1
  v_mov_b32 v251, -1
  s_add_u32 s59, s28, 0
  s_cmp_ge_u32 s59, 410
  s_cbranch_scc1 L_pz_9
  s_mov_b32 s73, 45883392
  s_cmp_ge_u32 s59, 126
  s_cselect_b32 s73, 45891584, s73
  s_lshl_b32 s59, s59, 12
  s_add_u32 s59, s59, s73
  buffer_store_dwordx4 v[248:251], v9, s[8:11], s59 offen sc1
L_pz_9:
  s_add_u32 s59, s28, 224
  s_cmp_ge_u32 s59, 410
  s_cbranch_scc1 L_pz_10
  s_mov_b32 s73, 45891584
  s_lshl_b32 s59, s59, 12
  s_add_u32 s59, s59, s73
  buffer_store_dwordx4 v[248:251], v9, s[8:11], s59 offen sc1
L_pz_10:
  v_mfma_f32_16x16x32_bf16 v[156:159], a[0:3], v[112:115], 0
  s_add_u32 s62, s63, 1024
  s_mov_b32 m0, s62
  s_nop 0
  buffer_load_dwordx4 v209, s[24:27], s56 offen lds
  v_mfma_f32_16x16x32_bf16 v[144:147], a[4:7], v[20:23], v[144:147]
  v_cvt_pk_bf16_f32 v194, v160, v161
  v_mfma_f32_16x16x32_bf16 v[148:151], a[4:7], v[52:55], v[148:151]
  v_cvt_pk_bf16_f32 v195, v162, v163
  v_mfma_f32_16x16x32_bf16 v[152:155], a[4:7], v[84:87], v[152:155]
  s_add_u32 s62, s63, 2048
  s_mov_b32 m0, s62
  s_nop 0
  buffer_load_dwordx4 v210, s[24:27], s56 offen lds
  v_mfma_f32_16x16x32_bf16 v[156:159], a[4:7], v[116:119], v[156:159]
  v_cvt_pk_bf16_f32 v198, v164, v165
  v_mfma_f32_16x16x32_bf16 v[144:147], a[8:11], v[24:27], v[144:147]
  v_cvt_pk_bf16_f32 v199, v166, v167
  v_mfma_f32_16x16x32_bf16 v[148:151], a[8:11], v[56:59], v[148:151]
  s_add_u32 s62, s63, 3072
  s_mov_b32 m0, s62
  s_nop 0
  buffer_load_dwordx4 v211, s[24:27], s56 offen lds
  v_mfma_f32_16x16x32_bf16 v[152:155], a[8:11], v[88:91], v[152:155]
  v_cvt_pk_bf16_f32 v202, v168, v169
  v_mfma_f32_16x16x32_bf16 v[156:159], a[8:11], v[120:123], v[156:159]
  v_cvt_pk_bf16_f32 v203, v170, v171
  v_mfma_f32_16x16x32_bf16 v[144:147], a[12:15], v[28:31], v[144:147]
  s_add_u32 s62, s63, 4096
  s_mov_b32 m0, s62
  s_nop 0
  buffer_load_dwordx4 v212, s[24:27], s56 offen lds
  s_lshl_b32 s59, s64, 9
  s_add_u32 s59, s59, s36
  buffer_store_dwordx4 v[176:179], v3, s[8:11], s59 offen sc1
  s_add_u32 s59, s59, 14336
  buffer_store_dwordx4 v[180:183], v3, s[8:11], s59 offen sc1
  s_add_u32 s59, s59, 14336
  buffer_store_dwordx4 v[184:187], v3, s[8:11], s59 offen sc1
  s_add_u32 s59, s59, 14336
  buffer_store_dwordx4 v[188:191], v3, s[8:11], s59 offen sc1
  s_add_u32 s59, s59, 14336
  v_mfma_f32_16x16x32_bf16 v[148:151], a[12:15], v[60:63], v[148:151]
  v_cvt_pk_bf16_f32 v206, v172, v173
  v_mfma_f32_16x16x32_bf16 v[152:155], a[12:15], v[92:95], v[152:155]
  v_cvt_pk_bf16_f32 v207, v174, v175
  v_mfma_f32_16x16x32_bf16 v[156:159], a[12:15], v[124:127], v[156:159]
  s_add_u32 s62, s63, 5120
  s_mov_b32 m0, s62
  s_nop 0
  buffer_load_dwordx4 v213, s[24:27], s56 offen lds
  v_mfma_f32_16x16x32_bf16 v[144:147], a[16:19], v[32:35], v[144:147]
  v_mfma_f32_16x16x32_bf16 v[148:151], a[16:19], v[64:67], v[148:151]
  v_mfma_f32_16x16x32_bf16 v[152:155], a[16:19], v[96:99], v[152:155]
  s_add_u32 s62, s63, 6144
  s_mov_b32 m0, s62
  s_nop 0
  buffer_load_dwordx4 v214, s[24:27], s56 offen lds
  v_mfma_f32_16x16x32_bf16 v[156:159], a[16:19], v[128:131], v[156:159]
  v_mfma_f32_16x16x32_bf16 v[144:147], a[20:23], v[36:39], v[144:147]
  v_mfma_f32_16x16x32_bf16 v[148:151], a[20:23], v[68:71], v[148:151]
  s_add_u32 s62, s63, 7168
  s_mov_b32 m0, s62
  s_nop 0
  buffer_load_dwordx4 v215, s[24:27], s56 offen lds
  v_mfma_f32_16x16x32_bf16 v[152:155], a[20:23], v[100:103], v[152:155]
  v_mfma_f32_16x16x32_bf16 v[156:159], a[20:23], v[132:135], v[156:159]
  s_waitcnt vmcnt(12)
  ds_read_b128 a[32:35], v220 offset:16384
  v_mfma_f32_16x16x32_bf16 v[144:147], a[24:27], v[40:43], v[144:147]
  ds_read_b128 a[36:39], v221 offset:16384
  v_mfma_f32_16x16x32_bf16 v[148:151], a[24:27], v[72:75], v[148:151]
  ds_read_b128 a[40:43], v222 offset:16384
  v_mfma_f32_16x16x32_bf16 v[152:155], a[24:27], v[104:107], v[152:155]
  ds_read_b128 a[44:47], v223 offset:16384
  v_mfma_f32_16x16x32_bf16 v[156:159], a[24:27], v[136:139], v[156:159]
  ds_read_b128 a[48:51], v220 offset:16640
  v_mfma_f32_16x16x32_bf16 v[144:147], a[28:31], v[44:47], v[144:147]
  ds_read_b128 a[52:55], v221 offset:16640
  v_mfma_f32_16x16x32_bf16 v[148:151], a[28:31], v[76:79], v[148:151]
  ds_read_b128 a[56:59], v222 offset:16640
  v_mfma_f32_16x16x32_bf16 v[152:155], a[28:31], v[108:111], v[152:155]
  ds_read_b128 a[60:63], v223 offset:16640
  v_mfma_f32_16x16x32_bf16 v[156:159], a[28:31], v[140:143], v[156:159]
  s_lshl_b32 s59, s66, 9
  s_add_u32 s59, s59, s36
  buffer_store_dwordx4 v[192:195], v3, s[8:11], s59 offen sc1
  s_add_u32 s59, s59, 14336
  buffer_store_dwordx4 v[196:199], v3, s[8:11], s59 offen sc1
  s_add_u32 s59, s59, 14336
  buffer_store_dwordx4 v[200:203], v3, s[8:11], s59 offen sc1
  s_add_u32 s59, s59, 14336
  buffer_store_dwordx4 v[204:207], v3, s[8:11], s59 offen sc1
  s_add_u32 s59, s59, 14336
  s_waitcnt lgkmcnt(0)
  v_mfma_f32_16x16x32_bf16 v[160:163], a[32:35], v[16:19], 0
  s_lshr_b32 s57, s71, 1
  s_lshl_b32 s57, s57, 18
  s_and_b32 s56, s71, 1
  s_lshl_b32 s56, s56, 15
  s_add_u32 s56, s56, s57
  s_add_u32 s63, s61, 8192
  s_add_u32 s62, s63, 0
  s_mov_b32 m0, s62
  s_nop 0
  buffer_load_dwordx4 v208, s[24:27], s56 offen lds
  v_mfma_f32_16x16x32_bf16 v[164:167], a[32:35], v[48:51], 0
  v_mfma_f32_16x16x32_bf16 v[168:171], a[32:35], v[80:83], 0
  v_mfma_f32_16x16x32_bf16 v[172:175], a[32:35], v[112:115], 0
  s_add_u32 s62, s63, 1024
  s_mov_b32 m0, s62
  s_nop 0
  buffer_load_dwordx4 v209, s[24:27], s56 offen lds
  v_mfma_f32_16x16x32_bf16 v[160:163], a[36:39], v[20:23], v[160:163]
  v_cvt_pk_bf16_f32 v224, v144, v145
  v_mfma_f32_16x16x32_bf16 v[164:167], a[36:39], v[52:55], v[164:167]
  v_cvt_pk_bf16_f32 v225, v146, v147
  v_mfma_f32_16x16x32_bf16 v[168:171], a[36:39], v[84:87], v[168:171]
  s_add_u32 s62, s63, 2048
  s_mov_b32 m0, s62
  s_nop 0
  buffer_load_dwordx4 v210, s[24:27], s56 offen lds
  v_mfma_f32_16x16x32_bf16 v[172:175], a[36:39], v[116:119], v[172:175]
  v_cvt_pk_bf16_f32 v228, v148, v149
  v_mfma_f32_16x16x32_bf16 v[160:163], a[40:43], v[24:27], v[160:163]
  v_cvt_pk_bf16_f32 v229, v150, v151
  v_mfma_f32_16x16x32_bf16 v[164:167], a[40:43], v[56:59], v[164:167]
  s_add_u32 s62, s63, 3072
  s_mov_b32 m0, s62
  s_nop 0
  buffer_load_dwordx4 v211, s[24:27], s56 offen lds
  v_mfma_f32_16x16x32_bf16 v[168:171], a[40:43], v[88:91], v[168:171]
  v_cvt_pk_bf16_f32 v232, v152, v153
  v_mfma_f32_16x16x32_bf16 v[172:175], a[40:43], v[120:123], v[172:175]
  v_cvt_pk_bf16_f32 v233, v154, v155
  v_mfma_f32_16x16x32_bf16 v[160:163], a[44:47], v[28:31], v[160:163]
  s_add_u32 s62, s63, 4096
  s_mov_b32 m0, s62
  s_nop 0
  buffer_load_dwordx4 v212, s[24:27], s56 offen lds
  v_mfma_f32_16x16x32_bf16 v[164:167], a[44:47], v[60:63], v[164:167]
  v_cvt_pk_bf16_f32 v236, v156, v157
  v_mfma_f32_16x16x32_bf16 v[168:171], a[44:47], v[92:95], v[168:171]
  v_cvt_pk_bf16_f32 v237, v158, v159
  v_mfma_f32_16x16x32_bf16 v[172:175], a[44:47], v[124:127], v[172:175]
  s_add_u32 s62, s63, 5120
  s_mov_b32 m0, s62
  s_nop 0
  buffer_load_dwordx4 v213, s[24:27], s56 offen lds
  v_mfma_f32_16x16x32_bf16 v[160:163], a[48:51], v[32:35], v[160:163]
  v_mfma_f32_16x16x32_bf16 v[164:167], a[48:51], v[64:67], v[164:167]
  v_mfma_f32_16x16x32_bf16 v[168:171], a[48:51], v[96:99], v[168:171]
  s_add_u32 s62, s63, 6144
  s_mov_b32 m0, s62
  s_nop 0
  buffer_load_dwordx4 v214, s[24:27], s56 offen lds
  v_mfma_f32_16x16x32_bf16 v[172:175], a[48:51], v[128:131], v[172:175]
  v_mfma_f32_16x16x32_bf16 v[160:163], a[52:55], v[36:39], v[160:163]
  v_mfma_f32_16x16x32_bf16 v[164:167], a[52:55], v[68:71], v[164:167]
  s_add_u32 s62, s63, 7168
  s_mov_b32 m0, s62
  s_nop 0
  buffer_load_dwordx4 v215, s[24:27], s56 offen lds
  v_mfma_f32_16x16x32_bf16 v[168:171], a[52:55], v[100:103], v[168:171]
  v_mfma_f32_16x16x32_bf16 v[172:175], a[52:55], v[132:135], v[172:175]
  s_waitcnt vmcnt(12)
  ds_read_b128 a[0:3], v220 offset:0
  v_mfma_f32_16x16x32_bf16 v[160:163], a[56:59], v[40:43], v[160:163]
  ds_read_b128 a[4:7], v221 offset:0
  v_mfma_f32_16x16x32_bf16 v[164:167], a[56:59], v[72:75], v[164:167]
  ds_read_b128 a[8:11], v222 offset:0
  v_mfma_f32_16x16x32_bf16 v[168:171], a[56:59], v[104:107], v[168:171]
  ds_read_b128 a[12:15], v223 offset:0
  v_mfma_f32_16x16x32_bf16 v[172:175], a[56:59], v[136:139], v[172:175]
  ds_read_b128 a[16:19], v220 offset:256
  v_mfma_f32_16x16x32_bf16 v[160:163], a[60:63], v[44:47], v[160:163]
  ds_read_b128 a[20:23], v221 offset:256
  v_mfma_f32_16x16x32_bf16 v[164:167], a[60:63], v[76:79], v[164:167]
  ds_read_b128 a[24:27], v222 offset:256
  v_mfma_f32_16x16x32_bf16 v[168:171], a[60:63], v[108:111], v[168:171]
  ds_read_b128 a[28:31], v223 offset:256
  v_mfma_f32_16x16x32_bf16 v[172:175], a[60:63], v[140:143], v[172:175]
  s_cmp_ge_u32 s3, 2
  s_cbranch_scc1 L_short_8
  s_waitcnt lgkmcnt(0)
  v_mfma_f32_16x16x32_bf16 v[144:147], a[0:3], v[16:19], 0
  v_mfma_f32_16x16x32_bf16 v[148:151], a[0:3], v[48:51], 0
  v_mfma_f32_16x16x32_bf16 v[152:155], a[0:3], v[80:83], 0
  v_mfma_f32_16x16x32_bf16 v[156:159], a[0:3], v[112:115], 0
  v_mfma_f32_16x16x32_bf16 v[144:147], a[4:7], v[20:23], v[144:147]
  v_cvt_pk_bf16_f32 v226, v160, v161
  v_mfma_f32_16x16x32_bf16 v[148:151], a[4:7], v[52:55], v[148:151]
  v_cvt_pk_bf16_f32 v227, v162, v163
  v_mfma_f32_16x16x32_bf16 v[152:155], a[4:7], v[84:87], v[152:155]
  v_cvt_pk_bf16_f32 v230, v164, v165
  v_mfma_f32_16x16x32_bf16 v[156:159], a[4:7], v[116:119], v[156:159]
  v_cvt_pk_bf16_f32 v231, v166, v167
  v_mfma_f32_16x16x32_bf16 v[144:147], a[8:11], v[24:27], v[144:147]
  v_cvt_pk_bf16_f32 v234, v168, v169
  v_mfma_f32_16x16x32_bf16 v[148:151], a[8:11], v[56:59], v[148:151]
  v_cvt_pk_bf16_f32 v235, v170, v171
  v_mfma_f32_16x16x32_bf16 v[152:155], a[8:11], v[88:91], v[152:155]
  v_cvt_pk_bf16_f32 v238, v172, v173
  v_mfma_f32_16x16x32_bf16 v[156:159], a[8:11], v[120:123], v[156:159]
  v_cvt_pk_bf16_f32 v239, v174, v175
  v_mfma_f32_16x16x32_bf16 v[144:147], a[12:15], v[28:31], v[144:147]
  v_mfma_f32_16x16x32_bf16 v[148:151], a[12:15], v[60:63], v[148:151]
  v_mfma_f32_16x16x32_bf16 v[152:155], a[12:15], v[92:95], v[152:155]
  v_mfma_f32_16x16x32_bf16 v[156:159], a[12:15], v[124:127], v[156:159]
  v_mfma_f32_16x16x32_bf16 v[144:147], a[16:19], v[32:35], v[144:147]
  v_mfma_f32_16x16x32_bf16 v[148:151], a[16:19], v[64:67], v[148:151]
  v_mfma_f32_16x16x32_bf16 v[152:155], a[16:19], v[96:99], v[152:155]
  v_mfma_f32_16x16x32_bf16 v[156:159], a[16:19], v[128:131], v[156:159]
  v_mfma_f32_16x16x32_bf16 v[144:147], a[20:23], v[36:39], v[144:147]
  v_mfma_f32_16x16x32_bf16 v[148:151], a[20:23], v[68:71], v[148:151]
  v_mfma_f32_16x16x32_bf16 v[152:155], a[20:23], v[100:103], v[152:155]
  v_mfma_f32_16x16x32_bf16 v[156:159], a[20:23], v[132:135], v[156:159]
  s_waitcnt vmcnt(0)
  ds_read_b128 a[32:35], v220 offset:8192
  v_mfma_f32_16x16x32_bf16 v[144:147], a[24:27], v[40:43], v[144:147]
  ds_read_b128 a[36:39], v221 offset:8192
  v_mfma_f32_16x16x32_bf16 v[148:151], a[24:27], v[72:75], v[148:151]
  ds_read_b128 a[40:43], v222 offset:8192
  v_mfma_f32_16x16x32_bf16 v[152:155], a[24:27], v[104:107], v[152:155]
  ds_read_b128 a[44:47], v223 offset:8192
  v_mfma_f32_16x16x32_bf16 v[156:159], a[24:27], v[136:139], v[156:159]
  ds_read_b128 a[48:51], v220 offset:8448
  v_mfma_f32_16x16x32_bf16 v[144:147], a[28:31], v[44:47], v[144:147]
  ds_read_b128 a[52:55], v221 offset:8448
  v_mfma_f32_16x16x32_bf16 v[148:151], a[28:31], v[76:79], v[148:151]
  ds_read_b128 a[56:59], v222 offset:8448
  v_mfma_f32_16x16x32_bf16 v[152:155], a[28:31], v[108:111], v[152:155]
  ds_read_b128 a[60:63], v223 offset:8448
  v_mfma_f32_16x16x32_bf16 v[156:159], a[28:31], v[140:143], v[156:159]
  s_lshl_b32 s59, s68, 9
  s_add_u32 s59, s59, s36
  buffer_store_dwordx4 v[224:227], v3, s[8:11], s59 offen sc1
  s_add_u32 s59, s59, 14336
  buffer_store_dwordx4 v[228:231], v3, s[8:11], s59 offen sc1
  s_add_u32 s59, s59, 14336
  buffer_store_dwordx4 v[232:235], v3, s[8:11], s59 offen sc1
  s_add_u32 s59, s59, 14336
  buffer_store_dwordx4 v[236:239], v3, s[8:11], s59 offen sc1
  s_add_u32 s59, s59, 14336
  s_waitcnt lgkmcnt(0)
  v_mfma_f32_16x16x32_bf16 v[160:163], a[32:35], v[16:19], 0
  v_mfma_f32_16x16x32_bf16 v[164:167], a[32:35], v[48:51], 0
  v_mfma_f32_16x16x32_bf16 v[168:171], a[32:35], v[80:83], 0
  v_mfma_f32_16x16x32_bf16 v[172:175], a[32:35], v[112:115], 0
  v_mfma_f32_16x16x32_bf16 v[160:163], a[36:39], v[20:23], v[160:163]
  v_cvt_pk_bf16_f32 v240, v144, v145
  v_mfma_f32_16x16x32_bf16 v[164:167], a[36:39], v[52:55], v[164:167]
  v_cvt_pk_bf16_f32 v241, v146, v147
  v_mfma_f32_16x16x32_bf16 v[168:171], a[36:39], v[84:87], v[168:171]
  v_cvt_pk_bf16_f32 v244, v148, v149
  v_mfma_f32_16x16x32_bf16 v[172:175], a[36:39], v[116:119], v[172:175]
  v_cvt_pk_bf16_f32 v245, v150, v151
  v_mfma_f32_16x16x32_bf16 v[160:163], a[40:43], v[24:27], v[160:163]
  v_cvt_pk_bf16_f32 v4, v152, v153
  v_mfma_f32_16x16x32_bf16 v[164:167], a[40:43], v[56:59], v[164:167]
  v_cvt_pk_bf16_f32 v5, v154, v155
  v_mfma_f32_16x16x32_bf16 v[168:171], a[40:43], v[88:91], v[168:171]
  v_cvt_pk_bf16_f32 v8, v156, v157
  v_mfma_f32_16x16x32_bf16 v[172:175], a[40:43], v[120:123], v[172:175]
  v_cvt_pk_bf16_f32 v9, v158, v159
  v_mfma_f32_16x16x32_bf16 v[160:163], a[44:47], v[28:31], v[160:163]
  v_mfma_f32_16x16x32_bf16 v[164:167], a[44:47], v[60:63], v[164:167]
  v_mfma_f32_16x16x32_bf16 v[168:171], a[44:47], v[92:95], v[168:171]
  v_mfma_f32_16x16x32_bf16 v[172:175], a[44:47], v[124:127], v[172:175]
  v_mfma_f32_16x16x32_bf16 v[160:163], a[48:51], v[32:35], v[160:163]
  v_mfma_f32_16x16x32_bf16 v[164:167], a[48:51], v[64:67], v[164:167]
  v_mfma_f32_16x16x32_bf16 v[168:171], a[48:51], v[96:99], v[168:171]
  v_mfma_f32_16x16x32_bf16 v[172:175], a[48:51], v[128:131], v[172:175]
  v_mfma_f32_16x16x32_bf16 v[160:163], a[52:55], v[36:39], v[160:163]
  v_mfma_f32_16x16x32_bf16 v[164:167], a[52:55], v[68:71], v[164:167]
  v_mfma_f32_16x16x32_bf16 v[168:171], a[52:55], v[100:103], v[168:171]
  v_mfma_f32_16x16x32_bf16 v[172:175], a[52:55], v[132:135], v[172:175]
  v_mfma_f32_16x16x32_bf16 v[160:163], a[56:59], v[40:43], v[160:163]
  v_mfma_f32_16x16x32_bf16 v[164:167], a[56:59], v[72:75], v[164:167]
  v_mfma_f32_16x16x32_bf16 v[168:171], a[56:59], v[104:107], v[168:171]
  v_mfma_f32_16x16x32_bf16 v[172:175], a[56:59], v[136:139], v[172:175]
  v_mfma_f32_16x16x32_bf16 v[160:163], a[60:63], v[44:47], v[160:163]
  v_mfma_f32_16x16x32_bf16 v[164:167], a[60:63], v[76:79], v[164:167]
  v_mfma_f32_16x16x32_bf16 v[168:171], a[60:63], v[108:111], v[168:171]
  v_mfma_f32_16x16x32_bf16 v[172:175], a[60:63], v[140:143], v[172:175]
  s_nop 4
  v_cvt_pk_bf16_f32 v242, v160, v161
  v_cvt_pk_bf16_f32 v243, v162, v163
  v_cvt_pk_bf16_f32 v246, v164, v165
  v_cvt_pk_bf16_f32 v247, v166, v167
  v_cvt_pk_bf16_f32 v6, v168, v169
  v_cvt_pk_bf16_f32 v7, v170, v171
  v_cvt_pk_bf16_f32 v10, v172, v173
  v_cvt_pk_bf16_f32 v11, v174, v175
  s_lshl_b32 s59, s70, 9
  s_add_u32 s59, s59, s36
  buffer_store_dwordx4 v[240:243], v3, s[8:11], s59 offen sc1
  s_add_u32 s59, s59, 14336
  buffer_store_dwordx4 v[244:247], v3, s[8:11], s59 offen sc1
  s_add_u32 s59, s59, 14336
  buffer_store_dwordx4 v[4:7], v3, s[8:11], s59 offen sc1
  s_add_u32 s59, s59, 14336
  buffer_store_dwordx4 v[8:11], v3, s[8:11], s59 offen sc1
  s_add_u32 s59, s59, 14336
  s_branch L_prep_done
L_short_8:
  v_cvt_pk_bf16_f32 v226, v160, v161
  v_cvt_pk_bf16_f32 v227, v162, v163
  v_cvt_pk_bf16_f32 v230, v164, v165
  v_cvt_pk_bf16_f32 v231, v166, v167
  v_cvt_pk_bf16_f32 v234, v168, v169
  v_cvt_pk_bf16_f32 v235, v170, v171
  v_cvt_pk_bf16_f32 v238, v172, v173
  v_cvt_pk_bf16_f32 v239, v174, v175
  s_lshl_b32 s59, s68, 9
  s_add_u32 s59, s59, s36
  buffer_store_dwordx4 v[224:227], v3, s[8:11], s59 offen sc1
  s_add_u32 s59, s59, 14336
  buffer_store_dwordx4 v[228:231], v3, s[8:11], s59 offen sc1
  s_add_u32 s59, s59, 14336
  buffer_store_dwordx4 v[232:235], v3, s[8:11], s59 offen sc1
  s_add_u32 s59, s59, 14336
  buffer_store_dwordx4 v[236:239], v3, s[8:11], s59 offen sc1
  s_add_u32 s59, s59, 14336
  s_branch L_prep_done
L_prep_none:
  s_mov_b32 s16, -1
  s_waitcnt lgkmcnt(0)
  s_mov_b32 s8, s40
  s_and_b32 s9, s41, 0xffff
  s_mov_b32 s10, 268435456
  s_mov_b32 s11, 0x20000
  s_mov_b32 s12, s42
  s_and_b32 s13, s43, 0xffff
  s_mov_b32 s14, 256
  s_mov_b32 s15, 0x20000
  s_or_b32 s19, s2, s3
  s_cmp_eq_u32 s19, 0
  s_cbranch_scc0 L_nonce_11
  s_memrealtime s[74:75]
  s_waitcnt lgkmcnt(0)
  s_lshl_b32 s74, s74, 4
  s_and_b32 s75, s7, 7
  s_or_b32 s74, s74, s75
  s_or_b32 s74, s74, 8
  v_mov_b32 v10, s74
  buffer_store_dword v10, v253, s[12:15], 0 offen offset:192 sc1
L_nonce_11:
  s_cmp_eq_u32 s3, 0
  s_cbranch_scc0 L_rank_12
  s_mov_b64 exec, 1
  buffer_atomic_add v252, v253, s[12:15], s17 offen sc0 sc1
  s_mov_b64 exec, -1
L_rank_12:
L_prep_done:
  v_mov_b32 v6, 131072
L_nonce:
  buffer_load_dword v7, v253, s[12:15], 0 offen offset:192 sc1
  s_add_u32 s6, s6, 1
  s_cmp_gt_u32 s6, 262144
  s_cbranch_scc1 L_timeout
  s_waitcnt vmcnt(0)
  v_readfirstlane_b32 s98, v7
  s_cmp_eq_u32 s98, 0
  s_cbranch_scc0 L_nonce_ok
  s_sleep 4
  s_branch L_nonce
L_nonce_ok:
  s_cmp_eq_u32 s3, 0
  s_cbranch_scc0 L_role_wait
  v_readfirstlane_b32 s30, v252
  s_sub_u32 s31, s7, s98
  s_and_b32 s31, s31, 7
  s_lshl_b32 s4, s31, 5
  s_add_u32 s4, s4, s30
  s_cmp_ge_u32 s7, 8
  s_cbranch_scc1 L_overflow
  s_cmp_ge_u32 s30, 32
  s_cbranch_scc0 L_role_known
L_overflow:
  v_mov_b32 v252, 1
  s_mov_b64 exec, 1
  buffer_atomic_add v252, v253, s[12:15], 0 offen offset:64 sc0 sc1
  s_waitcnt vmcnt(0)
  v_readfirstlane_b32 s31, v252
  s_mov_b64 exec, -1
  v_and_b32 v4, 4, v1
  v_lshlrev_b32 v4, 5, v4
  v_and_b32 v5, 11, v1
  v_lshl_add_u32 v4, v5, 2, v4
L_ov_poll:
  buffer_load_dword v5, v4, s[12:15], 0 offen sc1
  s_add_u32 s6, s6, 1
  s_cmp_gt_u32 s6, 262144
  s_cbranch_scc1 L_timeout
  s_waitcnt vmcnt(0)
  s_mov_b32 s32, 0
  v_readlane_b32 s44, v5, 0
  v_readlane_b32 s45, v5, 1
  v_readlane_b32 s46, v5, 2
  v_readlane_b32 s47, v5, 3
  v_readlane_b32 s48, v5, 4
  v_readlane_b32 s49, v5, 5
  v_readlane_b32 s50, v5, 6
  v_readlane_b32 s51, v5, 7
  v_readlane_b32 s52, v5, 8
  v_readlane_b32 s53, v5, 9
  v_readlane_b32 s54, v5, 10
  v_readlane_b32 s55, v5, 11
  v_readlane_b32 s56, v5, 12
  v_readlane_b32 s57, v5, 13
  v_readlane_b32 s58, v5, 14
  v_readlane_b32 s59, v5, 15
  s_add_u32 s32, s32, s44
  s_add_u32 s32, s32, s45
  s_add_u32 s32, s32, s46
  s_add_u32 s32, s32, s47
  s_add_u32 s32, s32, s48
  s_add_u32 s32, s32, s49
  s_add_u32 s32, s32, s50
  s_add_u32 s32, s32, s51
  s_add_u32 s32, s32, s52
  s_add_u32 s32, s32, s53
  s_add_u32 s32, s32, s54
  s_add_u32 s32, s32, s55
  s_add_u32 s32, s32, s56
  s_add_u32 s32, s32, s57
  s_add_u32 s32, s32, s58
  s_add_u32 s32, s32, s59
  s_cmp_lt_u32 s32, 256
  s_cbranch_scc1 L_ov_poll
  s_mov_b32 s5, 1
  s_min_u32 s33, s44, 32
  s_sub_u32 s34, 32, s33
  s_sub_u32 s35, 0, s98
  s_and_b32 s35, s35, 7
  s_lshl_b32 s35, s35, 5
  s_add_u32 s4, s33, s31
  s_add_u32 s4, s4, s35
  s_cmp_lt_u32 s31, s34
  s_cbranch_scc1 L_role_known
  s_sub_u32 s31, s31, s34
  s_min_u32 s33, s45, 32
  s_sub_u32 s34, 32, s33
  s_sub_u32 s35, 1, s98
  s_and_b32 s35, s35, 7
  s_lshl_b32 s35, s35, 5
  s_add_u32 s4, s33, s31
  s_add_u32 s4, s4, s35
  s_cmp_lt_u32 s31, s34
  s_cbranch_scc1 L_role_known
  s_sub_u32 s31, s31, s34
  s_min_u32 s33, s46, 32
  s_sub_u32 s34, 32, s33
  s_sub_u32 s35, 2, s98
  s_and_b32 s35, s35, 7
  s_lshl_b32 s35, s35, 5
  s_add_u32 s4, s33, s31
  s_add_u32 s4, s4, s35
  s_cmp_lt_u32 s31, s34
  s_cbranch_scc1 L_role_known
  s_sub_u32 s31, s31, s34
  s_min_u32 s33, s47, 32
  s_sub_u32 s34, 32, s33
  s_sub_u32 s35, 3, s98
  s_and_b32 s35, s35, 7
  s_lshl_b32 s35, s35, 5
  s_add_u32 s4, s33, s31
  s_add_u32 s4, s4, s35
  s_cmp_lt_u32 s31, s34
  s_cbranch_scc1 L_role_known
  s_sub_u32 s31, s31, s34
  s_min_u32 s33, s48, 32
  s_sub_u32 s34, 32, s33
  s_sub_u32 s35, 4, s98
  s_and_b32 s35, s35, 7
  s_lshl_b32 s35, s35, 5
  s_add_u32 s4, s33, s31
  s_add_u32 s4, s4, s35
  s_cmp_lt_u32 s31, s34
  s_cbranch_scc1 L_role_known
  s_sub_u32 s31, s31, s34
  s_min_u32 s33, s49, 32
  s_sub_u32 s34, 32, s33
  s_sub_u32 s35, 5, s98
  s_and_b32 s35, s35, 7
  s_lshl_b32 s35, s35, 5
  s_add_u32 s4, s33, s31
  s_add_u32 s4, s4, s35
  s_cmp_lt_u32 s31, s34
  s_cbranch_scc1 L_role_known
  s_sub_u32 s31, s31, s34
  s_min_u32 s33, s50, 32
  s_sub_u32 s34, 32, s33
  s_sub_u32 s35, 6, s98
  s_and_b32 s35, s35, 7
  s_lshl_b32 s35, s35, 5
  s_add_u32 s4, s33, s31
  s_add_u32 s4, s4, s35
  s_cmp_lt_u32 s31, s34
  s_cbranch_scc1 L_role_known
  s_sub_u32 s31, s31, s34
  s_min_u32 s33, s51, 32
  s_sub_u32 s34, 32, s33
  s_sub_u32 s35, 7, s98
  s_and_b32 s35, s35, 7
  s_lshl_b32 s35, s35, 5
  s_add_u32 s4, s33, s31
  s_add_u32 s4, s4, s35
  s_cmp_lt_u32 s31, s34
  s_cbranch_scc1 L_role_known
  s_sub_u32 s31, s31, s34
  s_mov_b32 s4, 0x2ff
L_role_known:
  s_lshl_b32 s29, s5, 8
  s_or_b32 s30, s29, s4
  v_mov_b32 v4, s30
  ds_write_b32 v6, v4
  s_waitcnt lgkmcnt(0)
L_role_wait:
  s_barrier
  ds_read_b32 v4, v6
  s_cmp_eq_u32 s3, 0
  s_cbranch_scc0 L_no_reg
  s_cmp_eq_u32 s16, -1
  s_cbranch_scc1 L_no_done
  v_mov_b32 v252, s98
  s_lshl_b32 s16, s16, 7
  s_add_u32 s16, s16, 77721600
  v_lshrrev_b32 v5, 2, v3
  v_and_b32 v5, 124, v5
  buffer_store_dword v252, v5, s[8:11], s16 offen sc1
L_no_done:
  s_mov_b64 exec, 1
  s_cmp_lt_u32 s4, 32
  s_cbranch_scc0 L_no_reg2
  s_add_u32 s29, s29, 1
  v_mov_b32 v254, s29
  buffer_atomic_add v254, v253, s[12:15], 0 offen offset:68 sc1
L_no_reg2:
  s_mov_b64 exec, -1
L_no_reg:
  s_waitcnt lgkmcnt(0)
  v_readfirstlane_b32 s30, v4
  s_bitcmp1_b32 s30, 9
  s_cbranch_scc1 L_exit
  s_and_b32 s4, s30, 0xff
  s_sub_u32 s36, s4, 30
  s_cmp_lt_u32 s36, 2
  s_cbranch_scc1 L_ln
  s_sub_u32 s36, s4, 160
  s_cmp_lt_u32 s36, 48
  s_cbranch_scc0 L_no_ln
  s_bitcmp1_b32 s36, 4
  s_cbranch_scc1 L_no_ln
  s_cmp_lt_u32 s36, 2
  s_cbranch_scc1 L_no_ln
  s_lshr_b32 s37, s36, 1
  s_and_b32 s37, s37, 16
  s_and_b32 s36, s36, 15
  s_add_u32 s36, s36, s37
L_ln:
  s_load_dwordx4 s[52:55], s[0:1], 0
  s_waitcnt lgkmcnt(0)
  s_mov_b32 s20, s52
  s_and_b32 s21, s53, 0xffff
  s_mov_b32 s22, 1835008
  s_mov_b32 s23, 0x20000
  s_mov_b32 s24, s54
  s_and_b32 s25, s55, 0xffff
  s_mov_b32 s26, 7168
  s_mov_b32 s27, 0x20000
  s_lshl_b32 s37, s36, 2
  s_add_u32 s37, s37, s3
  v_lshrrev_b32 v61, 2, v0
  v_and_b32 v62, 3, v0
  v_mul_u32_u24 v63, 896, v61
  v_lshl_add_u32 v63, v62, 4, v63
  s_mul_i32 s28, s37, 14336
  buffer_load_dwordx4 v[4:7], v63, s[20:23], s28 offen offset:0
  buffer_load_dwordx4 v[8:11], v63, s[20:23], s28 offen offset:64
  buffer_load_dwordx4 v[12:15], v63, s[20:23], s28 offen offset:128
  buffer_load_dwordx4 v[16:19], v63, s[20:23], s28 offen offset:192
  buffer_load_dwordx4 v[20:23], v63, s[20:23], s28 offen offset:256
  buffer_load_dwordx4 v[24:27], v63, s[20:23], s28 offen offset:320
  buffer_load_dwordx4 v[28:31], v63, s[20:23], s28 offen offset:384
  buffer_load_dwordx4 v[32:35], v63, s[20:23], s28 offen offset:448
  buffer_load_dwordx4 v[36:39], v63, s[20:23], s28 offen offset:512
  buffer_load_dwordx4 v[40:43], v63, s[20:23], s28 offen offset:576
  buffer_load_dwordx4 v[44:47], v63, s[20:23], s28 offen offset:640
  buffer_load_dwordx4 v[48:51], v63, s[20:23], s28 offen offset:704
  buffer_load_dwordx4 v[52:55], v63, s[20:23], s28 offen offset:768
  buffer_load_dwordx4 v[56:59], v63, s[20:23], s28 offen offset:832
  s_cmp_eq_u32 s36, 1
  s_cbranch_scc1 L_prep_mem
  s_waitcnt vmcnt(0)
  s_branch L_prep_nomem
L_prep_mem:
  v_and_b32 v214, 7, v1
  v_mul_u32_u24 v214, 896, v214
  v_lshrrev_b32 v215, 3, v1
  v_lshl_add_u32 v214, v215, 2, v214
  v_lshl_add_u32 v214, v2, 5, v214
  s_add_u32 s31, s3, 0
  s_min_u32 s31, s31, 6
  s_lshl_b32 s32, s31, 7
  s_lshl_b32 s33, s31, 10
  buffer_load_dword v188, v214, s[24:27], s32 offen offset:0
  buffer_load_dword v189, v214, s[24:27], s32 offen offset:8
  buffer_load_dword v190, v214, s[24:27], s32 offen offset:16
  buffer_load_dword v191, v214, s[24:27], s32 offen offset:24
  s_add_u32 s31, s3, 4
  s_min_u32 s31, s31, 6
  s_lshl_b32 s32, s31, 7
  s_lshl_b32 s34, s31, 10
  buffer_load_dword v192, v214, s[24:27], s32 offen offset:0
  buffer_load_dword v193, v214, s[24:27], s32 offen offset:8
  buffer_load_dword v194, v214, s[24:27], s32 offen offset:16
  buffer_load_dword v195, v214, s[24:27], s32 offen offset:24
  s_waitcnt vmcnt(0)
  v_min_u32 v188, -2, v188
  v_min_u32 v189, -2, v189
  v_min_u32 v190, -2, v190
  v_min_u32 v191, -2, v191
  s_add_u32 s35, s33, 46399488
  buffer_store_dwordx4 v[188:191], v3, s[8:11], s35 offen sc1
  s_add_u32 s35, s33, 45875200
  buffer_store_dwordx4 v[188:191], v3, s[8:11], s35 offen sc1
  v_min_u32 v192, -2, v192
  v_min_u32 v193, -2, v193
  v_min_u32 v194, -2, v194
  v_min_u32 v195, -2, v195
  s_add_u32 s35, s34, 46399488
  buffer_store_dwordx4 v[192:195], v3, s[8:11], s35 offen sc1
  s_add_u32 s35, s34, 45875200
  buffer_store_dwordx4 v[192:195], v3, s[8:11], s35 offen sc1
L_prep_nomem:
  s_waitcnt vmcnt(4)
  s_mov_b32 s29, 0xffff0000
  v_lshlrev_b32 v64, 16, v4
  v_and_b32 v65, s29, v4
  v_lshlrev_b32 v66, 16, v5
  v_and_b32 v67, s29, v5
  v_lshlrev_b32 v68, 16, v6
  v_and_b32 v69, s29, v6
  v_lshlrev_b32 v70, 16, v7
  v_and_b32 v71, s29, v7
  v_lshlrev_b32 v72, 16, v8
  v_and_b32 v73, s29, v8
  v_lshlrev_b32 v74, 16, v9
  v_and_b32 v75, s29, v9
  v_lshlrev_b32 v76, 16, v10
  v_and_b32 v77, s29, v10
  v_lshlrev_b32 v78, 16, v11
  v_and_b32 v79, s29, v11
  v_lshlrev_b32 v80, 16, v12
  v_and_b32 v81, s29, v12
  v_lshlrev_b32 v82, 16, v13
  v_and_b32 v83, s29, v13
  v_lshlrev_b32 v84, 16, v14
  v_and_b32 v85, s29, v14
  v_lshlrev_b32 v86, 16, v15
  v_and_b32 v87, s29, v15
  v_lshlrev_b32 v88, 16, v16
  v_and_b32 v89, s29, v16
  v_lshlrev_b32 v90, 16, v17
  v_and_b32 v91, s29, v17
  v_lshlrev_b32 v92, 16, v18
  v_and_b32 v93, s29, v18
  v_lshlrev_b32 v94, 16, v19
  v_and_b32 v95, s29, v19
  v_lshlrev_b32 v96, 16, v20
  v_and_b32 v97, s29, v20
  v_lshlrev_b32 v98, 16, v21
  v_and_b32 v99, s29, v21
  v_lshlrev_b32 v100, 16, v22
  v_and_b32 v101, s29, v22
  v_lshlrev_b32 v102, 16, v23
  v_and_b32 v103, s29, v23
  v_lshlrev_b32 v104, 16, v24
  v_and_b32 v105, s29, v24
  v_lshlrev_b32 v106, 16, v25
  v_and_b32 v107, s29, v25
  v_lshlrev_b32 v108, 16, v26
  v_and_b32 v109, s29, v26
  v_lshlrev_b32 v110, 16, v27
  v_and_b32 v111, s29, v27
  v_lshlrev_b32 v112, 16, v28
  v_and_b32 v113, s29, v28
  v_lshlrev_b32 v114, 16, v29
  v_and_b32 v115, s29, v29
  v_lshlrev_b32 v116, 16, v30
  v_and_b32 v117, s29, v30
  v_lshlrev_b32 v118, 16, v31
  v_and_b32 v119, s29, v31
  v_lshlrev_b32 v120, 16, v32
  v_and_b32 v121, s29, v32
  v_lshlrev_b32 v122, 16, v33
  v_and_b32 v123, s29, v33
  v_lshlrev_b32 v124, 16, v34
  v_and_b32 v125, s29, v34
  v_lshlrev_b32 v126, 16, v35
  v_and_b32 v127, s29, v35
  v_lshlrev_b32 v128, 16, v36
  v_and_b32 v129, s29, v36
  v_lshlrev_b32 v130, 16, v37
  v_and_b32 v131, s29, v37
  v_lshlrev_b32 v132, 16, v38
  v_and_b32 v133, s29, v38
  v_lshlrev_b32 v134, 16, v39
  v_and_b32 v135, s29, v39
  v_lshlrev_b32 v136, 16, v40
  v_and_b32 v137, s29, v40
  v_lshlrev_b32 v138, 16, v41
  v_and_b32 v139, s29, v41
  v_lshlrev_b32 v140, 16, v42
  v_and_b32 v141, s29, v42
  v_lshlrev_b32 v142, 16, v43
  v_and_b32 v143, s29, v43
  v_lshlrev_b32 v144, 16, v44
  v_and_b32 v145, s29, v44
  v_lshlrev_b32 v146, 16, v45
  v_and_b32 v147, s29, v45
  v_lshlrev_b32 v148, 16, v46
  v_and_b32 v149, s29, v46
  v_lshlrev_b32 v150, 16, v47
  v_and_b32 v151, s29, v47
  v_lshlrev_b32 v152, 16, v48
  v_and_b32 v153, s29, v48
  v_lshlrev_b32 v154, 16, v49
  v_and_b32 v155, s29, v49
  v_lshlrev_b32 v156, 16, v50
  v_and_b32 v157, s29, v50
  v_lshlrev_b32 v158, 16, v51
  v_and_b32 v159, s29, v51
  v_lshlrev_b32 v160, 16, v52
  v_and_b32 v161, s29, v52
  v_lshlrev_b32 v162, 16, v53
  v_and_b32 v163, s29, v53
  v_lshlrev_b32 v164, 16, v54
  v_and_b32 v165, s29, v54
  v_lshlrev_b32 v166, 16, v55
  v_and_b32 v167, s29, v55
  v_lshlrev_b32 v168, 16, v56
  v_and_b32 v169, s29, v56
  v_lshlrev_b32 v170, 16, v57
  v_and_b32 v171, s29, v57
  v_lshlrev_b32 v172, 16, v58
  v_and_b32 v173, s29, v58
  v_lshlrev_b32 v174, 16, v59
  v_and_b32 v175, s29, v59
  v_pk_add_f32 v[192:193], v[64:65], v[66:67]
  v_pk_add_f32 v[194:195], v[68:69], v[70:71]
  v_pk_add_f32 v[192:193], v[192:193], v[72:73]
  v_pk_add_f32 v[194:195], v[194:195], v[74:75]
  v_pk_add_f32 v[192:193], v[192:193], v[76:77]
  v_pk_add_f32 v[194:195], v[194:195], v[78:79]
  v_pk_add_f32 v[192:193], v[192:193], v[80:81]
  v_pk_add_f32 v[194:195], v[194:195], v[82:83]
  v_pk_add_f32 v[192:193], v[192:193], v[84:85]
  v_pk_add_f32 v[194:195], v[194:195], v[86:87]
  v_pk_add_f32 v[192:193], v[192:193], v[88:89]
  v_pk_add_f32 v[194:195], v[194:195], v[90:91]
  v_pk_add_f32 v[192:193], v[192:193], v[92:93]
  v_pk_add_f32 v[194:195], v[194:195], v[94:95]
  v_pk_add_f32 v[192:193], v[192:193], v[96:97]
  v_pk_add_f32 v[194:195], v[194:195], v[98:99]
  v_pk_add_f32 v[192:193], v[192:193], v[100:101]
  v_pk_add_f32 v[194:195], v[194:195], v[102:103]
  v_pk_add_f32 v[192:193], v[192:193], v[104:105]
  v_pk_add_f32 v[194:195], v[194:195], v[106:107]
  v_pk_add_f32 v[192:193], v[192:193], v[108:109]
  v_pk_add_f32 v[194:195], v[194:195], v[110:111]
  v_pk_add_f32 v[192:193], v[192:193], v[112:113]
  v_pk_add_f32 v[194:195], v[194:195], v[114:115]
  v_pk_add_f32 v[192:193], v[192:193], v[116:117]
  v_pk_add_f32 v[194:195], v[194:195], v[118:119]
  v_pk_add_f32 v[192:193], v[192:193], v[120:121]
  v_pk_add_f32 v[194:195], v[194:195], v[122:123]
  v_pk_add_f32 v[192:193], v[192:193], v[124:125]
  v_pk_add_f32 v[194:195], v[194:195], v[126:127]
  v_pk_add_f32 v[192:193], v[192:193], v[128:129]
  v_pk_add_f32 v[194:195], v[194:195], v[130:131]
  v_pk_add_f32 v[192:193], v[192:193], v[132:133]
  v_pk_add_f32 v[194:195], v[194:195], v[134:135]
  v_pk_add_f32 v[192:193], v[192:193], v[136:137]
  v_pk_add_f32 v[194:195], v[194:195], v[138:139]
  v_pk_add_f32 v[192:193], v[192:193], v[140:141]
  v_pk_add_f32 v[194:195], v[194:195], v[142:143]
  v_pk_add_f32 v[192:193], v[192:193], v[144:145]
  v_pk_add_f32 v[194:195], v[194:195], v[146:147]
  v_pk_add_f32 v[192:193], v[192:193], v[148:149]
  v_pk_add_f32 v[194:195], v[194:195], v[150:151]
  v_pk_add_f32 v[192:193], v[192:193], v[152:153]
  v_pk_add_f32 v[194:195], v[194:195], v[154:155]
  v_pk_add_f32 v[192:193], v[192:193], v[156:157]
  v_pk_add_f32 v[194:195], v[194:195], v[158:159]
  v_pk_add_f32 v[192:193], v[192:193], v[160:161]
  v_pk_add_f32 v[194:195], v[194:195], v[162:163]
  v_pk_add_f32 v[192:193], v[192:193], v[164:165]
  v_pk_add_f32 v[194:195], v[194:195], v[166:167]
  v_pk_add_f32 v[192:193], v[192:193], v[168:169]
  v_pk_add_f32 v[194:195], v[194:195], v[170:171]
  v_pk_add_f32 v[192:193], v[192:193], v[172:173]
  v_pk_add_f32 v[194:195], v[194:195], v[174:175]
  v_pk_add_f32 v[192:193], v[192:193], v[194:195]
  v_add_f32 v192, v192, v193
  s_nop 1
  v_add_f32_dpp v192, v192, v192 quad_perm:[1,0,3,2] row_mask:0xf bank_mask:0xf
  s_nop 1
  v_add_f32_dpp v192, v192, v192 quad_perm:[2,3,0,1] row_mask:0xf bank_mask:0xf
  v_mul_f32 v192, 0xbb124925, v192
  v_mov_b32 v193, v192
  v_pk_add_f32 v[64:65], v[64:65], v[192:193]
  v_pk_add_f32 v[66:67], v[66:67], v[192:193]
  v_pk_add_f32 v[68:69], v[68:69], v[192:193]
  v_pk_add_f32 v[70:71], v[70:71], v[192:193]
  v_pk_add_f32 v[72:73], v[72:73], v[192:193]
  v_pk_add_f32 v[74:75], v[74:75], v[192:193]
  v_pk_add_f32 v[76:77], v[76:77], v[192:193]
  v_pk_add_f32 v[78:79], v[78:79], v[192:193]
  v_pk_add_f32 v[80:81], v[80:81], v[192:193]
  v_pk_add_f32 v[82:83], v[82:83], v[192:193]
  v_pk_add_f32 v[84:85], v[84:85], v[192:193]
  v_pk_add_f32 v[86:87], v[86:87], v[192:193]
  v_pk_add_f32 v[88:89], v[88:89], v[192:193]
  v_pk_add_f32 v[90:91], v[90:91], v[192:193]
  v_pk_add_f32 v[92:93], v[92:93], v[192:193]
  v_pk_add_f32 v[94:95], v[94:95], v[192:193]
  v_pk_add_f32 v[96:97], v[96:97], v[192:193]
  v_pk_add_f32 v[98:99], v[98:99], v[192:193]
  v_pk_add_f32 v[100:101], v[100:101], v[192:193]
  v_pk_add_f32 v[102:103], v[102:103], v[192:193]
  v_pk_add_f32 v[104:105], v[104:105], v[192:193]
  v_pk_add_f32 v[106:107], v[106:107], v[192:193]
  v_pk_add_f32 v[108:109], v[108:109], v[192:193]
  v_pk_add_f32 v[110:111], v[110:111], v[192:193]
  v_pk_add_f32 v[112:113], v[112:113], v[192:193]
  v_pk_add_f32 v[114:115], v[114:115], v[192:193]
  v_pk_add_f32 v[116:117], v[116:117], v[192:193]
  v_pk_add_f32 v[118:119], v[118:119], v[192:193]
  v_pk_add_f32 v[120:121], v[120:121], v[192:193]
  v_pk_add_f32 v[122:123], v[122:123], v[192:193]
  v_pk_add_f32 v[124:125], v[124:125], v[192:193]
  v_pk_add_f32 v[126:127], v[126:127], v[192:193]
  v_pk_add_f32 v[128:129], v[128:129], v[192:193]
  v_pk_add_f32 v[130:131], v[130:131], v[192:193]
  v_pk_add_f32 v[132:133], v[132:133], v[192:193]
  v_pk_add_f32 v[134:135], v[134:135], v[192:193]
  v_pk_add_f32 v[136:137], v[136:137], v[192:193]
  v_pk_add_f32 v[138:139], v[138:139], v[192:193]
  v_pk_add_f32 v[140:141], v[140:141], v[192:193]
  v_pk_add_f32 v[142:143], v[142:143], v[192:193]
  v_pk_add_f32 v[144:145], v[144:145], v[192:193]
  v_pk_add_f32 v[146:147], v[146:147], v[192:193]
  v_pk_add_f32 v[148:149], v[148:149], v[192:193]
  v_pk_add_f32 v[150:151], v[150:151], v[192:193]
  v_pk_add_f32 v[152:153], v[152:153], v[192:193]
  v_pk_add_f32 v[154:155], v[154:155], v[192:193]
  v_pk_add_f32 v[156:157], v[156:157], v[192:193]
  v_pk_add_f32 v[158:159], v[158:159], v[192:193]
  v_pk_add_f32 v[160:161], v[160:161], v[192:193]
  v_pk_add_f32 v[162:163], v[162:163], v[192:193]
  v_pk_add_f32 v[164:165], v[164:165], v[192:193]
  v_pk_add_f32 v[166:167], v[166:167], v[192:193]
  v_pk_add_f32 v[168:169], v[168:169], v[192:193]
  v_pk_add_f32 v[170:171], v[170:171], v[192:193]
  v_pk_add_f32 v[172:173], v[172:173], v[192:193]
  v_pk_add_f32 v[174:175], v[174:175], v[192:193]
  v_pk_mul_f32 v[196:197], v[64:65], v[64:65]
  v_pk_mul_f32 v[198:199], v[66:67], v[66:67]
  v_pk_fma_f32 v[196:197], v[68:69], v[68:69], v[196:197]
  v_pk_fma_f32 v[198:199], v[70:71], v[70:71], v[198:199]
  v_pk_fma_f32 v[196:197], v[72:73], v[72:73], v[196:197]
  v_pk_fma_f32 v[198:199], v[74:75], v[74:75], v[198:199]
  v_pk_fma_f32 v[196:197], v[76:77], v[76:77], v[196:197]
  v_pk_fma_f32 v[198:199], v[78:79], v[78:79], v[198:199]
  v_pk_fma_f32 v[196:197], v[80:81], v[80:81], v[196:197]
  v_pk_fma_f32 v[198:199], v[82:83], v[82:83], v[198:199]
  v_pk_fma_f32 v[196:197], v[84:85], v[84:85], v[196:197]
  v_pk_fma_f32 v[198:199], v[86:87], v[86:87], v[198:199]
  v_pk_fma_f32 v[196:197], v[88:89], v[88:89], v[196:197]
  v_pk_fma_f32 v[198:199], v[90:91], v[90:91], v[198:199]
  v_pk_fma_f32 v[196:197], v[92:93], v[92:93], v[196:197]
  v_pk_fma_f32 v[198:199], v[94:95], v[94:95], v[198:199]
  v_pk_fma_f32 v[196:197], v[96:97], v[96:97], v[196:197]
  v_pk_fma_f32 v[198:199], v[98:99], v[98:99], v[198:199]
  v_pk_fma_f32 v[196:197], v[100:101], v[100:101], v[196:197]
  v_pk_fma_f32 v[198:199], v[102:103], v[102:103], v[198:199]
  v_pk_fma_f32 v[196:197], v[104:105], v[104:105], v[196:197]
  v_pk_fma_f32 v[198:199], v[106:107], v[106:107], v[198:199]
  v_pk_fma_f32 v[196:197], v[108:109], v[108:109], v[196:197]
  v_pk_fma_f32 v[198:199], v[110:111], v[110:111], v[198:199]
  v_pk_fma_f32 v[196:197], v[112:113], v[112:113], v[196:197]
  v_pk_fma_f32 v[198:199], v[114:115], v[114:115], v[198:199]
  v_pk_fma_f32 v[196:197], v[116:117], v[116:117], v[196:197]
  v_pk_fma_f32 v[198:199], v[118:119], v[118:119], v[198:199]
  v_pk_fma_f32 v[196:197], v[120:121], v[120:121], v[196:197]
  v_pk_fma_f32 v[198:199], v[122:123], v[122:123], v[198:199]
  v_pk_fma_f32 v[196:197], v[124:125], v[124:125], v[196:197]
  v_pk_fma_f32 v[198:199], v[126:127], v[126:127], v[198:199]
  v_pk_fma_f32 v[196:197], v[128:129], v[128:129], v[196:197]
  v_pk_fma_f32 v[198:199], v[130:131], v[130:131], v[198:199]
  v_pk_fma_f32 v[196:197], v[132:133], v[132:133], v[196:197]
  v_pk_fma_f32 v[198:199], v[134:135], v[134:135], v[198:199]
  v_pk_fma_f32 v[196:197], v[136:137], v[136:137], v[196:197]
  v_pk_fma_f32 v[198:199], v[138:139], v[138:139], v[198:199]
  v_pk_fma_f32 v[196:197], v[140:141], v[140:141], v[196:197]
  v_pk_fma_f32 v[198:199], v[142:143], v[142:143], v[198:199]
  v_pk_fma_f32 v[196:197], v[144:145], v[144:145], v[196:197]
  v_pk_fma_f32 v[198:199], v[146:147], v[146:147], v[198:199]
  v_pk_fma_f32 v[196:197], v[148:149], v[148:149], v[196:197]
  v_pk_fma_f32 v[198:199], v[150:151], v[150:151], v[198:199]
  v_pk_fma_f32 v[196:197], v[152:153], v[152:153], v[196:197]
  v_pk_fma_f32 v[198:199], v[154:155], v[154:155], v[198:199]
  v_pk_fma_f32 v[196:197], v[156:157], v[156:157], v[196:197]
  v_pk_fma_f32 v[198:199], v[158:159], v[158:159], v[198:199]
  v_pk_fma_f32 v[196:197], v[160:161], v[160:161], v[196:197]
  v_pk_fma_f32 v[198:199], v[162:163], v[162:163], v[198:199]
  v_pk_fma_f32 v[196:197], v[164:165], v[164:165], v[196:197]
  v_pk_fma_f32 v[198:199], v[166:167], v[166:167], v[198:199]
  v_pk_fma_f32 v[196:197], v[168:169], v[168:169], v[196:197]
  v_pk_fma_f32 v[198:199], v[170:171], v[170:171], v[198:199]
  v_pk_fma_f32 v[196:197], v[172:173], v[172:173], v[196:197]
  v_pk_fma_f32 v[198:199], v[174:175], v[174:175], v[198:199]
  v_pk_add_f32 v[196:197], v[196:197], v[198:199]
  v_add_f32 v196, v196, v197
  s_nop 1
  v_add_f32_dpp v196, v196, v196 quad_perm:[1,0,3,2] row_mask:0xf bank_mask:0xf
  s_nop 1
  v_add_f32_dpp v196, v196, v196 quad_perm:[2,3,0,1] row_mask:0xf bank_mask:0xf
  v_mov_b32 v198, 0x3727c5ac
  v_fmac_f32 v198, 0x3b124925, v196
  v_rsq_f32 v198, v198
  s_nop 0
  v_mov_b32 v199, v198
  s_mul_i32 s28, s37, 14336
  s_add_u32 s28, s28, 12845056
  v_lshrrev_b32 v63, 3, v61
  v_lshlrev_b32 v63, 1, v63
  v_xor_b32 v63, v63, v62
  v_lshl_add_u32 v63, v61, 2, v63
  v_lshlrev_b32 v208, 4, v63
  v_and_b32 v63, 1, v62
  v_cmp_eq_u32 s[56:57], 1, v63
  s_add_u32 s30, s28, 1835008
  v_pk_mul_f32 v[64:65], v[64:65], v[198:199]
  v_pk_mul_f32 v[66:67], v[66:67], v[198:199]
  v_pk_mul_f32 v[68:69], v[68:69], v[198:199]
  v_pk_mul_f32 v[70:71], v[70:71], v[198:199]
  v_cvt_pk_bf16_f32 v4, v64, v65
  v_cvt_pk_bf16_f32 v5, v66, v67
  v_cvt_pk_bf16_f32 v6, v68, v69
  v_cvt_pk_bf16_f32 v7, v70, v71
  buffer_store_dwordx4 v[4:7], v208, s[8:11], s28 offen offset:0 sc1
  v_cndmask_b32 v210, v5, v4, s[56:57]
  v_cndmask_b32 v211, v7, v6, s[56:57]
  v_mov_b32_dpp v212, v210 quad_perm:[1,0,3,2] row_mask:0xf bank_mask:0xf
  v_mov_b32_dpp v213, v211 quad_perm:[1,0,3,2] row_mask:0xf bank_mask:0xf
  v_cndmask_b32 v200, v4, v212, s[56:57]
  v_cndmask_b32 v201, v6, v213, s[56:57]
  v_cndmask_b32 v202, v212, v5, s[56:57]
  v_cndmask_b32 v203, v213, v7, s[56:57]
  buffer_store_dwordx4 v[200:203], v208, s[8:11], s30 offen offset:0 sc1
  v_pk_mul_f32 v[72:73], v[72:73], v[198:199]
  v_pk_mul_f32 v[74:75], v[74:75], v[198:199]
  v_pk_mul_f32 v[76:77], v[76:77], v[198:199]
  v_pk_mul_f32 v[78:79], v[78:79], v[198:199]
  v_cvt_pk_bf16_f32 v8, v72, v73
  v_cvt_pk_bf16_f32 v9, v74, v75
  v_cvt_pk_bf16_f32 v10, v76, v77
  v_cvt_pk_bf16_f32 v11, v78, v79
  buffer_store_dwordx4 v[8:11], v208, s[8:11], s28 offen offset:1024 sc1
  v_cndmask_b32 v210, v9, v8, s[56:57]
  v_cndmask_b32 v211, v11, v10, s[56:57]
  v_mov_b32_dpp v212, v210 quad_perm:[1,0,3,2] row_mask:0xf bank_mask:0xf
  v_mov_b32_dpp v213, v211 quad_perm:[1,0,3,2] row_mask:0xf bank_mask:0xf
  v_cndmask_b32 v204, v8, v212, s[56:57]
  v_cndmask_b32 v205, v10, v213, s[56:57]
  v_cndmask_b32 v206, v212, v9, s[56:57]
  v_cndmask_b32 v207, v213, v11, s[56:57]
  buffer_store_dwordx4 v[204:207], v208, s[8:11], s30 offen offset:1024 sc1
  v_pk_mul_f32 v[80:81], v[80:81], v[198:199]
  v_pk_mul_f32 v[82:83], v[82:83], v[198:199]
  v_pk_mul_f32 v[84:85], v[84:85], v[198:199]
  v_pk_mul_f32 v[86:87], v[86:87], v[198:199]
  v_cvt_pk_bf16_f32 v12, v80, v81
  v_cvt_pk_bf16_f32 v13, v82, v83
  v_cvt_pk_bf16_f32 v14, v84, v85
  v_cvt_pk_bf16_f32 v15, v86, v87
  buffer_store_dwordx4 v[12:15], v208, s[8:11], s28 offen offset:2048 sc1
  v_cndmask_b32 v210, v13, v12, s[56:57]
  v_cndmask_b32 v211, v15, v14, s[56:57]
  v_mov_b32_dpp v212, v210 quad_perm:[1,0,3,2] row_mask:0xf bank_mask:0xf
  v_mov_b32_dpp v213, v211 quad_perm:[1,0,3,2] row_mask:0xf bank_mask:0xf
  v_cndmask_b32 v200, v12, v212, s[56:57]
  v_cndmask_b32 v201, v14, v213, s[56:57]
  v_cndmask_b32 v202, v212, v13, s[56:57]
  v_cndmask_b32 v203, v213, v15, s[56:57]
  buffer_store_dwordx4 v[200:203], v208, s[8:11], s30 offen offset:2048 sc1
  v_pk_mul_f32 v[88:89], v[88:89], v[198:199]
  v_pk_mul_f32 v[90:91], v[90:91], v[198:199]
  v_pk_mul_f32 v[92:93], v[92:93], v[198:199]
  v_pk_mul_f32 v[94:95], v[94:95], v[198:199]
  v_cvt_pk_bf16_f32 v16, v88, v89
  v_cvt_pk_bf16_f32 v17, v90, v91
  v_cvt_pk_bf16_f32 v18, v92, v93
  v_cvt_pk_bf16_f32 v19, v94, v95
  buffer_store_dwordx4 v[16:19], v208, s[8:11], s28 offen offset:3072 sc1
  v_cndmask_b32 v210, v17, v16, s[56:57]
  v_cndmask_b32 v211, v19, v18, s[56:57]
  v_mov_b32_dpp v212, v210 quad_perm:[1,0,3,2] row_mask:0xf bank_mask:0xf
  v_mov_b32_dpp v213, v211 quad_perm:[1,0,3,2] row_mask:0xf bank_mask:0xf
  v_cndmask_b32 v204, v16, v212, s[56:57]
  v_cndmask_b32 v205, v18, v213, s[56:57]
  v_cndmask_b32 v206, v212, v17, s[56:57]
  v_cndmask_b32 v207, v213, v19, s[56:57]
  buffer_store_dwordx4 v[204:207], v208, s[8:11], s30 offen offset:3072 sc1
  s_add_u32 s28, s28, 4096
  s_add_u32 s30, s30, 4096
  s_waitcnt vmcnt(40)
  v_pk_mul_f32 v[96:97], v[96:97], v[198:199]
  v_pk_mul_f32 v[98:99], v[98:99], v[198:199]
  v_pk_mul_f32 v[100:101], v[100:101], v[198:199]
  v_pk_mul_f32 v[102:103], v[102:103], v[198:199]
  v_cvt_pk_bf16_f32 v20, v96, v97
  v_cvt_pk_bf16_f32 v21, v98, v99
  v_cvt_pk_bf16_f32 v22, v100, v101
  v_cvt_pk_bf16_f32 v23, v102, v103
  buffer_store_dwordx4 v[20:23], v208, s[8:11], s28 offen offset:0 sc1
  v_cndmask_b32 v210, v21, v20, s[56:57]
  v_cndmask_b32 v211, v23, v22, s[56:57]
  v_mov_b32_dpp v212, v210 quad_perm:[1,0,3,2] row_mask:0xf bank_mask:0xf
  v_mov_b32_dpp v213, v211 quad_perm:[1,0,3,2] row_mask:0xf bank_mask:0xf
  v_cndmask_b32 v200, v20, v212, s[56:57]
  v_cndmask_b32 v201, v22, v213, s[56:57]
  v_cndmask_b32 v202, v212, v21, s[56:57]
  v_cndmask_b32 v203, v213, v23, s[56:57]
  buffer_store_dwordx4 v[200:203], v208, s[8:11], s30 offen offset:0 sc1
  v_pk_mul_f32 v[104:105], v[104:105], v[198:199]
  v_pk_mul_f32 v[106:107], v[106:107], v[198:199]
  v_pk_mul_f32 v[108:109], v[108:109], v[198:199]
  v_pk_mul_f32 v[110:111], v[110:111], v[198:199]
  v_cvt_pk_bf16_f32 v24, v104, v105
  v_cvt_pk_bf16_f32 v25, v106, v107
  v_cvt_pk_bf16_f32 v26, v108, v109
  v_cvt_pk_bf16_f32 v27, v110, v111
  buffer_store_dwordx4 v[24:27], v208, s[8:11], s28 offen offset:1024 sc1
  v_cndmask_b32 v210, v25, v24, s[56:57]
  v_cndmask_b32 v211, v27, v26, s[56:57]
  v_mov_b32_dpp v212, v210 quad_perm:[1,0,3,2] row_mask:0xf bank_mask:0xf
  v_mov_b32_dpp v213, v211 quad_perm:[1,0,3,2] row_mask:0xf bank_mask:0xf
  v_cndmask_b32 v204, v24, v212, s[56:57]
  v_cndmask_b32 v205, v26, v213, s[56:57]
  v_cndmask_b32 v206, v212, v25, s[56:57]
  v_cndmask_b32 v207, v213, v27, s[56:57]
  buffer_store_dwordx4 v[204:207], v208, s[8:11], s30 offen offset:1024 sc1
  v_pk_mul_f32 v[112:113], v[112:113], v[198:199]
  v_pk_mul_f32 v[114:115], v[114:115], v[198:199]
  v_pk_mul_f32 v[116:117], v[116:117], v[198:199]
  v_pk_mul_f32 v[118:119], v[118:119], v[198:199]
  v_cvt_pk_bf16_f32 v28, v112, v113
  v_cvt_pk_bf16_f32 v29, v114, v115
  v_cvt_pk_bf16_f32 v30, v116, v117
  v_cvt_pk_bf16_f32 v31, v118, v119
  buffer_store_dwordx4 v[28:31], v208, s[8:11], s28 offen offset:2048 sc1
  v_cndmask_b32 v210, v29, v28, s[56:57]
  v_cndmask_b32 v211, v31, v30, s[56:57]
  v_mov_b32_dpp v212, v210 quad_perm:[1,0,3,2] row_mask:0xf bank_mask:0xf
  v_mov_b32_dpp v213, v211 quad_perm:[1,0,3,2] row_mask:0xf bank_mask:0xf
  v_cndmask_b32 v200, v28, v212, s[56:57]
  v_cndmask_b32 v201, v30, v213, s[56:57]
  v_cndmask_b32 v202, v212, v29, s[56:57]
  v_cndmask_b32 v203, v213, v31, s[56:57]
  buffer_store_dwordx4 v[200:203], v208, s[8:11], s30 offen offset:2048 sc1
  v_pk_mul_f32 v[120:121], v[120:121], v[198:199]
  v_pk_mul_f32 v[122:123], v[122:123], v[198:199]
  v_pk_mul_f32 v[124:125], v[124:125], v[198:199]
  v_pk_mul_f32 v[126:127], v[126:127], v[198:199]
  v_cvt_pk_bf16_f32 v32, v120, v121
  v_cvt_pk_bf16_f32 v33, v122, v123
  v_cvt_pk_bf16_f32 v34, v124, v125
  v_cvt_pk_bf16_f32 v35, v126, v127
  buffer_store_dwordx4 v[32:35], v208, s[8:11], s28 offen offset:3072 sc1
  v_cndmask_b32 v210, v33, v32, s[56:57]
  v_cndmask_b32 v211, v35, v34, s[56:57]
  v_mov_b32_dpp v212, v210 quad_perm:[1,0,3,2] row_mask:0xf bank_mask:0xf
  v_mov_b32_dpp v213, v211 quad_perm:[1,0,3,2] row_mask:0xf bank_mask:0xf
  v_cndmask_b32 v204, v32, v212, s[56:57]
  v_cndmask_b32 v205, v34, v213, s[56:57]
  v_cndmask_b32 v206, v212, v33, s[56:57]
  v_cndmask_b32 v207, v213, v35, s[56:57]
  buffer_store_dwordx4 v[204:207], v208, s[8:11], s30 offen offset:3072 sc1
  s_add_u32 s28, s28, 4096
  s_add_u32 s30, s30, 4096
  s_waitcnt vmcnt(40)
  v_pk_mul_f32 v[128:129], v[128:129], v[198:199]
  v_pk_mul_f32 v[130:131], v[130:131], v[198:199]
  v_pk_mul_f32 v[132:133], v[132:133], v[198:199]
  v_pk_mul_f32 v[134:135], v[134:135], v[198:199]
  v_cvt_pk_bf16_f32 v36, v128, v129
  v_cvt_pk_bf16_f32 v37, v130, v131
  v_cvt_pk_bf16_f32 v38, v132, v133
  v_cvt_pk_bf16_f32 v39, v134, v135
  buffer_store_dwordx4 v[36:39], v208, s[8:11], s28 offen offset:0 sc1
  v_cndmask_b32 v210, v37, v36, s[56:57]
  v_cndmask_b32 v211, v39, v38, s[56:57]
  v_mov_b32_dpp v212, v210 quad_perm:[1,0,3,2] row_mask:0xf bank_mask:0xf
  v_mov_b32_dpp v213, v211 quad_perm:[1,0,3,2] row_mask:0xf bank_mask:0xf
  v_cndmask_b32 v200, v36, v212, s[56:57]
  v_cndmask_b32 v201, v38, v213, s[56:57]
  v_cndmask_b32 v202, v212, v37, s[56:57]
  v_cndmask_b32 v203, v213, v39, s[56:57]
  buffer_store_dwordx4 v[200:203], v208, s[8:11], s30 offen offset:0 sc1
  v_pk_mul_f32 v[136:137], v[136:137], v[198:199]
  v_pk_mul_f32 v[138:139], v[138:139], v[198:199]
  v_pk_mul_f32 v[140:141], v[140:141], v[198:199]
  v_pk_mul_f32 v[142:143], v[142:143], v[198:199]
  v_cvt_pk_bf16_f32 v40, v136, v137
  v_cvt_pk_bf16_f32 v41, v138, v139
  v_cvt_pk_bf16_f32 v42, v140, v141
  v_cvt_pk_bf16_f32 v43, v142, v143
  buffer_store_dwordx4 v[40:43], v208, s[8:11], s28 offen offset:1024 sc1
  v_cndmask_b32 v210, v41, v40, s[56:57]
  v_cndmask_b32 v211, v43, v42, s[56:57]
  v_mov_b32_dpp v212, v210 quad_perm:[1,0,3,2] row_mask:0xf bank_mask:0xf
  v_mov_b32_dpp v213, v211 quad_perm:[1,0,3,2] row_mask:0xf bank_mask:0xf
  v_cndmask_b32 v204, v40, v212, s[56:57]
  v_cndmask_b32 v205, v42, v213, s[56:57]
  v_cndmask_b32 v206, v212, v41, s[56:57]
  v_cndmask_b32 v207, v213, v43, s[56:57]
  buffer_store_dwordx4 v[204:207], v208, s[8:11], s30 offen offset:1024 sc1
  v_pk_mul_f32 v[144:145], v[144:145], v[198:199]
  v_pk_mul_f32 v[146:147], v[146:147], v[198:199]
  v_pk_mul_f32 v[148:149], v[148:149], v[198:199]
  v_pk_mul_f32 v[150:151], v[150:151], v[198:199]
  v_cvt_pk_bf16_f32 v44, v144, v145
  v_cvt_pk_bf16_f32 v45, v146, v147
  v_cvt_pk_bf16_f32 v46, v148, v149
  v_cvt_pk_bf16_f32 v47, v150, v151
  buffer_store_dwordx4 v[44:47], v208, s[8:11], s28 offen offset:2048 sc1
  v_cndmask_b32 v210, v45, v44, s[56:57]
  v_cndmask_b32 v211, v47, v46, s[56:57]
  v_mov_b32_dpp v212, v210 quad_perm:[1,0,3,2] row_mask:0xf bank_mask:0xf
  v_mov_b32_dpp v213, v211 quad_perm:[1,0,3,2] row_mask:0xf bank_mask:0xf
  v_cndmask_b32 v200, v44, v212, s[56:57]
  v_cndmask_b32 v201, v46, v213, s[56:57]
  v_cndmask_b32 v202, v212, v45, s[56:57]
  v_cndmask_b32 v203, v213, v47, s[56:57]
  buffer_store_dwordx4 v[200:203], v208, s[8:11], s30 offen offset:2048 sc1
  v_pk_mul_f32 v[152:153], v[152:153], v[198:199]
  v_pk_mul_f32 v[154:155], v[154:155], v[198:199]
  v_pk_mul_f32 v[156:157], v[156:157], v[198:199]
  v_pk_mul_f32 v[158:159], v[158:159], v[198:199]
  v_cvt_pk_bf16_f32 v48, v152, v153
  v_cvt_pk_bf16_f32 v49, v154, v155
  v_cvt_pk_bf16_f32 v50, v156, v157
  v_cvt_pk_bf16_f32 v51, v158, v159
  buffer_store_dwordx4 v[48:51], v208, s[8:11], s28 offen offset:3072 sc1
  v_cndmask_b32 v210, v49, v48, s[56:57]
  v_cndmask_b32 v211, v51, v50, s[56:57]
  v_mov_b32_dpp v212, v210 quad_perm:[1,0,3,2] row_mask:0xf bank_mask:0xf
  v_mov_b32_dpp v213, v211 quad_perm:[1,0,3,2] row_mask:0xf bank_mask:0xf
  v_cndmask_b32 v204, v48, v212, s[56:57]
  v_cndmask_b32 v205, v50, v213, s[56:57]
  v_cndmask_b32 v206, v212, v49, s[56:57]
  v_cndmask_b32 v207, v213, v51, s[56:57]
  buffer_store_dwordx4 v[204:207], v208, s[8:11], s30 offen offset:3072 sc1
  s_add_u32 s28, s28, 4096
  s_add_u32 s30, s30, 4096
  s_waitcnt vmcnt(40)
  v_pk_mul_f32 v[160:161], v[160:161], v[198:199]
  v_pk_mul_f32 v[162:163], v[162:163], v[198:199]
  v_pk_mul_f32 v[164:165], v[164:165], v[198:199]
  v_pk_mul_f32 v[166:167], v[166:167], v[198:199]
  v_cvt_pk_bf16_f32 v52, v160, v161
  v_cvt_pk_bf16_f32 v53, v162, v163
  v_cvt_pk_bf16_f32 v54, v164, v165
  v_cvt_pk_bf16_f32 v55, v166, v167
  buffer_store_dwordx4 v[52:55], v208, s[8:11], s28 offen offset:0 sc1
  v_cndmask_b32 v210, v53, v52, s[56:57]
  v_cndmask_b32 v211, v55, v54, s[56:57]
  v_mov_b32_dpp v212, v210 quad_perm:[1,0,3,2] row_mask:0xf bank_mask:0xf
  v_mov_b32_dpp v213, v211 quad_perm:[1,0,3,2] row_mask:0xf bank_mask:0xf
  v_cndmask_b32 v200, v52, v212, s[56:57]
  v_cndmask_b32 v201, v54, v213, s[56:57]
  v_cndmask_b32 v202, v212, v53, s[56:57]
  v_cndmask_b32 v203, v213, v55, s[56:57]
  buffer_store_dwordx4 v[200:203], v208, s[8:11], s30 offen offset:0 sc1
  v_pk_mul_f32 v[168:169], v[168:169], v[198:199]
  v_pk_mul_f32 v[170:171], v[170:171], v[198:199]
  v_pk_mul_f32 v[172:173], v[172:173], v[198:199]
  v_pk_mul_f32 v[174:175], v[174:175], v[198:199]
  v_cvt_pk_bf16_f32 v56, v168, v169
  v_cvt_pk_bf16_f32 v57, v170, v171
  v_cvt_pk_bf16_f32 v58, v172, v173
  v_cvt_pk_bf16_f32 v59, v174, v175
  buffer_store_dwordx4 v[56:59], v208, s[8:11], s28 offen offset:1024 sc1
  v_cndmask_b32 v210, v57, v56, s[56:57]
  v_cndmask_b32 v211, v59, v58, s[56:57]
  v_mov_b32_dpp v212, v210 quad_perm:[1,0,3,2] row_mask:0xf bank_mask:0xf
  v_mov_b32_dpp v213, v211 quad_perm:[1,0,3,2] row_mask:0xf bank_mask:0xf
  v_cndmask_b32 v204, v56, v212, s[56:57]
  v_cndmask_b32 v205, v58, v213, s[56:57]
  v_cndmask_b32 v206, v212, v57, s[56:57]
  v_cndmask_b32 v207, v213, v59, s[56:57]
  buffer_store_dwordx4 v[204:207], v208, s[8:11], s30 offen offset:1024 sc1
  s_cmp_lt_u32 s36, 2
  s_cbranch_scc1 L_ln_nopz
  s_sub_u32 s38, s36, 2
  s_lshl_b32 s59, s3, 10
  v_add_u32 v60, s59, v3
  s_waitcnt vmcnt(24)
  v_mov_b32 v216, -1
  v_mov_b32 v217, -1
  v_mov_b32 v218, -1
  v_mov_b32 v219, -1
  s_add_u32 s59, s38, 0
  s_cmp_ge_u32 s59, 312
  s_cbranch_scc1 L_pz_13
  s_mov_b32 s73, 66306048
  s_lshl_b32 s59, s59, 12
  s_add_u32 s59, s59, s73
  buffer_store_dwordx4 v[216:219], v60, s[8:11], s59 offen sc1
L_pz_13:
  s_add_u32 s59, s38, 30
  s_cmp_ge_u32 s59, 312
  s_cbranch_scc1 L_pz_14
  s_mov_b32 s73, 66306048
  s_cmp_ge_u32 s59, 36
  s_cselect_b32 s73, 62472192, s73
  s_lshl_b32 s59, s59, 12
  s_add_u32 s59, s59, s73
  buffer_store_dwordx4 v[216:219], v60, s[8:11], s59 offen sc1
L_pz_14:
  s_add_u32 s59, s38, 60
  s_cmp_ge_u32 s59, 312
  s_cbranch_scc1 L_pz_15
  s_mov_b32 s73, 62472192
  s_lshl_b32 s59, s59, 12
  s_add_u32 s59, s59, s73
  buffer_store_dwordx4 v[216:219], v60, s[8:11], s59 offen sc1
L_pz_15:
  s_add_u32 s59, s38, 90
  s_cmp_ge_u32 s59, 312
  s_cbranch_scc1 L_pz_16
  s_mov_b32 s73, 62472192
  s_lshl_b32 s59, s59, 12
  s_add_u32 s59, s59, s73
  buffer_store_dwordx4 v[216:219], v60, s[8:11], s59 offen sc1
L_pz_16:
  s_add_u32 s59, s38, 120
  s_cmp_ge_u32 s59, 312
  s_cbranch_scc1 L_pz_17
  s_mov_b32 s73, 62472192
  s_lshl_b32 s59, s59, 12
  s_add_u32 s59, s59, s73
  buffer_store_dwordx4 v[216:219], v60, s[8:11], s59 offen sc1
L_pz_17:
  s_add_u32 s59, s38, 150
  s_cmp_ge_u32 s59, 312
  s_cbranch_scc1 L_pz_18
  s_mov_b32 s73, 62472192
  s_lshl_b32 s59, s59, 12
  s_add_u32 s59, s59, s73
  buffer_store_dwordx4 v[216:219], v60, s[8:11], s59 offen sc1
L_pz_18:
  s_add_u32 s59, s38, 180
  s_cmp_ge_u32 s59, 312
  s_cbranch_scc1 L_pz_19
  s_mov_b32 s73, 62472192
  s_cmp_ge_u32 s59, 204
  s_cselect_b32 s73, 67366912, s73
  s_lshl_b32 s59, s59, 12
  s_add_u32 s59, s59, s73
  buffer_store_dwordx4 v[216:219], v60, s[8:11], s59 offen sc1
L_pz_19:
  s_add_u32 s59, s38, 210
  s_cmp_ge_u32 s59, 312
  s_cbranch_scc1 L_pz_20
  s_mov_b32 s73, 67366912
  s_cmp_ge_u32 s59, 225
  s_cselect_b32 s73, 67585536, s73
  s_cmp_ge_u32 s59, 228
  s_cselect_b32 s73, 74579968, s73
  s_lshl_b32 s59, s59, 12
  s_add_u32 s59, s59, s73
  buffer_store_dwordx4 v[216:219], v60, s[8:11], s59 offen sc1
L_pz_20:
  s_add_u32 s59, s38, 240
  s_cmp_ge_u32 s59, 312
  s_cbranch_scc1 L_pz_21
  s_mov_b32 s73, 74579968
  s_lshl_b32 s59, s59, 12
  s_add_u32 s59, s59, s73
  buffer_store_dwordx4 v[216:219], v60, s[8:11], s59 offen sc1
L_pz_21:
  s_add_u32 s59, s38, 270
  s_cmp_ge_u32 s59, 312
  s_cbranch_scc1 L_pz_22
  s_mov_b32 s73, 74579968
  s_lshl_b32 s59, s59, 12
  s_add_u32 s59, s59, s73
  buffer_store_dwordx4 v[216:219], v60, s[8:11], s59 offen sc1
L_pz_22:
  s_add_u32 s59, s38, 300
  s_cmp_ge_u32 s59, 312
  s_cbranch_scc1 L_pz_23
  s_mov_b32 s73, 74579968
  s_lshl_b32 s59, s59, 12
  s_add_u32 s59, s59, s73
  buffer_store_dwordx4 v[216:219], v60, s[8:11], s59 offen sc1
L_pz_23:
L_ln_nopz:
  s_add_u32 s16, s36, 224
  s_lshl_b32 s16, s16, 7
  s_add_u32 s16, s16, 77721600
  v_mov_b32 v4, s98
  v_lshrrev_b32 v5, 2, v3
  v_and_b32 v5, 124, v5
  s_cmp_eq_u32 s3, 0
  s_waitcnt vmcnt(0)
  s_barrier
  s_cbranch_scc0 L_ln_noflag
  buffer_store_dword v4, v5, s[8:11], s16 offen sc1
L_ln_noflag:
L_no_ln:
  s_lshr_b32 s28, s4, 5
  s_and_b32 s29, s4, 31
  s_cmp_eq_u32 s28, 0
  s_cbranch_scc0 L_not_chain
  s_cmp_lt_u32 s29, 16
  s_cbranch_scc1 L_go_24
  s_cmp_lt_u32 s29, 30
  s_cbranch_scc1 L_go_25
  s_cmp_eq_u32 s29, 30
  s_cbranch_scc1 L_go_26
  s_branch L_chain_g
L_not_chain:
  s_cmp_lt_u32 s28, 5
  s_cbranch_scc0 L_not_yx
  s_sub_u32 s30, s28, 1
  s_lshl_b32 s30, s30, 2
  s_and_b32 s31, s29, 3
  s_add_u32 s30, s30, s31
  s_lshr_b32 s31, s29, 2
  s_cmp_lt_u32 s29, 12
  s_cbranch_scc1 L_go_27
  s_sub_u32 s31, s31, 3
  s_cmp_lt_u32 s29, 24
  s_cbranch_scc1 L_go_28
  s_sub_u32 s30, s28, 1
  s_mul_i32 s30, s30, 7
  s_add_u32 s30, s30, s29
  s_sub_u32 s30, s30, 24
  s_mov_b32 s31, 1
  s_cmp_lt_u32 s29, 31
  s_cbranch_scc1 L_go_29
  s_sub_u32 s30, s28, 1
  s_branch L_go_z
L_not_yx:
  s_mov_b32 s30, s29
  s_mov_b32 s31, 0
  s_cmp_eq_u32 s28, 7
  s_cbranch_scc0 L_not_f1
  s_cmp_lt_u32 s29, 28
  s_cbranch_scc1 L_go_30
  s_sub_u32 s30, s29, 16
  s_branch L_go_z
L_not_f1:
  s_sub_u32 s31, s28, 5
  s_cmp_lt_u32 s29, 14
  s_cbranch_scc1 L_go_31
  s_cmp_lt_u32 s29, 28
  s_cbranch_scc0 L_not_f2
  s_sub_u32 s30, s29, 14
  s_sub_u32 s33, s30, 7
  s_cmp_ge_u32 s30, 7
  s_cselect_b32 s30, s33, s30
  s_cselect_b32 s33, 1, 0
  s_lshl_b32 s30, s30, 1
  s_add_u32 s30, s30, s31
  s_mov_b32 s31, s33
  s_branch L_f2
L_not_f2:
  s_lshl_b32 s30, s31, 2
  s_add_u32 s30, s30, s29
  s_sub_u32 s30, s30, 24
L_go_z:
  s_branch L_z
L_exit:
  s_endpgm
L_go_24:
  s_branch L_chain_a
L_go_25:
  s_branch L_chain_b
L_go_26:
  s_branch L_chain_f
L_go_27:
  s_branch L_y
L_go_28:
  s_branch L_x1
L_go_29:
  s_branch L_f1
L_go_30:
  s_branch L_f1
L_go_31:
  s_branch L_x2
L_timeout:
  s_mov_b64 exec, -1
  s_add_u32 s29, s4, 0x1000
  v_mov_b32 v1, s29
  v_mov_b32 v2, 72
  buffer_store_dword v1, v2, s[12:15], 0 offen
  s_endpgm
L_chain_a:
  s_and_b32 s51, s3, 1
  s_mul_i32 s33, s3, 7
  s_add_u32 s50, s33, s51
  s_lshr_b32 s50, s50, 1
  s_lshl_b32 s52, s3, 15
  s_mov_b32 s49, s52
  s_lshl_b32 s47, s50, 10
  s_add_u32 s47, s47, 14680064
  s_mul_i32 s33, s51, 4092
  s_sub_u32 s48, s47, s33
  s_mul_i32 s34, s4, 401408
  s_mul_i32 s33, s3, 100352
  s_add_u32 s34, s34, s33
  s_mul_i32 s35, s51, 14336
  s_add_u32 s35, s35, s34
  s_add_u32 s36, s34, 86016
  s_cmp_eq_u32 s51, 0
  s_cselect_b32 s36, s36, s34
  s_mul_i32 s33, s4, 7
  v_min_u32 v4, 6, v0
  v_add_u32 v4, s33, v4
  s_lshl_b32 s57, s3, 11
  s_add_u32 s56, s57, 24576
  s_add_u32 s57, s57, 46399488
  v_lshlrev_b32 v4, 7, v4
  v_add_u32 v4, 1863680, v4
  v_and_b32 v5, 1, v0
  v_lshlrev_b32 v5, 7, v5
  v_add_u32 v5, 1892352, v5
  v_cmp_gt_u32 vcc, 32, v0
  s_nop 1
  v_cndmask_b32 v4, v5, v4, vcc
  s_mov_b32 s38, 0
  s_mov_b32 s39, 75857920
L_lp_32:
  buffer_load_dwordx2 v[6:7], v4, s[8:11], s39 offen sc1
  s_add_u32 s6, s6, 1
  s_cmp_gt_u32 s6, 262144
  s_cbranch_scc1 L_timeout
  s_waitcnt vmcnt(0)
  v_cmp_eq_u32 vcc, s98, v6
  v_cmp_eq_u32 s[42:43], s98, v7
  s_and_b64 vcc, vcc, s[42:43]
  s_and_b32 s40, vcc_lo, 127
  s_cmp_eq_u32 vcc_hi, -1
  s_cselect_b32 s42, 128, 0
  s_or_b32 s40, s40, s42
  s_andn2_b32 s40, s40, s38
  s_bitcmp1_b32 s40, 0
  s_cbranch_scc0 L_lps_33
  s_waitcnt vmcnt(49)
  s_add_u32 s41, s35, 0
  buffer_load_dwordx4 a[0:3], v3, s[8:11], s41 offen offset:0 sc1
  buffer_load_dwordx4 a[4:7], v3, s[8:11], s41 offen offset:1024 sc1
  s_add_u32 s41, s35, 14336
  buffer_load_dwordx4 a[56:59], v3, s[8:11], s41 offen offset:0 sc1
  buffer_load_dwordx4 a[60:63], v3, s[8:11], s41 offen offset:1024 sc1
  s_add_u32 s41, s35, 28672
  buffer_load_dwordx4 a[112:115], v3, s[8:11], s41 offen offset:0 sc1
  buffer_load_dwordx4 a[116:119], v3, s[8:11], s41 offen offset:1024 sc1
  s_add_u32 s41, s35, 43008
  buffer_load_dwordx4 a[168:171], v3, s[8:11], s41 offen offset:0 sc1
  buffer_load_dwordx4 a[172:175], v3, s[8:11], s41 offen offset:1024 sc1
  s_add_u32 s41, s35, 57344
  buffer_load_dwordx4 a[224:227], v3, s[8:11], s41 offen offset:0 sc1
  buffer_load_dwordx4 a[228:231], v3, s[8:11], s41 offen offset:1024 sc1
  s_add_u32 s41, s35, 71680
  buffer_load_dwordx4 v[144:147], v3, s[8:11], s41 offen offset:0 sc1
  buffer_load_dwordx4 v[148:151], v3, s[8:11], s41 offen offset:1024 sc1
  s_add_u32 s41, s36, 0
  buffer_load_dwordx4 v[200:203], v3, s[8:11], s41 offen offset:0 sc1
  buffer_load_dwordx4 v[204:207], v3, s[8:11], s41 offen offset:1024 sc1
L_lps_33:
  s_bitcmp1_b32 s40, 1
  s_cbranch_scc0 L_lps_34
  s_waitcnt vmcnt(49)
  s_add_u32 s41, s35, 2048
  buffer_load_dwordx4 a[8:11], v3, s[8:11], s41 offen offset:0 sc1
  buffer_load_dwordx4 a[12:15], v3, s[8:11], s41 offen offset:1024 sc1
  s_add_u32 s41, s35, 16384
  buffer_load_dwordx4 a[64:67], v3, s[8:11], s41 offen offset:0 sc1
  buffer_load_dwordx4 a[68:71], v3, s[8:11], s41 offen offset:1024 sc1
  s_add_u32 s41, s35, 30720
  buffer_load_dwordx4 a[120:123], v3, s[8:11], s41 offen offset:0 sc1
  buffer_load_dwordx4 a[124:127], v3, s[8:11], s41 offen offset:1024 sc1
  s_add_u32 s41, s35, 45056
  buffer_load_dwordx4 a[176:179], v3, s[8:11], s41 offen offset:0 sc1
  buffer_load_dwordx4 a[180:183], v3, s[8:11], s41 offen offset:1024 sc1
  s_add_u32 s41, s35, 59392
  buffer_load_dwordx4 a[232:235], v3, s[8:11], s41 offen offset:0 sc1
  buffer_load_dwordx4 a[236:239], v3, s[8:11], s41 offen offset:1024 sc1
  s_add_u32 s41, s35, 73728
  buffer_load_dwordx4 v[152:155], v3, s[8:11], s41 offen offset:0 sc1
  buffer_load_dwordx4 v[156:159], v3, s[8:11], s41 offen offset:1024 sc1
  s_add_u32 s41, s36, 2048
  buffer_load_dwordx4 v[208:211], v3, s[8:11], s41 offen offset:0 sc1
  buffer_load_dwordx4 v[212:215], v3, s[8:11], s41 offen offset:1024 sc1
L_lps_34:
  s_bitcmp1_b32 s40, 2
  s_cbranch_scc0 L_lps_35
  s_waitcnt vmcnt(49)
  s_add_u32 s41, s35, 4096
  buffer_load_dwordx4 a[16:19], v3, s[8:11], s41 offen offset:0 sc1
  buffer_load_dwordx4 a[20:23], v3, s[8:11], s41 offen offset:1024 sc1
  s_add_u32 s41, s35, 18432
  buffer_load_dwordx4 a[72:75], v3, s[8:11], s41 offen offset:0 sc1
  buffer_load_dwordx4 a[76:79], v3, s[8:11], s41 offen offset:1024 sc1
  s_add_u32 s41, s35, 32768
  buffer_load_dwordx4 a[128:131], v3, s[8:11], s41 offen offset:0 sc1
  buffer_load_dwordx4 a[132:135], v3, s[8:11], s41 offen offset:1024 sc1
  s_add_u32 s41, s35, 47104
  buffer_load_dwordx4 a[184:187], v3, s[8:11], s41 offen offset:0 sc1
  buffer_load_dwordx4 a[188:191], v3, s[8:11], s41 offen offset:1024 sc1
  s_add_u32 s41, s35, 61440
  buffer_load_dwordx4 a[240:243], v3, s[8:11], s41 offen offset:0 sc1
  buffer_load_dwordx4 a[244:247], v3, s[8:11], s41 offen offset:1024 sc1
  s_add_u32 s41, s35, 75776
  buffer_load_dwordx4 v[160:163], v3, s[8:11], s41 offen offset:0 sc1
  buffer_load_dwordx4 v[164:167], v3, s[8:11], s41 offen offset:1024 sc1
  s_add_u32 s41, s36, 4096
  buffer_load_dwordx4 v[216:219], v3, s[8:11], s41 offen offset:0 sc1
  buffer_load_dwordx4 v[220:223], v3, s[8:11], s41 offen offset:1024 sc1
L_lps_35:
  s_bitcmp1_b32 s40, 3
  s_cbranch_scc0 L_lps_36
  s_waitcnt vmcnt(49)
  s_add_u32 s41, s35, 6144
  buffer_load_dwordx4 a[24:27], v3, s[8:11], s41 offen offset:0 sc1
  buffer_load_dwordx4 a[28:31], v3, s[8:11], s41 offen offset:1024 sc1
  s_add_u32 s41, s35, 20480
  buffer_load_dwordx4 a[80:83], v3, s[8:11], s41 offen offset:0 sc1
  buffer_load_dwordx4 a[84:87], v3, s[8:11], s41 offen offset:1024 sc1
  s_add_u32 s41, s35, 34816
  buffer_load_dwordx4 a[136:139], v3, s[8:11], s41 offen offset:0 sc1
  buffer_load_dwordx4 a[140:143], v3, s[8:11], s41 offen offset:1024 sc1
  s_add_u32 s41, s35, 49152
  buffer_load_dwordx4 a[192:195], v3, s[8:11], s41 offen offset:0 sc1
  buffer_load_dwordx4 a[196:199], v3, s[8:11], s41 offen offset:1024 sc1
  s_add_u32 s41, s35, 63488
  buffer_load_dwordx4 a[248:251], v3, s[8:11], s41 offen offset:0 sc1
  buffer_load_dwordx4 a[252:255], v3, s[8:11], s41 offen offset:1024 sc1
  s_add_u32 s41, s35, 77824
  buffer_load_dwordx4 v[168:171], v3, s[8:11], s41 offen offset:0 sc1
  buffer_load_dwordx4 v[172:175], v3, s[8:11], s41 offen offset:1024 sc1
  s_add_u32 s41, s36, 6144
  buffer_load_dwordx4 v[224:227], v3, s[8:11], s41 offen offset:0 sc1
  buffer_load_dwordx4 v[228:231], v3, s[8:11], s41 offen offset:1024 sc1
L_lps_36:
  s_bitcmp1_b32 s40, 4
  s_cbranch_scc0 L_lps_37
  s_waitcnt vmcnt(49)
  s_add_u32 s41, s35, 8192
  buffer_load_dwordx4 a[32:35], v3, s[8:11], s41 offen offset:0 sc1
  buffer_load_dwordx4 a[36:39], v3, s[8:11], s41 offen offset:1024 sc1
  s_add_u32 s41, s35, 22528
  buffer_load_dwordx4 a[88:91], v3, s[8:11], s41 offen offset:0 sc1
  buffer_load_dwordx4 a[92:95], v3, s[8:11], s41 offen offset:1024 sc1
  s_add_u32 s41, s35, 36864
  buffer_load_dwordx4 a[144:147], v3, s[8:11], s41 offen offset:0 sc1
  buffer_load_dwordx4 a[148:151], v3, s[8:11], s41 offen offset:1024 sc1
  s_add_u32 s41, s35, 51200
  buffer_load_dwordx4 a[200:203], v3, s[8:11], s41 offen offset:0 sc1
  buffer_load_dwordx4 a[204:207], v3, s[8:11], s41 offen offset:1024 sc1
  s_add_u32 s41, s35, 65536
  buffer_load_dwordx4 v[120:123], v3, s[8:11], s41 offen offset:0 sc1
  buffer_load_dwordx4 v[124:127], v3, s[8:11], s41 offen offset:1024 sc1
  s_add_u32 s41, s35, 79872
  buffer_load_dwordx4 v[176:179], v3, s[8:11], s41 offen offset:0 sc1
  buffer_load_dwordx4 v[180:183], v3, s[8:11], s41 offen offset:1024 sc1
  s_add_u32 s41, s36, 8192
  buffer_load_dwordx4 v[232:235], v3, s[8:11], s41 offen offset:0 sc1
  buffer_load_dwordx4 v[236:239], v3, s[8:11], s41 offen offset:1024 sc1
L_lps_37:
  s_bitcmp1_b32 s40, 5
  s_cbranch_scc0 L_lps_38
  s_waitcnt vmcnt(49)
  s_add_u32 s41, s35, 10240
  buffer_load_dwordx4 a[40:43], v3, s[8:11], s41 offen offset:0 sc1
  buffer_load_dwordx4 a[44:47], v3, s[8:11], s41 offen offset:1024 sc1
  s_add_u32 s41, s35, 24576
  buffer_load_dwordx4 a[96:99], v3, s[8:11], s41 offen offset:0 sc1
  buffer_load_dwordx4 a[100:103], v3, s[8:11], s41 offen offset:1024 sc1
  s_add_u32 s41, s35, 38912
  buffer_load_dwordx4 a[152:155], v3, s[8:11], s41 offen offset:0 sc1
  buffer_load_dwordx4 a[156:159], v3, s[8:11], s41 offen offset:1024 sc1
  s_add_u32 s41, s35, 53248
  buffer_load_dwordx4 a[208:211], v3, s[8:11], s41 offen offset:0 sc1
  buffer_load_dwordx4 a[212:215], v3, s[8:11], s41 offen offset:1024 sc1
  s_add_u32 s41, s35, 67584
  buffer_load_dwordx4 v[128:131], v3, s[8:11], s41 offen offset:0 sc1
  buffer_load_dwordx4 v[132:135], v3, s[8:11], s41 offen offset:1024 sc1
  s_add_u32 s41, s35, 81920
  buffer_load_dwordx4 v[184:187], v3, s[8:11], s41 offen offset:0 sc1
  buffer_load_dwordx4 v[188:191], v3, s[8:11], s41 offen offset:1024 sc1
  s_add_u32 s41, s36, 10240
  buffer_load_dwordx4 v[240:243], v3, s[8:11], s41 offen offset:0 sc1
  buffer_load_dwordx4 v[244:247], v3, s[8:11], s41 offen offset:1024 sc1
L_lps_38:
  s_bitcmp1_b32 s40, 6
  s_cbranch_scc0 L_lps_39
  s_waitcnt vmcnt(49)
  s_add_u32 s41, s35, 12288
  buffer_load_dwordx4 a[48:51], v3, s[8:11], s41 offen offset:0 sc1
  buffer_load_dwordx4 a[52:55], v3, s[8:11], s41 offen offset:1024 sc1
  s_add_u32 s41, s35, 26624
  buffer_load_dwordx4 a[104:107], v3, s[8:11], s41 offen offset:0 sc1
  buffer_load_dwordx4 a[108:111], v3, s[8:11], s41 offen offset:1024 sc1
  s_add_u32 s41, s35, 40960
  buffer_load_dwordx4 a[160:163], v3, s[8:11], s41 offen offset:0 sc1
  buffer_load_dwordx4 a[164:167], v3, s[8:11], s41 offen offset:1024 sc1
  s_add_u32 s41, s35, 55296
  buffer_load_dwordx4 a[216:219], v3, s[8:11], s41 offen offset:0 sc1
  buffer_load_dwordx4 a[220:223], v3, s[8:11], s41 offen offset:1024 sc1
  s_add_u32 s41, s35, 69632
  buffer_load_dwordx4 v[136:139], v3, s[8:11], s41 offen offset:0 sc1
  buffer_load_dwordx4 v[140:143], v3, s[8:11], s41 offen offset:1024 sc1
  s_add_u32 s41, s35, 83968
  buffer_load_dwordx4 v[192:195], v3, s[8:11], s41 offen offset:0 sc1
  buffer_load_dwordx4 v[196:199], v3, s[8:11], s41 offen offset:1024 sc1
  s_add_u32 s41, s36, 12288
  buffer_load_dwordx4 v[248:251], v3, s[8:11], s41 offen offset:0 sc1
  buffer_load_dwordx4 v[252:255], v3, s[8:11], s41 offen offset:1024 sc1
L_lps_39:
  s_bitcmp1_b32 s40, 7
  s_cbranch_scc0 L_lps_40
  s_waitcnt vmcnt(53)
  s_add_u32 s33, s49, 0
  s_mov_b32 m0, s33
  s_add_u32 s34, s47, 0
  buffer_load_dwordx4 v3, s[8:11], s34 offen offset:0 sc1 lds
  buffer_load_dwordx4 v3, s[8:11], s34 offen offset:1024 sc1 lds
  buffer_load_dwordx4 v3, s[8:11], s34 offen offset:2048 sc1 lds
  s_add_u32 s34, s48, 0
  buffer_load_dwordx4 v3, s[8:11], s34 offen offset:3072 sc1 lds
  s_add_u32 s33, s49, 4096
  s_mov_b32 m0, s33
  s_add_u32 s34, s47, 14336
  buffer_load_dwordx4 v3, s[8:11], s34 offen offset:0 sc1 lds
  buffer_load_dwordx4 v3, s[8:11], s34 offen offset:1024 sc1 lds
  buffer_load_dwordx4 v3, s[8:11], s34 offen offset:2048 sc1 lds
  s_add_u32 s34, s48, 14336
  buffer_load_dwordx4 v3, s[8:11], s34 offen offset:3072 sc1 lds
  s_mov_b32 m0, s56
  s_nop 0
  buffer_load_dwordx4 v3, s[8:11], s57 offen sc1 lds
  s_cmp_eq_u32 s3, 3
  s_cbranch_scc1 L_f3_41
  buffer_load_dwordx4 v3, s[8:11], s57 offen offset:1024 sc1 lds
L_f3_41:
L_lps_40:
  s_or_b32 s38, s38, s40
  s_and_b32 s38, s38, 255
  s_cmp_eq_u32 s38, 255
  s_cbranch_scc1 L_lpo_42
  s_sleep 2
  s_branch L_lp_32
L_lpo_42:
  v_mov_b32 v108, 0x44444444
  v_mov_b32 v4, 0xeeeeeeee
  v_cmp_gt_u32 vcc, 8, v1
  s_nop 1
  v_cndmask_b32 v108, v4, v108, vcc
  v_and_b32 v4, 7, v1
  v_lshlrev_b32 v4, 4, v4
  v_lshl_add_u32 v4, v2, 7, v4
  s_lshl_b32 s33, s50, 9
  v_add_u32 v113, s33, v4
  s_mul_i32 s34, s51, 2044
  s_sub_u32 s34, 26112, s34
  v_add_u32 v114, s34, v113
  v_lshrrev_b32 v4, 1, v2
  v_lshlrev_b32 v4, 3, v4
  v_xor_b32 v4, v4, v1
  v_lshlrev_b32 v4, 3, v4
  v_lshl_add_u32 v4, v2, 7, v4
  v_add_u32 v115, s52, v4
  s_add_u32 s34, s52, 19456
  v_lshrrev_b32 v4, 5, v0
  v_lshlrev_b32 v4, 2, v4
  v_xor_b32 v4, v4, v0
  v_lshlrev_b32 v4, 3, v4
  v_add_u32 v116, s34, v4
  v_xor_b32 v117, 64, v116
  v_add_u32 v117, 512, v117
  v_lshrrev_b32 v4, 2, v1
  v_and_b32 v5, 3, v1
  v_lshrrev_b32 v6, 1, v2
  v_lshrrev_b32 v8, 1, v5
  v_xor_b32 v6, v6, v8
  v_lshlrev_b32 v6, 3, v6
  v_and_b32 v7, 1, v2
  v_lshl_add_u32 v6, v7, 1, v6
  v_and_b32 v7, 1, v4
  v_add_u32 v6, v6, v7
  v_lshrrev_b32 v7, 1, v4
  v_lshlrev_b32 v6, 3, v6
  v_lshl_add_u32 v6, v7, 9, v6
  v_lshl_add_u32 v6, v5, 7, v6
  v_add_u32 v118, s52, v6
  v_lshrrev_b32 v6, 1, v2
  v_xor_b32 v6, v6, v8
  v_lshlrev_b32 v6, 3, v6
  v_and_b32 v7, 1, v2
  v_lshl_add_u32 v6, v7, 1, v6
  v_and_b32 v7, 1, v4
  v_add_u32 v6, v6, v7
  v_lshrrev_b32 v9, 1, v4
  v_lshl_add_u32 v6, v9, 2, v6
  v_lshlrev_b32 v6, 3, v6
  v_lshl_add_u32 v6, v8, 9, v6
  v_lshl_add_u32 v6, v9, 8, v6
  v_and_b32 v7, 1, v5
  v_lshl_add_u32 v6, v7, 7, v6
  v_add_u32 v119, s34, v6
  v_xor_b32 v110, 32, v119
  s_lshl_b32 s33, s51, 2
  v_add_u32 v4, s33, v2
  v_lshrrev_b32 v5, 2, v1
  v_lshlrev_b32 v5, 7, v5
  v_and_b32 v6, 3, v1
  v_lshl_add_u32 v5, v6, 2, v5
  v_lshl_add_u32 v106, v4, 4, v5
  v_lshlrev_b32 v4, 4, v4
  v_lshl_add_u32 v4, v1, 1, v4
  v_add_u32 v4, 512, v4
  v_and_b32 v5, 9, v1
  v_cmp_eq_u32 vcc, 0, v5
  v_mov_b32 v5, 1073741824
  s_nop 0
  v_cndmask_b32 v107, v5, v4, vcc
  v_lshrrev_b32 v4, 1, v2
  v_lshlrev_b32 v4, 5, v4
  v_add_u32 v4, v4, v1
  s_lshl_b32 s33, s51, 4
  v_add_u32 v4, s33, v4
  v_lshlrev_b32 v4, 3, v4
  v_and_b32 v5, 1, v2
  v_lshl_add_u32 v4, v5, 2, v4
  v_add_u32 v13, 57344, v4
  v_lshlrev_b32 v14, 3, v0
  s_lshl_b32 s33, s3, 11
  v_add_u32 v14, s33, v14
  s_cmp_eq_u32 s3, 3
  s_cselect_b32 s34, 7, 15
  v_min_u32 v112, s34, v1
  v_lshlrev_b32 v112, 2, v112
  s_lshl_b32 s33, s4, 2
  s_add_u32 s33, s33, s3
  s_lshl_b32 s33, s33, 7
  v_add_u32 v112, s33, v112
  s_mov_b32 s54, 47579136
  s_mov_b32 s53, 0
  v_and_b32 v5, 1, v1
  v_lshlrev_b32 v5, 3, v5
  v_lshrrev_b32 v6, 3, v1
  v_lshl_add_u32 v5, v6, 2, v5
  v_and_b32 v6, 2, v1
  v_add_u32 v5, v5, v6
  v_bfe_u32 v6, v1, 2, 1
  v_add_u32 v5, v5, v6
  v_lshrrev_b32 v4, 3, v5
  v_lshlrev_b32 v4, 1, v4
  v_xor_b32 v4, v4, v2
  v_lshl_add_u32 v4, v5, 2, v4
  v_lshlrev_b32 v12, 4, v4
  v_add_u32 v12, s52, v12
  v_mov_b32 v0, v12
  v_mov_b32 v1, v14
  v_mov_b32 v2, v13
  s_mov_b32 s44, 0
  s_mov_b32 s45, 46399488
  s_mul_i32 s46, s4, 640
  s_add_u32 s46, s46, 46923776
  s_lshl_b32 s72, s4, 2
  s_add_u32 s72, s72, 8192
  s_mul_i32 s55, s4, 28672
  s_mul_i32 s33, s3, 7168
  s_add_u32 s55, s55, s33
  s_add_u32 s55, s55, 17432576
  v_mov_b64 v[32:33], 0
  v_mov_b64 v[34:35], 0
  v_mov_b64 v[36:37], 0
  v_mov_b64 v[38:39], 0
  v_mov_b64 v[40:41], 0
  v_mov_b64 v[42:43], 0
  v_mov_b64 v[44:45], 0
  v_mov_b64 v[46:47], 0
  v_mov_b64 v[48:49], 0
  v_mov_b64 v[50:51], 0
  v_mov_b64 v[52:53], 0
  v_mov_b64 v[54:55], 0
  v_mov_b64 v[56:57], 0
  v_mov_b64 v[58:59], 0
  v_lshlrev_b32 v104, 3, v3
  v_lshlrev_b32 v4, 3, v3
  v_mov_b32 v5, 68
  v_min_u32 v7, 4224, v4
L_ws_44:
  s_mov_b32 s35, 77721600
  buffer_load_dwordx2 v[8:9], v4, s[8:11], s35 offen sc1
  s_mov_b32 s35, 77729792
  buffer_load_dwordx2 v[10:11], v4, s[8:11], s35 offen sc1
  s_mov_b32 s35, 77737984
  buffer_load_dwordx2 v[12:13], v4, s[8:11], s35 offen sc1
  s_mov_b32 s35, 77746176
  buffer_load_dwordx2 v[14:15], v7, s[8:11], s35 offen sc1
  buffer_load_dword v6, v5, s[12:15], 0 offen sc1
  s_add_u32 s6, s6, 1
  s_cmp_gt_u32 s6, 262144
  s_cbranch_scc1 L_timeout
  s_waitcnt vmcnt(0)
  v_readfirstlane_b32 s34, v6
  v_cmp_ne_u32 vcc, s98, v8
  v_cmp_ne_u32 s[36:37], s98, v9
  s_or_b64 vcc, vcc, s[36:37]
  v_cmp_ne_u32 s[36:37], s98, v10
  s_or_b64 vcc, vcc, s[36:37]
  v_cmp_ne_u32 s[36:37], s98, v11
  s_or_b64 vcc, vcc, s[36:37]
  v_cmp_ne_u32 s[36:37], s98, v12
  s_or_b64 vcc, vcc, s[36:37]
  v_cmp_ne_u32 s[36:37], s98, v13
  s_or_b64 vcc, vcc, s[36:37]
  v_cmp_ne_u32 s[36:37], s98, v14
  s_or_b64 vcc, vcc, s[36:37]
  v_cmp_ne_u32 s[36:37], s98, v15
  s_or_b64 vcc, vcc, s[36:37]
  s_cbranch_vccnz L_ws_44
  s_and_b32 s35, s34, 0xff
  s_cmp_eq_u32 s35, 32
  s_cbranch_scc0 L_ws_44
  s_waitcnt lgkmcnt(0)
  s_lshr_b32 s34, s34, 8
  s_cmp_eq_u32 s34, 0
  s_cbranch_scc0 L_a_slow_43
  s_branch L_a_poll_48
.p2align 6
  s_nop 0
  s_nop 0
L_a_top_45:
  buffer_load_dword v68, v112, s[8:11], s54 offen offset:0 sc1
  buffer_load_dword v69, v112, s[8:11], s54 offen offset:0 sc1
  buffer_load_dword v70, v112, s[8:11], s54 offen offset:0 sc1
  v_mov_b64 v[32:33], 0
  v_mov_b64 v[34:35], 0
  v_mov_b64 v[36:37], 0
  v_mov_b64 v[38:39], 0
  v_mov_b64 v[40:41], 0
  v_mov_b64 v[42:43], 0
  v_mov_b64 v[44:45], 0
  v_mov_b64 v[46:47], 0
  v_mov_b64 v[48:49], 0
  v_mov_b64 v[50:51], 0
  v_mov_b64 v[52:53], 0
  v_mov_b64 v[54:55], 0
  v_mov_b64 v[56:57], 0
  v_mov_b64 v[58:59], 0
  v_lshlrev_b32 v104, 3, v3
  s_mov_b32 m0, s56
L_nw_52:
  s_add_u32 s6, s6, 1
  s_cmp_gt_u32 s6, 262144
  s_cbranch_scc1 L_timeout
  buffer_load_dword v71, v112, s[8:11], s54 offen offset:0 sc1
  s_waitcnt vmcnt(3)
  v_cmp_ne_u32 vcc, s98, v68
  s_cbranch_vccz L_nok_53
  buffer_load_dword v68, v112, s[8:11], s54 offen offset:0 sc1
  s_waitcnt vmcnt(3)
  v_cmp_ne_u32 vcc, s98, v69
  s_cbranch_vccz L_nok_53
  buffer_load_dword v69, v112, s[8:11], s54 offen offset:0 sc1
  s_waitcnt vmcnt(3)
  v_cmp_ne_u32 vcc, s98, v70
  s_cbranch_vccz L_nok_53
  buffer_load_dword v70, v112, s[8:11], s54 offen offset:0 sc1
  s_waitcnt vmcnt(3)
  v_cmp_ne_u32 vcc, s98, v71
  s_cbranch_vccnz L_nw_52
L_nok_53:
  buffer_load_dwordx4 v3, s[8:11], s57 offen sc1 lds
  s_cmp_eq_u32 s3, 3
  s_cbranch_scc1 L_f3_54
  buffer_load_dwordx4 v3, s[8:11], s57 offen offset:1024 sc1 lds
L_f3_54:
L_a_poll_48:
  s_waitcnt vmcnt(0)
  s_barrier
  ds_read_b128 v[4:7], v3 offset:24576
  ds_read_b128 v[8:11], v3 offset:25600
  ds_read_b128 v[12:15], v3 offset:26624
  ds_read_b128 v[16:19], v3 offset:27648
  ds_read_b128 v[20:23], v3 offset:28672
  ds_read_b128 v[24:27], v3 offset:29696
  ds_read_b128 v[28:31], v3 offset:30720
  s_add_u32 s33, s52, 24320
  s_mov_b32 m0, s33
  s_nop 0
  buffer_load_dword v104, s[8:11], s55 offen offset:0 sc1 lds
  s_waitcnt lgkmcnt(6)
  v_smfmac_f32_16x16x64_bf16 v[32:35], v[4:7], a[0:7], v108
  s_nop 1
  s_waitcnt lgkmcnt(5)
  v_smfmac_f32_16x16x64_bf16 v[32:35], v[8:11], a[8:15], v108
  ds_read_b128 v[60:63], v0 offset:0
  s_waitcnt lgkmcnt(5)
  v_smfmac_f32_16x16x64_bf16 v[32:35], v[12:15], a[16:23], v108
  ds_read_b128 v[64:67], v0 offset:4096
  s_waitcnt lgkmcnt(5)
  v_smfmac_f32_16x16x64_bf16 v[32:35], v[16:19], a[24:31], v108
  ds_read_b128 v[68:71], v113 offset:24576
  s_waitcnt lgkmcnt(5)
  v_smfmac_f32_16x16x64_bf16 v[32:35], v[20:23], a[32:39], v108
  ds_read_b128 v[72:75], v0 offset:1024
  s_waitcnt lgkmcnt(5)
  v_smfmac_f32_16x16x64_bf16 v[32:35], v[24:27], a[40:47], v108
  ds_read_b128 v[76:79], v0 offset:5120
  s_waitcnt lgkmcnt(5)
  v_smfmac_f32_16x16x64_bf16 v[32:35], v[28:31], a[48:55], v108
  ds_read_b128 v[80:83], v113 offset:25088
  v_smfmac_f32_16x16x64_bf16 v[36:39], v[4:7], a[56:63], v108
  v_max3_u32 v109, v4, v8, v12
  v_smfmac_f32_16x16x64_bf16 v[36:39], v[8:11], a[64:71], v108
  v_max3_u32 v109, v109, v16, v20
  v_smfmac_f32_16x16x64_bf16 v[36:39], v[12:15], a[72:79], v108
  v_max3_u32 v109, v109, v24, v28
  v_smfmac_f32_16x16x64_bf16 v[36:39], v[16:19], a[80:87], v108
  v_cmp_eq_u32 vcc, -1, v109
  v_smfmac_f32_16x16x64_bf16 v[36:39], v[20:23], a[88:95], v108
  v_cvt_pk_bf16_f32 v104, v32, v33
  v_smfmac_f32_16x16x64_bf16 v[36:39], v[24:27], a[96:103], v108
  v_cvt_pk_bf16_f32 v105, v34, v35
  s_cbranch_vccnz L_a_redo_51
  v_smfmac_f32_16x16x64_bf16 v[36:39], v[28:31], a[104:111], v108
  ds_write_b64 v115, v[104:105] offset:16384
  v_smfmac_f32_16x16x64_bf16 v[40:43], v[4:7], a[112:119], v108
  s_nop 1
  v_smfmac_f32_16x16x64_bf16 v[40:43], v[8:11], a[120:127], v108
  s_nop 1
  v_smfmac_f32_16x16x64_bf16 v[40:43], v[12:15], a[128:135], v108
  s_nop 1
  v_smfmac_f32_16x16x64_bf16 v[40:43], v[16:19], a[136:143], v108
  s_nop 1
  v_smfmac_f32_16x16x64_bf16 v[40:43], v[20:23], a[144:151], v108
  v_cvt_pk_bf16_f32 v104, v36, v37
  v_smfmac_f32_16x16x64_bf16 v[40:43], v[24:27], a[152:159], v108
  v_cvt_pk_bf16_f32 v105, v38, v39
  v_smfmac_f32_16x16x64_bf16 v[40:43], v[28:31], a[160:167], v108
  ds_write_b64 v115, v[104:105] offset:16896
  v_smfmac_f32_16x16x64_bf16 v[44:47], v[4:7], a[168:175], v108
  ds_read_b64_tr_b16 v[84:85], v118 offset:16384
  v_smfmac_f32_16x16x64_bf16 v[44:47], v[8:11], a[176:183], v108
  ds_read_b64_tr_b16 v[86:87], v118 offset:16416
  v_smfmac_f32_16x16x64_bf16 v[44:47], v[12:15], a[184:191], v108
  s_nop 1
  v_smfmac_f32_16x16x64_bf16 v[44:47], v[16:19], a[192:199], v108
  s_nop 1
  v_smfmac_f32_16x16x64_bf16 v[44:47], v[20:23], a[200:207], v108
  v_cvt_pk_bf16_f32 v104, v40, v41
  v_smfmac_f32_16x16x64_bf16 v[44:47], v[24:27], a[208:215], v108
  v_cvt_pk_bf16_f32 v105, v42, v43
  v_smfmac_f32_16x16x64_bf16 v[44:47], v[28:31], a[216:223], v108
  ds_write_b64 v115, v[104:105] offset:17408
  s_waitcnt lgkmcnt(1)
  v_mfma_f32_16x16x32_bf16 v[92:95], v[84:87], v[60:63], 0
  s_nop 1
  v_mfma_f32_16x16x32_bf16 v[96:99], v[84:87], v[64:67], 0
  s_nop 1
  v_mfma_f32_16x16x32_bf16 v[100:103], v[84:87], v[68:71], 0
  s_nop 1
  v_smfmac_f32_16x16x64_bf16 v[48:51], v[4:7], a[224:231], v108
  ds_read_b128 v[60:63], v0 offset:2048
  v_smfmac_f32_16x16x64_bf16 v[48:51], v[8:11], a[232:239], v108
  v_cvt_pk_bf16_f32 v104, v44, v45
  v_smfmac_f32_16x16x64_bf16 v[48:51], v[12:15], a[240:247], v108
  v_cvt_pk_bf16_f32 v105, v46, v47
  v_smfmac_f32_16x16x64_bf16 v[48:51], v[16:19], a[248:255], v108
  ds_write_b64 v115, v[104:105] offset:17920
  v_smfmac_f32_16x16x64_bf16 v[48:51], v[20:23], v[120:127], v108
  ds_read_b64_tr_b16 v[88:89], v118 offset:17408
  v_smfmac_f32_16x16x64_bf16 v[48:51], v[24:27], v[128:135], v108
  ds_read_b64_tr_b16 v[90:91], v118 offset:17440
  v_smfmac_f32_16x16x64_bf16 v[48:51], v[28:31], v[136:143], v108
  s_nop 1
  v_smfmac_f32_16x16x64_bf16 v[52:55], v[4:7], v[144:151], v108
  ds_read_b128 v[64:67], v0 offset:6144
  v_smfmac_f32_16x16x64_bf16 v[52:55], v[8:11], v[152:159], v108
  ds_read_b128 v[68:71], v113 offset:25600
  v_smfmac_f32_16x16x64_bf16 v[52:55], v[12:15], v[160:167], v108
  s_nop 1
  v_smfmac_f32_16x16x64_bf16 v[52:55], v[16:19], v[168:175], v108
  v_cvt_pk_bf16_f32 v104, v48, v49
  v_smfmac_f32_16x16x64_bf16 v[52:55], v[20:23], v[176:183], v108
  v_cvt_pk_bf16_f32 v105, v50, v51
  v_smfmac_f32_16x16x64_bf16 v[52:55], v[24:27], v[184:191], v108
  ds_write_b64 v115, v[104:105] offset:18432
  v_smfmac_f32_16x16x64_bf16 v[52:55], v[28:31], v[192:199], v108
  s_nop 1
  s_waitcnt lgkmcnt(3)
  v_mfma_f32_16x16x32_bf16 v[92:95], v[88:91], v[72:75], v[92:95]
  ds_read_b128 v[72:75], v0 offset:3072
  v_mfma_f32_16x16x32_bf16 v[96:99], v[88:91], v[76:79], v[96:99]
  ds_read_b128 v[76:79], v0 offset:7168
  v_mfma_f32_16x16x32_bf16 v[100:103], v[88:91], v[80:83], v[100:103]
  v_cvt_pk_bf16_f32 v104, v52, v53
  v_smfmac_f32_16x16x64_bf16 v[56:59], v[4:7], v[200:207], v108
  v_cvt_pk_bf16_f32 v105, v54, v55
  v_smfmac_f32_16x16x64_bf16 v[56:59], v[8:11], v[208:215], v108
  ds_write_b64 v115, v[104:105] offset:18944
  v_smfmac_f32_16x16x64_bf16 v[56:59], v[12:15], v[216:223], v108
  ds_read_b64_tr_b16 v[84:85], v118 offset:18432
  v_smfmac_f32_16x16x64_bf16 v[56:59], v[16:19], v[224:231], v108
  ds_read_b64_tr_b16 v[86:87], v118 offset:18464
  v_smfmac_f32_16x16x64_bf16 v[56:59], v[20:23], v[232:239], v108
  s_waitcnt lgkmcnt(3)
  v_mov_b32 v73, v72
  v_smfmac_f32_16x16x64_bf16 v[56:59], v[24:27], v[240:247], v108
  v_mov_b32 v75, v74
  v_smfmac_f32_16x16x64_bf16 v[56:59], v[28:31], v[248:255], v108
  v_mov_b32 v77, v76
  s_waitcnt lgkmcnt(0)
  v_mfma_f32_16x16x32_bf16 v[92:95], v[84:87], v[60:63], v[92:95]
  ds_read2_b32 v[80:81], v114 offset0:0 offset1:0
  v_mfma_f32_16x16x32_bf16 v[96:99], v[84:87], v[64:67], v[96:99]
  ds_read2_b32 v[82:83], v114 offset0:2 offset1:2
  s_nop 1
  v_cvt_pk_bf16_f32 v104, v56, v57
  v_cvt_pk_bf16_f32 v105, v58, v59
  v_mfma_f32_16x16x32_bf16 v[100:103], v[84:87], v[68:71], v[100:103]
  ds_write_b64 v116, v[104:105]
  v_permlane32_swap_b32 v92, v94
  ds_write2_b32 v117, v105, v104 offset0:0 offset1:1
  v_permlane32_swap_b32 v93, v95
  ds_read_b64_tr_b16 v[88:89], v119
  ds_read_b64_tr_b16 v[90:91], v110
  v_pk_add_f32 v[92:93], v[92:93], v[94:95]
  v_permlane32_swap_b32 v96, v98
  v_permlane32_swap_b32 v97, v99
  v_pk_add_f32 v[96:97], v[96:97], v[98:99]
  v_permlane32_swap_b32 v100, v102
  v_permlane32_swap_b32 v101, v103
  v_pk_add_f32 v[100:101], v[100:101], v[102:103]
  v_mov_b32 v79, v78
  s_cmp_ge_u32 s3, 2
  s_waitcnt lgkmcnt(0)
  v_mfma_f32_16x16x32_bf16 v[92:95], v[88:91], v[72:75], v[92:95]
  v_max3_u32 v109, v5, v6, v7
  v_max3_u32 v109, v109, v9, v10
  v_mfma_f32_16x16x32_bf16 v[96:99], v[88:91], v[76:79], v[96:99]
  v_max3_u32 v109, v109, v11, v13
  v_max3_u32 v109, v109, v14, v15
  v_mfma_f32_16x16x32_bf16 v[100:103], v[88:91], v[80:83], v[100:103]
  v_max3_u32 v109, v109, v17, v18
  v_max3_u32 v109, v109, v19, v21
  ds_write_b64 v1, v[92:93] offset:57344
  v_max3_u32 v109, v109, v22, v23
  v_max3_u32 v109, v109, v25, v26
  ds_write_b64 v1, v[96:97] offset:57856
  v_max3_u32 v109, v109, v27, v29
  v_max3_u32 v109, v109, v30, v31
  ds_write_b64 v1, v[100:101] offset:58368
  v_cmp_eq_u32 vcc, -1, v109
  s_cbranch_vccnz L_a_redo_51
  s_waitcnt lgkmcnt(0)
  s_barrier
  s_cbranch_scc1 L_a_idle_50
  ds_read2st64_b32 v[16:17], v2 offset0:0 offset1:8
  ds_read2st64_b32 v[18:19], v2 offset0:16 offset1:24
  ds_read2st64_b32 v[20:21], v2 offset0:2 offset1:10
  ds_read2st64_b32 v[22:23], v2 offset0:18 offset1:26
  ds_read2st64_b32 v[24:25], v2 offset0:4 offset1:12
  ds_read2st64_b32 v[26:27], v2 offset0:20 offset1:28
  s_waitcnt lgkmcnt(4)
  v_pk_add_f32 v[16:17], v[16:17], v[18:19]
  v_add_f32 v12, v16, v17
  s_waitcnt lgkmcnt(2)
  v_pk_add_f32 v[20:21], v[20:21], v[22:23]
  v_add_f32 v13, v20, v21
  s_waitcnt lgkmcnt(0)
  v_pk_add_f32 v[24:25], v[24:25], v[26:27]
  v_add_f32 v14, v24, v25
  v_max3_f32 v104, v12, v13, v14
  s_nop 1
  v_max_f32_dpp v104, v104, v104 row_ror:8 row_mask:0xf bank_mask:0xf
  s_nop 1
  v_max_f32_dpp v104, v104, v104 row_ror:4 row_mask:0xf bank_mask:0xf
  s_nop 1
  v_max_f32_dpp v104, v104, v104 row_ror:2 row_mask:0xf bank_mask:0xf
  s_nop 1
  v_max_f32_dpp v104, v104, v104 row_ror:1 row_mask:0xf bank_mask:0xf
  v_sub_f32 v14, v14, v104
  v_sub_f32 v12, v12, v104
  v_sub_f32 v13, v13, v104
  v_exp_f32 v14, v14
  v_exp_f32 v12, v12
  v_exp_f32 v13, v13
  v_fma_f32 v105, 0.5, v14, v12
  v_mov_b32_dpp v15, v14 quad_perm:[1,0,3,2] row_mask:0xf bank_mask:0xf
  v_add_f32 v105, v105, v13
  s_nop 1
  v_add_f32_dpp v105, v105, v105 row_ror:8 row_mask:0xf bank_mask:0xf
  s_nop 1
  v_add_f32_dpp v105, v105, v105 row_ror:4 row_mask:0xf bank_mask:0xf
  s_nop 1
  v_add_f32_dpp v105, v105, v105 row_ror:2 row_mask:0xf bank_mask:0xf
  s_nop 1
  v_add_f32_dpp v105, v105, v105 row_ror:1 row_mask:0xf bank_mask:0xf
  v_rcp_f32 v105, v105
  s_nop 0
  v_mul_f32 v12, v12, v105
  v_mul_f32 v13, v13, v105
  v_cvt_pk_bf16_f32 v12, v12, v13
  v_min_u32 v12, -2, v12
  buffer_store_dword v12, v106, s[8:11], s46 offen
  v_mul_f32 v14, v14, v105
  v_mul_f32 v15, v15, v105
  v_cvt_pk_bf16_f32 v14, v14, v15
  v_min_u32 v14, -2, v14
  buffer_store_dword v14, v107, s[8:11], s46 offen
L_a_next_46:
  s_add_u32 s44, s44, 1
  s_add_u32 s57, s57, 8192
  s_add_u32 s46, s46, 10240
  s_add_u32 s54, s54, 16384
  s_add_u32 s47, s47, 28672
  s_add_u32 s48, s48, 28672
  s_add_u32 s55, s55, 458752
  s_barrier
  s_add_u32 s33, s49, 0
  s_mov_b32 m0, s33
  s_add_u32 s34, s47, 0
  buffer_load_dwordx4 v3, s[8:11], s34 offen offset:0 sc1 lds
  buffer_load_dwordx4 v3, s[8:11], s34 offen offset:1024 sc1 lds
  buffer_load_dwordx4 v3, s[8:11], s34 offen offset:2048 sc1 lds
  s_add_u32 s34, s48, 0
  buffer_load_dwordx4 v3, s[8:11], s34 offen offset:3072 sc1 lds
  s_add_u32 s33, s49, 4096
  s_mov_b32 m0, s33
  s_add_u32 s34, s47, 14336
  buffer_load_dwordx4 v3, s[8:11], s34 offen offset:0 sc1 lds
  buffer_load_dwordx4 v3, s[8:11], s34 offen offset:1024 sc1 lds
  buffer_load_dwordx4 v3, s[8:11], s34 offen offset:2048 sc1 lds
  s_add_u32 s34, s48, 14336
  buffer_load_dwordx4 v3, s[8:11], s34 offen offset:3072 sc1 lds
  s_cmp_eq_u32 s44, 63
  s_cbranch_scc0 L_a_top_45
  s_waitcnt vmcnt(0)
  s_endpgm
L_a_redo_51:
  s_mov_b32 m0, s56
  s_waitcnt lgkmcnt(0)
  s_barrier
  buffer_load_dwordx4 v3, s[8:11], s57 offen sc1 lds
  s_cmp_eq_u32 s3, 3
  s_cbranch_scc1 L_f3_55
  buffer_load_dwordx4 v3, s[8:11], s57 offen offset:1024 sc1 lds
L_f3_55:
  s_add_u32 s6, s6, 1
  s_cmp_gt_u32 s6, 262144
  s_cbranch_scc1 L_timeout
  v_mov_b64 v[32:33], 0
  v_mov_b64 v[34:35], 0
  v_mov_b64 v[36:37], 0
  v_mov_b64 v[38:39], 0
  v_mov_b64 v[40:41], 0
  v_mov_b64 v[42:43], 0
  v_mov_b64 v[44:45], 0
  v_mov_b64 v[46:47], 0
  v_mov_b64 v[48:49], 0
  v_mov_b64 v[50:51], 0
  v_mov_b64 v[52:53], 0
  v_mov_b64 v[54:55], 0
  v_mov_b64 v[56:57], 0
  v_mov_b64 v[58:59], 0
  v_lshlrev_b32 v104, 3, v3
  s_branch L_a_poll_48
L_a_idle_50:
  s_waitcnt lgkmcnt(0)
  v_lshrrev_b32 v105, 4, v3
  v_min_u32 v105, 13, v105
  v_lshl_add_u32 v105, v105, 9, s72
  v_mov_b32 v104, s98
  v_mfma_f32_16x16x32_bf16 v[32:35], v[84:87], v[84:87], v[32:35]
  v_mfma_f32_16x16x32_bf16 v[32:35], v[84:87], v[84:87], v[32:35]
  v_mfma_f32_16x16x32_bf16 v[32:35], v[84:87], v[84:87], v[32:35]
  v_mfma_f32_16x16x32_bf16 v[32:35], v[84:87], v[84:87], v[32:35]
  s_cmp_eq_u32 s3, 2
  s_cbranch_scc0 L_a_w3_56
  buffer_store_dword v104, v105, s[8:11], s54 offen offset:0
  s_branch L_a_next_46
L_a_w3_56:
  s_branch L_a_next_46
L_a_slow_43:
  s_branch L_a_poll_60
.p2align 6
  s_nop 0
  s_nop 0
L_a_top_57:
  buffer_load_dword v68, v112, s[8:11], s54 offen offset:0 sc1
  buffer_load_dword v69, v112, s[8:11], s54 offen offset:0 sc1
  buffer_load_dword v70, v112, s[8:11], s54 offen offset:0 sc1
  v_mov_b64 v[32:33], 0
  v_mov_b64 v[34:35], 0
  v_mov_b64 v[36:37], 0
  v_mov_b64 v[38:39], 0
  v_mov_b64 v[40:41], 0
  v_mov_b64 v[42:43], 0
  v_mov_b64 v[44:45], 0
  v_mov_b64 v[46:47], 0
  v_mov_b64 v[48:49], 0
  v_mov_b64 v[50:51], 0
  v_mov_b64 v[52:53], 0
  v_mov_b64 v[54:55], 0
  v_mov_b64 v[56:57], 0
  v_mov_b64 v[58:59], 0
  v_lshlrev_b32 v104, 3, v3
  s_mov_b32 m0, s56
L_nw_64:
  s_add_u32 s6, s6, 1
  s_cmp_gt_u32 s6, 262144
  s_cbranch_scc1 L_timeout
  buffer_load_dword v71, v112, s[8:11], s54 offen offset:0 sc1
  s_waitcnt vmcnt(3)
  v_cmp_ne_u32 vcc, s98, v68
  s_cbranch_vccz L_nok_65
  buffer_load_dword v68, v112, s[8:11], s54 offen offset:0 sc1
  s_waitcnt vmcnt(3)
  v_cmp_ne_u32 vcc, s98, v69
  s_cbranch_vccz L_nok_65
  buffer_load_dword v69, v112, s[8:11], s54 offen offset:0 sc1
  s_waitcnt vmcnt(3)
  v_cmp_ne_u32 vcc, s98, v70
  s_cbranch_vccz L_nok_65
  buffer_load_dword v70, v112, s[8:11], s54 offen offset:0 sc1
  s_waitcnt vmcnt(3)
  v_cmp_ne_u32 vcc, s98, v71
  s_cbranch_vccnz L_nw_64
L_nok_65:
  buffer_load_dwordx4 v3, s[8:11], s57 offen sc1 lds
  s_cmp_eq_u32 s3, 3
  s_cbranch_scc1 L_f3_66
  buffer_load_dwordx4 v3, s[8:11], s57 offen offset:1024 sc1 lds
L_f3_66:
L_a_poll_60:
  s_waitcnt vmcnt(0)
  s_barrier
  ds_read_b128 v[4:7], v3 offset:24576
  ds_read_b128 v[8:11], v3 offset:25600
  ds_read_b128 v[12:15], v3 offset:26624
  ds_read_b128 v[16:19], v3 offset:27648
  ds_read_b128 v[20:23], v3 offset:28672
  ds_read_b128 v[24:27], v3 offset:29696
  ds_read_b128 v[28:31], v3 offset:30720
  s_add_u32 s33, s52, 24320
  s_mov_b32 m0, s33
  s_nop 0
  buffer_load_dword v104, s[8:11], s55 offen offset:0 sc1 lds
  s_waitcnt lgkmcnt(6)
  v_smfmac_f32_16x16x64_bf16 v[32:35], v[4:7], a[0:7], v108
  s_nop 1
  s_waitcnt lgkmcnt(5)
  v_smfmac_f32_16x16x64_bf16 v[32:35], v[8:11], a[8:15], v108
  ds_read_b128 v[60:63], v0 offset:0
  s_waitcnt lgkmcnt(5)
  v_smfmac_f32_16x16x64_bf16 v[32:35], v[12:15], a[16:23], v108
  ds_read_b128 v[64:67], v0 offset:4096
  s_waitcnt lgkmcnt(5)
  v_smfmac_f32_16x16x64_bf16 v[32:35], v[16:19], a[24:31], v108
  ds_read_b128 v[68:71], v113 offset:24576
  s_waitcnt lgkmcnt(5)
  v_smfmac_f32_16x16x64_bf16 v[32:35], v[20:23], a[32:39], v108
  ds_read_b128 v[72:75], v0 offset:1024
  s_waitcnt lgkmcnt(5)
  v_smfmac_f32_16x16x64_bf16 v[32:35], v[24:27], a[40:47], v108
  ds_read_b128 v[76:79], v0 offset:5120
  s_waitcnt lgkmcnt(5)
  v_smfmac_f32_16x16x64_bf16 v[32:35], v[28:31], a[48:55], v108
  ds_read_b128 v[80:83], v113 offset:25088
  v_smfmac_f32_16x16x64_bf16 v[36:39], v[4:7], a[56:63], v108
  v_max3_u32 v109, v4, v8, v12
  v_smfmac_f32_16x16x64_bf16 v[36:39], v[8:11], a[64:71], v108
  v_max3_u32 v109, v109, v16, v20
  v_smfmac_f32_16x16x64_bf16 v[36:39], v[12:15], a[72:79], v108
  v_max3_u32 v109, v109, v24, v28
  v_smfmac_f32_16x16x64_bf16 v[36:39], v[16:19], a[80:87], v108
  v_cmp_eq_u32 vcc, -1, v109
  v_smfmac_f32_16x16x64_bf16 v[36:39], v[20:23], a[88:95], v108
  v_cvt_pk_bf16_f32 v104, v32, v33
  v_smfmac_f32_16x16x64_bf16 v[36:39], v[24:27], a[96:103], v108
  v_cvt_pk_bf16_f32 v105, v34, v35
  s_cbranch_vccnz L_a_redo_63
  v_smfmac_f32_16x16x64_bf16 v[36:39], v[28:31], a[104:111], v108
  ds_write_b64 v115, v[104:105] offset:16384
  v_smfmac_f32_16x16x64_bf16 v[40:43], v[4:7], a[112:119], v108
  s_nop 1
  v_smfmac_f32_16x16x64_bf16 v[40:43], v[8:11], a[120:127], v108
  s_nop 1
  v_smfmac_f32_16x16x64_bf16 v[40:43], v[12:15], a[128:135], v108
  s_nop 1
  v_smfmac_f32_16x16x64_bf16 v[40:43], v[16:19], a[136:143], v108
  s_nop 1
  v_smfmac_f32_16x16x64_bf16 v[40:43], v[20:23], a[144:151], v108
  v_cvt_pk_bf16_f32 v104, v36, v37
  v_smfmac_f32_16x16x64_bf16 v[40:43], v[24:27], a[152:159], v108
  v_cvt_pk_bf16_f32 v105, v38, v39
  v_smfmac_f32_16x16x64_bf16 v[40:43], v[28:31], a[160:167], v108
  ds_write_b64 v115, v[104:105] offset:16896
  v_smfmac_f32_16x16x64_bf16 v[44:47], v[4:7], a[168:175], v108
  ds_read_b64_tr_b16 v[84:85], v118 offset:16384
  v_smfmac_f32_16x16x64_bf16 v[44:47], v[8:11], a[176:183], v108
  ds_read_b64_tr_b16 v[86:87], v118 offset:16416
  v_smfmac_f32_16x16x64_bf16 v[44:47], v[12:15], a[184:191], v108
  s_nop 1
  v_smfmac_f32_16x16x64_bf16 v[44:47], v[16:19], a[192:199], v108
  s_nop 1
  v_smfmac_f32_16x16x64_bf16 v[44:47], v[20:23], a[200:207], v108
  v_cvt_pk_bf16_f32 v104, v40, v41
  v_smfmac_f32_16x16x64_bf16 v[44:47], v[24:27], a[208:215], v108
  v_cvt_pk_bf16_f32 v105, v42, v43
  v_smfmac_f32_16x16x64_bf16 v[44:47], v[28:31], a[216:223], v108
  ds_write_b64 v115, v[104:105] offset:17408
  s_waitcnt lgkmcnt(1)
  v_mfma_f32_16x16x32_bf16 v[92:95], v[84:87], v[60:63], 0
  s_nop 1
  v_mfma_f32_16x16x32_bf16 v[96:99], v[84:87], v[64:67], 0
  s_nop 1
  v_mfma_f32_16x16x32_bf16 v[100:103], v[84:87], v[68:71], 0
  s_nop 1
  v_smfmac_f32_16x16x64_bf16 v[48:51], v[4:7], a[224:231], v108
  ds_read_b128 v[60:63], v0 offset:2048
  v_smfmac_f32_16x16x64_bf16 v[48:51], v[8:11], a[232:239], v108
  v_cvt_pk_bf16_f32 v104, v44, v45
  v_smfmac_f32_16x16x64_bf16 v[48:51], v[12:15], a[240:247], v108
  v_cvt_pk_bf16_f32 v105, v46, v47
  v_smfmac_f32_16x16x64_bf16 v[48:51], v[16:19], a[248:255], v108
  ds_write_b64 v115, v[104:105] offset:17920
  v_smfmac_f32_16x16x64_bf16 v[48:51], v[20:23], v[120:127], v108
  ds_read_b64_tr_b16 v[88:89], v118 offset:17408
  v_smfmac_f32_16x16x64_bf16 v[48:51], v[24:27], v[128:135], v108
  ds_read_b64_tr_b16 v[90:91], v118 offset:17440
  v_smfmac_f32_16x16x64_bf16 v[48:51], v[28:31], v[136:143], v108
  s_nop 1
  v_smfmac_f32_16x16x64_bf16 v[52:55], v[4:7], v[144:151], v108
  ds_read_b128 v[64:67], v0 offset:6144
  v_smfmac_f32_16x16x64_bf16 v[52:55], v[8:11], v[152:159], v108
  ds_read_b128 v[68:71], v113 offset:25600
  v_smfmac_f32_16x16x64_bf16 v[52:55], v[12:15], v[160:167], v108
  s_nop 1
  v_smfmac_f32_16x16x64_bf16 v[52:55], v[16:19], v[168:175], v108
  v_cvt_pk_bf16_f32 v104, v48, v49
  v_smfmac_f32_16x16x64_bf16 v[52:55], v[20:23], v[176:183], v108
  v_cvt_pk_bf16_f32 v105, v50, v51
  v_smfmac_f32_16x16x64_bf16 v[52:55], v[24:27], v[184:191], v108
  ds_write_b64 v115, v[104:105] offset:18432
  v_smfmac_f32_16x16x64_bf16 v[52:55], v[28:31], v[192:199], v108
  s_nop 1
  s_waitcnt lgkmcnt(3)
  v_mfma_f32_16x16x32_bf16 v[92:95], v[88:91], v[72:75], v[92:95]
  ds_read_b128 v[72:75], v0 offset:3072
  v_mfma_f32_16x16x32_bf16 v[96:99], v[88:91], v[76:79], v[96:99]
  ds_read_b128 v[76:79], v0 offset:7168
  v_mfma_f32_16x16x32_bf16 v[100:103], v[88:91], v[80:83], v[100:103]
  v_cvt_pk_bf16_f32 v104, v52, v53
  v_smfmac_f32_16x16x64_bf16 v[56:59], v[4:7], v[200:207], v108
  v_cvt_pk_bf16_f32 v105, v54, v55
  v_smfmac_f32_16x16x64_bf16 v[56:59], v[8:11], v[208:215], v108
  ds_write_b64 v115, v[104:105] offset:18944
  v_smfmac_f32_16x16x64_bf16 v[56:59], v[12:15], v[216:223], v108
  ds_read_b64_tr_b16 v[84:85], v118 offset:18432
  v_smfmac_f32_16x16x64_bf16 v[56:59], v[16:19], v[224:231], v108
  ds_read_b64_tr_b16 v[86:87], v118 offset:18464
  v_smfmac_f32_16x16x64_bf16 v[56:59], v[20:23], v[232:239], v108
  s_waitcnt lgkmcnt(3)
  v_mov_b32 v73, v72
  v_smfmac_f32_16x16x64_bf16 v[56:59], v[24:27], v[240:247], v108
  v_mov_b32 v75, v74
  v_smfmac_f32_16x16x64_bf16 v[56:59], v[28:31], v[248:255], v108
  v_mov_b32 v77, v76
  s_waitcnt lgkmcnt(0)
  v_mfma_f32_16x16x32_bf16 v[92:95], v[84:87], v[60:63], v[92:95]
  ds_read2_b32 v[80:81], v114 offset0:0 offset1:0
  v_mfma_f32_16x16x32_bf16 v[96:99], v[84:87], v[64:67], v[96:99]
  ds_read2_b32 v[82:83], v114 offset0:2 offset1:2
  s_nop 1
  v_cvt_pk_bf16_f32 v104, v56, v57
  v_cvt_pk_bf16_f32 v105, v58, v59
  v_mfma_f32_16x16x32_bf16 v[100:103], v[84:87], v[68:71], v[100:103]
  ds_write_b64 v116, v[104:105]
  v_permlane32_swap_b32 v92, v94
  ds_write2_b32 v117, v105, v104 offset0:0 offset1:1
  v_permlane32_swap_b32 v93, v95
  ds_read_b64_tr_b16 v[88:89], v119
  ds_read_b64_tr_b16 v[90:91], v110
  v_pk_add_f32 v[92:93], v[92:93], v[94:95]
  v_permlane32_swap_b32 v96, v98
  v_permlane32_swap_b32 v97, v99
  v_pk_add_f32 v[96:97], v[96:97], v[98:99]
  v_permlane32_swap_b32 v100, v102
  v_permlane32_swap_b32 v101, v103
  v_pk_add_f32 v[100:101], v[100:101], v[102:103]
  v_mov_b32 v79, v78
  s_cmp_ge_u32 s3, 2
  s_waitcnt lgkmcnt(0)
  v_mfma_f32_16x16x32_bf16 v[92:95], v[88:91], v[72:75], v[92:95]
  v_max3_u32 v109, v5, v6, v7
  v_max3_u32 v109, v109, v9, v10
  v_mfma_f32_16x16x32_bf16 v[96:99], v[88:91], v[76:79], v[96:99]
  v_max3_u32 v109, v109, v11, v13
  v_max3_u32 v109, v109, v14, v15
  v_mfma_f32_16x16x32_bf16 v[100:103], v[88:91], v[80:83], v[100:103]
  v_max3_u32 v109, v109, v17, v18
  v_max3_u32 v109, v109, v19, v21
  ds_write_b64 v1, v[92:93] offset:57344
  v_max3_u32 v109, v109, v22, v23
  v_max3_u32 v109, v109, v25, v26
  ds_write_b64 v1, v[96:97] offset:57856
  v_max3_u32 v109, v109, v27, v29
  v_max3_u32 v109, v109, v30, v31
  ds_write_b64 v1, v[100:101] offset:58368
  v_cmp_eq_u32 vcc, -1, v109
  s_cbranch_vccnz L_a_redo_63
  s_waitcnt lgkmcnt(0)
  s_barrier
  s_cbranch_scc1 L_a_idle_62
  ds_read2st64_b32 v[16:17], v2 offset0:0 offset1:8
  ds_read2st64_b32 v[18:19], v2 offset0:16 offset1:24
  ds_read2st64_b32 v[20:21], v2 offset0:2 offset1:10
  ds_read2st64_b32 v[22:23], v2 offset0:18 offset1:26
  ds_read2st64_b32 v[24:25], v2 offset0:4 offset1:12
  ds_read2st64_b32 v[26:27], v2 offset0:20 offset1:28
  s_waitcnt lgkmcnt(4)
  v_pk_add_f32 v[16:17], v[16:17], v[18:19]
  v_add_f32 v12, v16, v17
  s_waitcnt lgkmcnt(2)
  v_pk_add_f32 v[20:21], v[20:21], v[22:23]
  v_add_f32 v13, v20, v21
  s_waitcnt lgkmcnt(0)
  v_pk_add_f32 v[24:25], v[24:25], v[26:27]
  v_add_f32 v14, v24, v25
  v_max3_f32 v104, v12, v13, v14
  s_nop 1
  v_max_f32_dpp v104, v104, v104 row_ror:8 row_mask:0xf bank_mask:0xf
  s_nop 1
  v_max_f32_dpp v104, v104, v104 row_ror:4 row_mask:0xf bank_mask:0xf
  s_nop 1
  v_max_f32_dpp v104, v104, v104 row_ror:2 row_mask:0xf bank_mask:0xf
  s_nop 1
  v_max_f32_dpp v104, v104, v104 row_ror:1 row_mask:0xf bank_mask:0xf
  v_sub_f32 v14, v14, v104
  v_sub_f32 v12, v12, v104
  v_sub_f32 v13, v13, v104
  v_exp_f32 v14, v14
  v_exp_f32 v12, v12
  v_exp_f32 v13, v13
  v_fma_f32 v105, 0.5, v14, v12
  v_mov_b32_dpp v15, v14 quad_perm:[1,0,3,2] row_mask:0xf bank_mask:0xf
  v_add_f32 v105, v105, v13
  s_nop 1
  v_add_f32_dpp v105, v105, v105 row_ror:8 row_mask:0xf bank_mask:0xf
  s_nop 1
  v_add_f32_dpp v105, v105, v105 row_ror:4 row_mask:0xf bank_mask:0xf
  s_nop 1
  v_add_f32_dpp v105, v105, v105 row_ror:2 row_mask:0xf bank_mask:0xf
  s_nop 1
  v_add_f32_dpp v105, v105, v105 row_ror:1 row_mask:0xf bank_mask:0xf
  v_rcp_f32 v105, v105
  s_nop 0
  v_mul_f32 v12, v12, v105
  v_mul_f32 v13, v13, v105
  v_cvt_pk_bf16_f32 v12, v12, v13
  v_min_u32 v12, -2, v12
  buffer_store_dword v12, v106, s[8:11], s46 offen sc1
  v_mul_f32 v14, v14, v105
  v_mul_f32 v15, v15, v105
  v_cvt_pk_bf16_f32 v14, v14, v15
  v_min_u32 v14, -2, v14
  buffer_store_dword v14, v107, s[8:11], s46 offen sc1
L_a_next_58:
  s_add_u32 s44, s44, 1
  s_add_u32 s57, s57, 8192
  s_add_u32 s46, s46, 10240
  s_add_u32 s54, s54, 16384
  s_add_u32 s47, s47, 28672
  s_add_u32 s48, s48, 28672
  s_add_u32 s55, s55, 458752
  s_barrier
  s_add_u32 s33, s49, 0
  s_mov_b32 m0, s33
  s_add_u32 s34, s47, 0
  buffer_load_dwordx4 v3, s[8:11], s34 offen offset:0 sc1 lds
  buffer_load_dwordx4 v3, s[8:11], s34 offen offset:1024 sc1 lds
  buffer_load_dwordx4 v3, s[8:11], s34 offen offset:2048 sc1 lds
  s_add_u32 s34, s48, 0
  buffer_load_dwordx4 v3, s[8:11], s34 offen offset:3072 sc1 lds
  s_add_u32 s33, s49, 4096
  s_mov_b32 m0, s33
  s_add_u32 s34, s47, 14336
  buffer_load_dwordx4 v3, s[8:11], s34 offen offset:0 sc1 lds
  buffer_load_dwordx4 v3, s[8:11], s34 offen offset:1024 sc1 lds
  buffer_load_dwordx4 v3, s[8:11], s34 offen offset:2048 sc1 lds
  s_add_u32 s34, s48, 14336
  buffer_load_dwordx4 v3, s[8:11], s34 offen offset:3072 sc1 lds
  s_cmp_eq_u32 s44, 63
  s_cbranch_scc0 L_a_top_57
  s_waitcnt vmcnt(0)
  s_endpgm
L_a_redo_63:
  s_mov_b32 m0, s56
  s_waitcnt lgkmcnt(0)
  s_barrier
  buffer_load_dwordx4 v3, s[8:11], s57 offen sc1 lds
  s_cmp_eq_u32 s3, 3
  s_cbranch_scc1 L_f3_67
  buffer_load_dwordx4 v3, s[8:11], s57 offen offset:1024 sc1 lds
L_f3_67:
  s_add_u32 s6, s6, 1
  s_cmp_gt_u32 s6, 262144
  s_cbranch_scc1 L_timeout
  v_mov_b64 v[32:33], 0
  v_mov_b64 v[34:35], 0
  v_mov_b64 v[36:37], 0
  v_mov_b64 v[38:39], 0
  v_mov_b64 v[40:41], 0
  v_mov_b64 v[42:43], 0
  v_mov_b64 v[44:45], 0
  v_mov_b64 v[46:47], 0
  v_mov_b64 v[48:49], 0
  v_mov_b64 v[50:51], 0
  v_mov_b64 v[52:53], 0
  v_mov_b64 v[54:55], 0
  v_mov_b64 v[56:57], 0
  v_mov_b64 v[58:59], 0
  v_lshlrev_b32 v104, 3, v3
  s_branch L_a_poll_60
L_a_idle_62:
  s_waitcnt lgkmcnt(0)
  v_lshrrev_b32 v105, 4, v3
  v_min_u32 v105, 13, v105
  v_lshl_add_u32 v105, v105, 9, s72
  v_mov_b32 v104, s98
  v_mfma_f32_16x16x32_bf16 v[32:35], v[84:87], v[84:87], v[32:35]
  v_mfma_f32_16x16x32_bf16 v[32:35], v[84:87], v[84:87], v[32:35]
  v_mfma_f32_16x16x32_bf16 v[32:35], v[84:87], v[84:87], v[32:35]
  v_mfma_f32_16x16x32_bf16 v[32:35], v[84:87], v[84:87], v[32:35]
  s_cmp_eq_u32 s3, 2
  s_cbranch_scc0 L_a_w3_68
  buffer_store_dword v104, v105, s[8:11], s54 offen offset:0 sc1
  s_branch L_a_next_58
L_a_w3_68:
  s_branch L_a_next_58
L_chain_b:
  s_sub_u32 s50, s4, 16
  s_mul_i32 s34, s3, 1605632
  s_mul_i32 s33, s50, 28672
  s_add_u32 s34, s34, s33
  s_add_u32 s34, s34, 6422528
  s_mul_i32 s36, s3, 28672
  s_add_u32 s36, s36, 12288
  v_add_u32 v141, s36, v3
  s_add_u32 s37, s34, 1204224
  s_mul_i32 s33, s3, 28
  s_lshr_b32 s35, s50, 1
  s_add_u32 s33, s33, s35
  s_add_u32 s33, s33, 112
  v_and_b32 v4, 3, v0
  v_mul_u32_u24 v4, 7, v4
  v_add_u32 v4, s33, v4
  v_lshlrev_b32 v4, 7, v4
  v_add_u32 v4, 1863680, v4
  s_mov_b32 s38, 0
  s_mov_b32 s39, 75857920
L_lp_69:
  buffer_load_dwordx2 v[6:7], v4, s[8:11], s39 offen sc1
  s_add_u32 s6, s6, 1
  s_cmp_gt_u32 s6, 262144
  s_cbranch_scc1 L_timeout
  s_waitcnt vmcnt(0)
  v_cmp_eq_u32 vcc, s98, v6
  v_cmp_eq_u32 s[42:43], s98, v7
  s_and_b64 vcc, vcc, s[42:43]
  s_andn2_b32 s40, vcc_lo, s38
  s_bitcmp1_b32 s40, 0
  s_cbranch_scc0 L_lps_70
  s_waitcnt vmcnt(35)
  s_add_u32 s41, s34, 0
  buffer_load_dwordx4 a[0:3], v3, s[8:11], s41 offen offset:0 sc1
  buffer_load_dwordx4 a[4:7], v3, s[8:11], s41 offen offset:1024 sc1
  buffer_load_dwordx4 a[8:11], v3, s[8:11], s41 offen offset:2048 sc1
  buffer_load_dwordx4 a[12:15], v3, s[8:11], s41 offen offset:3072 sc1
  s_add_u32 s41, s34, 4096
  buffer_load_dwordx4 a[16:19], v3, s[8:11], s41 offen offset:0 sc1
  buffer_load_dwordx4 a[20:23], v3, s[8:11], s41 offen offset:1024 sc1
  buffer_load_dwordx4 a[24:27], v3, s[8:11], s41 offen offset:2048 sc1
  buffer_load_dwordx4 a[28:31], v3, s[8:11], s41 offen offset:3072 sc1
  s_add_u32 s41, s34, 8192
  buffer_load_dwordx4 a[32:35], v3, s[8:11], s41 offen offset:0 sc1
  buffer_load_dwordx4 a[36:39], v3, s[8:11], s41 offen offset:1024 sc1
  buffer_load_dwordx4 a[40:43], v3, s[8:11], s41 offen offset:2048 sc1
  buffer_load_dwordx4 a[44:47], v3, s[8:11], s41 offen offset:3072 sc1
  s_add_u32 s41, s34, 12288
  buffer_load_dwordx4 a[48:51], v3, s[8:11], s41 offen offset:0 sc1
  buffer_load_dwordx4 a[52:55], v3, s[8:11], s41 offen offset:1024 sc1
  buffer_load_dwordx4 a[56:59], v3, s[8:11], s41 offen offset:2048 sc1
  buffer_load_dwordx4 a[60:63], v3, s[8:11], s41 offen offset:3072 sc1
  s_add_u32 s41, s34, 16384
  buffer_load_dwordx4 a[64:67], v3, s[8:11], s41 offen offset:0 sc1
  buffer_load_dwordx4 a[68:71], v3, s[8:11], s41 offen offset:1024 sc1
  buffer_load_dwordx4 a[72:75], v3, s[8:11], s41 offen offset:2048 sc1
  buffer_load_dwordx4 a[76:79], v3, s[8:11], s41 offen offset:3072 sc1
  s_add_u32 s41, s34, 20480
  buffer_load_dwordx4 a[80:83], v3, s[8:11], s41 offen offset:0 sc1
  buffer_load_dwordx4 a[84:87], v3, s[8:11], s41 offen offset:1024 sc1
  buffer_load_dwordx4 a[88:91], v3, s[8:11], s41 offen offset:2048 sc1
  buffer_load_dwordx4 a[92:95], v3, s[8:11], s41 offen offset:3072 sc1
  s_add_u32 s41, s34, 24576
  buffer_load_dwordx4 a[96:99], v3, s[8:11], s41 offen offset:0 sc1
  buffer_load_dwordx4 a[100:103], v3, s[8:11], s41 offen offset:1024 sc1
  buffer_load_dwordx4 a[104:107], v3, s[8:11], s41 offen offset:2048 sc1
  buffer_load_dwordx4 a[108:111], v3, s[8:11], s41 offen offset:3072 sc1
L_lps_70:
  s_bitcmp1_b32 s40, 1
  s_cbranch_scc0 L_lps_71
  s_waitcnt vmcnt(35)
  s_add_u32 s41, s34, 401408
  buffer_load_dwordx4 a[112:115], v3, s[8:11], s41 offen offset:0 sc1
  buffer_load_dwordx4 a[116:119], v3, s[8:11], s41 offen offset:1024 sc1
  buffer_load_dwordx4 a[120:123], v3, s[8:11], s41 offen offset:2048 sc1
  buffer_load_dwordx4 a[124:127], v3, s[8:11], s41 offen offset:3072 sc1
  s_add_u32 s41, s34, 405504
  buffer_load_dwordx4 a[128:131], v3, s[8:11], s41 offen offset:0 sc1
  buffer_load_dwordx4 a[132:135], v3, s[8:11], s41 offen offset:1024 sc1
  buffer_load_dwordx4 a[136:139], v3, s[8:11], s41 offen offset:2048 sc1
  buffer_load_dwordx4 a[140:143], v3, s[8:11], s41 offen offset:3072 sc1
  s_add_u32 s41, s34, 409600
  buffer_load_dwordx4 a[144:147], v3, s[8:11], s41 offen offset:0 sc1
  buffer_load_dwordx4 a[148:151], v3, s[8:11], s41 offen offset:1024 sc1
  buffer_load_dwordx4 a[152:155], v3, s[8:11], s41 offen offset:2048 sc1
  buffer_load_dwordx4 a[156:159], v3, s[8:11], s41 offen offset:3072 sc1
  s_add_u32 s41, s34, 413696
  buffer_load_dwordx4 a[160:163], v3, s[8:11], s41 offen offset:0 sc1
  buffer_load_dwordx4 a[164:167], v3, s[8:11], s41 offen offset:1024 sc1
  buffer_load_dwordx4 a[168:171], v3, s[8:11], s41 offen offset:2048 sc1
  buffer_load_dwordx4 a[172:175], v3, s[8:11], s41 offen offset:3072 sc1
  s_add_u32 s41, s34, 417792
  buffer_load_dwordx4 a[176:179], v3, s[8:11], s41 offen offset:0 sc1
  buffer_load_dwordx4 a[180:183], v3, s[8:11], s41 offen offset:1024 sc1
  buffer_load_dwordx4 a[184:187], v3, s[8:11], s41 offen offset:2048 sc1
  buffer_load_dwordx4 a[188:191], v3, s[8:11], s41 offen offset:3072 sc1
  s_add_u32 s41, s34, 421888
  buffer_load_dwordx4 a[192:195], v3, s[8:11], s41 offen offset:0 sc1
  buffer_load_dwordx4 a[196:199], v3, s[8:11], s41 offen offset:1024 sc1
  buffer_load_dwordx4 a[200:203], v3, s[8:11], s41 offen offset:2048 sc1
  buffer_load_dwordx4 a[204:207], v3, s[8:11], s41 offen offset:3072 sc1
  s_add_u32 s41, s34, 425984
  buffer_load_dwordx4 a[208:211], v3, s[8:11], s41 offen offset:0 sc1
  buffer_load_dwordx4 a[212:215], v3, s[8:11], s41 offen offset:1024 sc1
  buffer_load_dwordx4 a[216:219], v3, s[8:11], s41 offen offset:2048 sc1
  buffer_load_dwordx4 a[220:223], v3, s[8:11], s41 offen offset:3072 sc1
L_lps_71:
  s_bitcmp1_b32 s40, 2
  s_cbranch_scc0 L_lps_72
  s_waitcnt vmcnt(35)
  s_add_u32 s41, s34, 802816
  buffer_load_dwordx4 a[224:227], v3, s[8:11], s41 offen offset:0 sc1
  buffer_load_dwordx4 a[228:231], v3, s[8:11], s41 offen offset:1024 sc1
  buffer_load_dwordx4 a[232:235], v3, s[8:11], s41 offen offset:2048 sc1
  buffer_load_dwordx4 a[236:239], v3, s[8:11], s41 offen offset:3072 sc1
  s_add_u32 s41, s34, 806912
  buffer_load_dwordx4 a[240:243], v3, s[8:11], s41 offen offset:0 sc1
  buffer_load_dwordx4 a[244:247], v3, s[8:11], s41 offen offset:1024 sc1
  buffer_load_dwordx4 a[248:251], v3, s[8:11], s41 offen offset:2048 sc1
  buffer_load_dwordx4 a[252:255], v3, s[8:11], s41 offen offset:3072 sc1
  s_add_u32 s41, s34, 811008
  buffer_load_dwordx4 v[176:179], v3, s[8:11], s41 offen offset:0 sc1
  buffer_load_dwordx4 v[180:183], v3, s[8:11], s41 offen offset:1024 sc1
  buffer_load_dwordx4 v[184:187], v3, s[8:11], s41 offen offset:2048 sc1
  buffer_load_dwordx4 v[188:191], v3, s[8:11], s41 offen offset:3072 sc1
  s_add_u32 s41, s34, 815104
  buffer_load_dwordx4 v[192:195], v3, s[8:11], s41 offen offset:0 sc1
  buffer_load_dwordx4 v[196:199], v3, s[8:11], s41 offen offset:1024 sc1
  buffer_load_dwordx4 v[200:203], v3, s[8:11], s41 offen offset:2048 sc1
  buffer_load_dwordx4 v[204:207], v3, s[8:11], s41 offen offset:3072 sc1
  s_add_u32 s41, s34, 819200
  buffer_load_dwordx4 v[208:211], v3, s[8:11], s41 offen offset:0 sc1
  buffer_load_dwordx4 v[212:215], v3, s[8:11], s41 offen offset:1024 sc1
  buffer_load_dwordx4 v[216:219], v3, s[8:11], s41 offen offset:2048 sc1
  buffer_load_dwordx4 v[220:223], v3, s[8:11], s41 offen offset:3072 sc1
  s_add_u32 s41, s34, 823296
  buffer_load_dwordx4 v[224:227], v3, s[8:11], s41 offen offset:0 sc1
  buffer_load_dwordx4 v[228:231], v3, s[8:11], s41 offen offset:1024 sc1
  buffer_load_dwordx4 v[232:235], v3, s[8:11], s41 offen offset:2048 sc1
  buffer_load_dwordx4 v[236:239], v3, s[8:11], s41 offen offset:3072 sc1
  s_add_u32 s41, s34, 827392
  buffer_load_dwordx4 v[240:243], v3, s[8:11], s41 offen offset:0 sc1
  buffer_load_dwordx4 v[244:247], v3, s[8:11], s41 offen offset:1024 sc1
  buffer_load_dwordx4 v[248:251], v3, s[8:11], s41 offen offset:2048 sc1
  buffer_load_dwordx4 v[252:255], v3, s[8:11], s41 offen offset:3072 sc1
L_lps_72:
  s_bitcmp1_b32 s40, 3
  s_cbranch_scc0 L_lps_73
  s_waitcnt vmcnt(35)
  s_mov_b32 m0, s36
  s_add_u32 s36, s36, 4096
  buffer_load_dwordx4 v3, s[8:11], s37 offen offset:0 sc1 lds
  buffer_load_dwordx4 v3, s[8:11], s37 offen offset:1024 sc1 lds
  buffer_load_dwordx4 v3, s[8:11], s37 offen offset:2048 sc1 lds
  buffer_load_dwordx4 v3, s[8:11], s37 offen offset:3072 sc1 lds
  s_add_u32 s37, s37, 4096
  s_mov_b32 m0, s36
  s_add_u32 s36, s36, 4096
  buffer_load_dwordx4 v3, s[8:11], s37 offen offset:0 sc1 lds
  buffer_load_dwordx4 v3, s[8:11], s37 offen offset:1024 sc1 lds
  buffer_load_dwordx4 v3, s[8:11], s37 offen offset:2048 sc1 lds
  buffer_load_dwordx4 v3, s[8:11], s37 offen offset:3072 sc1 lds
  s_add_u32 s37, s37, 4096
  s_mov_b32 m0, s36
  s_add_u32 s36, s36, 4096
  buffer_load_dwordx4 v3, s[8:11], s37 offen offset:0 sc1 lds
  buffer_load_dwordx4 v3, s[8:11], s37 offen offset:1024 sc1 lds
  buffer_load_dwordx4 v3, s[8:11], s37 offen offset:2048 sc1 lds
  buffer_load_dwordx4 v3, s[8:11], s37 offen offset:3072 sc1 lds
  s_add_u32 s37, s37, 4096
  s_mov_b32 m0, s36
  s_add_u32 s36, s36, 4096
  buffer_load_dwordx4 v3, s[8:11], s37 offen offset:0 sc1 lds
  buffer_load_dwordx4 v3, s[8:11], s37 offen offset:1024 sc1 lds
  buffer_load_dwordx4 v3, s[8:11], s37 offen offset:2048 sc1 lds
  buffer_load_dwordx4 v3, s[8:11], s37 offen offset:3072 sc1 lds
  s_add_u32 s37, s37, 4096
  s_mov_b32 m0, s36
  s_add_u32 s36, s36, 4096
  buffer_load_dwordx4 v3, s[8:11], s37 offen offset:0 sc1 lds
  buffer_load_dwordx4 v3, s[8:11], s37 offen offset:1024 sc1 lds
  buffer_load_dwordx4 v3, s[8:11], s37 offen offset:2048 sc1 lds
  buffer_load_dwordx4 v3, s[8:11], s37 offen offset:3072 sc1 lds
  s_add_u32 s37, s37, 4096
  s_mov_b32 m0, s36
  s_add_u32 s36, s36, 4096
  buffer_load_dwordx4 v3, s[8:11], s37 offen offset:0 sc1 lds
  buffer_load_dwordx4 v3, s[8:11], s37 offen offset:1024 sc1 lds
  buffer_load_dwordx4 v3, s[8:11], s37 offen offset:2048 sc1 lds
  buffer_load_dwordx4 v3, s[8:11], s37 offen offset:3072 sc1 lds
  s_add_u32 s37, s37, 4096
  s_mov_b32 m0, s36
  s_add_u32 s36, s36, 4096
  buffer_load_dwordx4 v3, s[8:11], s37 offen offset:0 sc1 lds
  buffer_load_dwordx4 v3, s[8:11], s37 offen offset:1024 sc1 lds
  buffer_load_dwordx4 v3, s[8:11], s37 offen offset:2048 sc1 lds
  buffer_load_dwordx4 v3, s[8:11], s37 offen offset:3072 sc1 lds
  s_add_u32 s37, s37, 4096
L_lps_73:
  s_or_b32 s38, s38, s40
  s_and_b32 s38, s38, 15
  s_cmp_eq_u32 s38, 15
  s_cbranch_scc1 L_lpo_74
  s_sleep 2
  s_branch L_lp_69
L_lpo_74:
  s_mul_i32 s33, s3, 1792
  v_add_u32 v133, s33, v3
  v_min_u32 v134, 47, v0
  v_lshlrev_b32 v134, 4, v134
  s_add_u32 s33, s33, 1024
  v_add_u32 v134, s33, v134
  v_mov_b32 v132, 0x44444444
  v_mov_b32 v4, 0xeeeeeeee
  v_cmp_gt_u32 vcc, 8, v1
  s_nop 1
  v_cndmask_b32 v132, v4, v132, vcc
  v_and_b32 v4, 7, v1
  v_lshrrev_b32 v5, 3, v1
  v_lshrrev_b32 v6, 1, v2
  v_and_b32 v7, 1, v2
  s_mul_i32 s33, s3, 2560
  v_mul_u32_u24 v8, 640, v6
  v_lshl_add_u32 v8, v4, 4, v8
  v_lshl_add_u32 v8, v7, 8, v8
  v_lshl_add_u32 v8, v5, 7, v8
  v_add_u32 v135, s33, v8
  v_lshl_add_u32 v8, v6, 1, v5
  v_mul_u32_u24 v8, 640, v8
  v_lshl_add_u32 v8, v4, 4, v8
  s_add_u32 s33, s33, 512
  v_add_u32 v136, s33, v8
  v_lshl_add_u32 v8, v6, 1, v7
  v_xor_b32 v8, v0, v8
  v_lshlrev_b32 v8, 4, v8
  s_lshl_b32 s33, s3, 10
  s_add_u32 s33, s33, 8192
  v_add_u32 v137, s33, v8
  v_lshrrev_b32 v4, 5, v0
  v_bfe_u32 v5, v0, 2, 3
  v_and_b32 v6, 3, v0
  v_and_b32 v7, 1, v6
  v_lshrrev_b32 v8, 2, v5
  v_lshlrev_b32 v9, 5, v7
  v_lshl_add_u32 v9, v8, 4, v9
  s_and_b32 s33, s3, 1
  s_lshl_b32 s33, s33, 3
  v_add_u32 v9, s33, v9
  v_lshrrev_b32 v10, 1, v6
  v_lshl_add_u32 v9, v10, 2, v9
  v_lshl_add_u32 v9, v4, 1, v9
  v_lshl_add_u32 v10, v7, 1, v8
  v_xor_b32 v9, v9, v10
  v_lshlrev_b32 v9, 4, v9
  v_and_b32 v10, 3, v5
  v_lshl_add_u32 v9, v10, 2, v9
  v_add_u32 v138, 8192, v9
  v_xor_b32 v139, 16, v138
  s_lshl_b32 s33, s50, 9
  s_and_b32 s35, s3, 1
  s_lshl_b32 s35, s35, 8
  s_add_u32 s33, s33, s35
  v_lshl_add_u32 v140, v0, 2, s33
  v_lshlrev_b32 v142, 7, v1
  v_mov_b32 v143, 0
  s_mov_b32 s44, 0
  s_mov_b32 s45, 46399488
  s_mov_b32 s46, 46923776
  s_mul_i32 s33, s3, 114688
  s_lshl_b32 s35, s50, 11
  s_add_u32 s47, s33, s35
  s_add_u32 s47, s47, 16515072
  s_mov_b32 s51, 75857920
  s_mov_b32 s48, 47579136
  s_mov_b32 s53, 0
  s_mov_b32 s55, 0
  v_and_b32 v4, 3, v0
  v_and_b32 v5, 1, v0
  v_add_u32 v5, 16, v5
  s_lshl_b32 s33, s50, 9
  s_add_u32 s33, s33, 8192
  s_lshl_b32 s35, s3, 2
  v_add_u32 v4, s35, v4
  v_cmp_gt_u32 vcc, 32, v0
  s_nop 1
  v_cndmask_b32 v131, v5, v4, vcc
  v_lshl_add_u32 v131, v131, 2, s33
  s_and_b32 s33, s50, 3
  s_lshl_b32 s33, s33, 2
  s_add_u32 s33, s33, s3
  s_lshl_b32 s33, s33, 2
  s_lshr_b32 s35, s50, 2
  s_lshl_b32 s35, s35, 7
  s_add_u32 s33, s33, s35
  s_add_u32 s33, s33, 16384
  v_min_u32 v130, 15, v0
  v_lshl_add_u32 v130, v130, 9, s33
  v_mov_b32 v129, s98
  v_lshlrev_b32 v4, 3, v3
  v_mov_b32 v5, 68
  v_min_u32 v7, 4224, v4
L_ws_76:
  s_mov_b32 s35, 77721600
  buffer_load_dwordx2 v[8:9], v4, s[8:11], s35 offen sc1
  s_mov_b32 s35, 77729792
  buffer_load_dwordx2 v[10:11], v4, s[8:11], s35 offen sc1
  s_mov_b32 s35, 77737984
  buffer_load_dwordx2 v[12:13], v4, s[8:11], s35 offen sc1
  s_mov_b32 s35, 77746176
  buffer_load_dwordx2 v[14:15], v7, s[8:11], s35 offen sc1
  buffer_load_dwordx2 v[16:17], v142, s[8:11], s51 offen sc1
  buffer_load_dword v6, v5, s[12:15], 0 offen sc1
  s_add_u32 s6, s6, 1
  s_cmp_gt_u32 s6, 262144
  s_cbranch_scc1 L_timeout
  s_waitcnt vmcnt(0)
  v_readfirstlane_b32 s34, v6
  v_cmp_ne_u32 vcc, s98, v8
  v_cmp_ne_u32 s[36:37], s98, v9
  s_or_b64 vcc, vcc, s[36:37]
  v_cmp_ne_u32 s[36:37], s98, v10
  s_or_b64 vcc, vcc, s[36:37]
  v_cmp_ne_u32 s[36:37], s98, v11
  s_or_b64 vcc, vcc, s[36:37]
  v_cmp_ne_u32 s[36:37], s98, v12
  s_or_b64 vcc, vcc, s[36:37]
  v_cmp_ne_u32 s[36:37], s98, v13
  s_or_b64 vcc, vcc, s[36:37]
  v_cmp_ne_u32 s[36:37], s98, v14
  s_or_b64 vcc, vcc, s[36:37]
  v_cmp_ne_u32 s[36:37], s98, v15
  s_or_b64 vcc, vcc, s[36:37]
  v_cmp_ne_u32 s[36:37], s98, v16
  s_or_b64 vcc, vcc, s[36:37]
  v_cmp_ne_u32 s[36:37], s98, v17
  s_or_b64 vcc, vcc, s[36:37]
  s_cbranch_vccnz L_ws_76
  s_and_b32 s35, s34, 0xff
  s_cmp_eq_u32 s35, 32
  s_cbranch_scc0 L_ws_76
  s_waitcnt lgkmcnt(0)
  s_lshr_b32 s34, s34, 8
  s_cmp_eq_u32 s34, 0
  s_cbranch_scc0 L_b_slow_75
  s_branch L_b_top_77
.p2align 6
  s_nop 0
  s_nop 0
  s_nop 0
L_b_top_77:
  v_mov_b64 v[32:33], 0
  v_mov_b64 v[34:35], 0
  v_mov_b64 v[36:37], 0
  v_mov_b64 v[38:39], 0
  v_mov_b64 v[40:41], 0
  v_mov_b64 v[42:43], 0
  v_mov_b64 v[44:45], 0
  v_mov_b64 v[46:47], 0
  v_mov_b64 v[48:49], 0
  v_mov_b64 v[50:51], 0
  v_mov_b64 v[52:53], 0
  v_mov_b64 v[54:55], 0
  v_mov_b64 v[56:57], 0
  v_mov_b64 v[58:59], 0
  v_mov_b64 v[108:109], 0
  v_mov_b64 v[110:111], 0
  v_mov_b64 v[112:113], 0
  v_mov_b64 v[114:115], 0
L_fm_88:
  buffer_load_dwordx4 v[144:147], v133, s[8:11], s45 offen sc1
  buffer_load_dwordx4 v[148:151], v134, s[8:11], s45 offen sc1
  s_add_u32 s6, s6, 1
  s_cmp_gt_u32 s6, 262144
  s_cbranch_scc1 L_timeout
  s_waitcnt vmcnt(0)
  ds_write_b128 v133, v[144:147] offset:0
  ds_write_b128 v134, v[148:151] offset:0
  v_max3_u32 v116, v144, v145, v146
  v_max3_u32 v117, v147, v148, v149
  v_max3_u32 v116, v116, v150, v151
  v_max_u32 v116, v116, v117
  v_cmp_eq_u32 vcc, -1, v116
  s_cbranch_vccnz L_fm_88
  s_waitcnt lgkmcnt(0)
  s_barrier
  ds_read_b128 v[4:7], v3 offset:0
  ds_read_b128 v[8:11], v3 offset:1024
  ds_read_b128 v[12:15], v3 offset:2048
  ds_read_b128 v[16:19], v3 offset:3072
  ds_read_b128 v[20:23], v3 offset:4096
  ds_read_b128 v[24:27], v3 offset:5120
  ds_read_b128 v[28:31], v3 offset:6144
  ds_read_b128 v[144:147], v141 offset:0
  ds_read_b128 v[148:151], v141 offset:1024
  ds_read_b128 v[152:155], v141 offset:2048
  ds_read_b128 v[156:159], v141 offset:3072
  s_add_u32 s33, s47, 0
  buffer_load_dwordx4 v[76:79], v3, s[8:11], s33 offen offset:0 sc1
  buffer_load_dwordx4 v[84:87], v3, s[8:11], s33 offen offset:1024 sc1
  s_waitcnt lgkmcnt(10)
  v_smfmac_f32_16x16x64_bf16 v[32:35], v[4:7], a[0:7], v132
  ds_read_b128 v[160:163], v141 offset:4096
  s_waitcnt lgkmcnt(10)
  v_smfmac_f32_16x16x64_bf16 v[32:35], v[8:11], a[8:15], v132
  ds_read_b128 v[164:167], v141 offset:5120
  s_waitcnt lgkmcnt(10)
  v_smfmac_f32_16x16x64_bf16 v[32:35], v[12:15], a[16:23], v132
  s_add_u32 s33, s47, 28672
  buffer_load_dwordx4 v[80:83], v3, s[8:11], s33 offen offset:0 sc1
  s_waitcnt lgkmcnt(4)
  v_smfmac_f32_16x16x64_bf16 v[56:59], v[4:7], v[144:151], v132
  buffer_load_dwordx4 v[88:91], v3, s[8:11], s33 offen offset:1024 sc1
  v_smfmac_f32_16x16x64_bf16 v[32:35], v[16:19], a[24:31], v132
  ds_read_b128 v[168:171], v141 offset:6144
  v_smfmac_f32_16x16x64_bf16 v[32:35], v[20:23], a[32:39], v132
  ds_read_b128 v[172:175], v141 offset:7168
  v_smfmac_f32_16x16x64_bf16 v[32:35], v[24:27], a[40:47], v132
  s_add_u32 s33, s47, 57344
  buffer_load_dwordx4 v[92:95], v3, s[8:11], s33 offen offset:0 sc1
  s_waitcnt lgkmcnt(4)
  v_smfmac_f32_16x16x64_bf16 v[56:59], v[8:11], v[152:159], v132
  buffer_load_dwordx4 v[100:103], v3, s[8:11], s33 offen offset:1024 sc1
  v_smfmac_f32_16x16x64_bf16 v[32:35], v[28:31], a[48:55], v132
  ds_read_b128 v[144:147], v141 offset:8192
  v_smfmac_f32_16x16x64_bf16 v[36:39], v[4:7], a[56:63], v132
  ds_read_b128 v[148:151], v141 offset:9216
  v_smfmac_f32_16x16x64_bf16 v[36:39], v[8:11], a[64:71], v132
  s_add_u32 s33, s47, 86016
  buffer_load_dwordx4 v[96:99], v3, s[8:11], s33 offen offset:0 sc1
  s_waitcnt lgkmcnt(4)
  v_smfmac_f32_16x16x64_bf16 v[56:59], v[12:15], v[160:167], v132
  buffer_load_dwordx4 v[104:107], v3, s[8:11], s33 offen offset:1024 sc1
  v_smfmac_f32_16x16x64_bf16 v[36:39], v[12:15], a[72:79], v132
  ds_read_b128 v[152:155], v141 offset:10240
  v_smfmac_f32_16x16x64_bf16 v[36:39], v[16:19], a[80:87], v132
  ds_read_b128 v[156:159], v141 offset:11264
  v_smfmac_f32_16x16x64_bf16 v[36:39], v[20:23], a[88:95], v132
  v_cvt_pk_bf16_f32 v60, v32, v33
  s_waitcnt lgkmcnt(4)
  v_smfmac_f32_16x16x64_bf16 v[56:59], v[16:19], v[168:175], v132
  v_cvt_pk_bf16_f32 v62, v34, v35
  v_smfmac_f32_16x16x64_bf16 v[36:39], v[24:27], a[96:103], v132
  ds_read_b128 v[160:163], v141 offset:12288
  v_smfmac_f32_16x16x64_bf16 v[36:39], v[28:31], a[104:111], v132
  ds_read_b128 v[164:167], v141 offset:13312
  v_smfmac_f32_16x16x64_bf16 v[40:43], v[4:7], a[112:119], v132
  v_mov_b64 v[32:33], 0
  s_waitcnt lgkmcnt(4)
  v_smfmac_f32_16x16x64_bf16 v[56:59], v[20:23], v[144:151], v132
  v_mov_b64 v[34:35], 0
  v_smfmac_f32_16x16x64_bf16 v[40:43], v[8:11], a[120:127], v132
  ds_read_b128 v[168:171], v141 offset:14336
  v_smfmac_f32_16x16x64_bf16 v[40:43], v[12:15], a[128:135], v132
  ds_read_b128 v[172:175], v141 offset:15360
  v_smfmac_f32_16x16x64_bf16 v[40:43], v[16:19], a[136:143], v132
  v_cvt_pk_bf16_f32 v68, v36, v37
  s_waitcnt lgkmcnt(4)
  v_smfmac_f32_16x16x64_bf16 v[56:59], v[24:27], v[152:159], v132
  v_cvt_pk_bf16_f32 v70, v38, v39
  v_smfmac_f32_16x16x64_bf16 v[40:43], v[20:23], a[144:151], v132
  ds_read_b128 v[144:147], v141 offset:16384
  v_smfmac_f32_16x16x64_bf16 v[40:43], v[24:27], a[152:159], v132
  ds_read_b128 v[148:151], v141 offset:17408
  v_smfmac_f32_16x16x64_bf16 v[40:43], v[28:31], a[160:167], v132
  s_nop 1
  s_waitcnt lgkmcnt(4)
  v_smfmac_f32_16x16x64_bf16 v[56:59], v[28:31], v[160:167], v132
  s_nop 1
  v_smfmac_f32_16x16x64_bf16 v[44:47], v[4:7], a[168:175], v132
  ds_read_b128 v[152:155], v141 offset:18432
  v_smfmac_f32_16x16x64_bf16 v[44:47], v[8:11], a[176:183], v132
  ds_read_b128 v[156:159], v141 offset:19456
  v_smfmac_f32_16x16x64_bf16 v[44:47], v[12:15], a[184:191], v132
  v_cvt_pk_bf16_f32 v61, v40, v41
  s_waitcnt lgkmcnt(4)
  v_smfmac_f32_16x16x64_bf16 v[32:35], v[4:7], v[168:175], v132
  v_cvt_pk_bf16_f32 v63, v42, v43
  v_smfmac_f32_16x16x64_bf16 v[44:47], v[16:19], a[192:199], v132
  ds_read_b128 v[160:163], v141 offset:20480
  v_smfmac_f32_16x16x64_bf16 v[44:47], v[20:23], a[200:207], v132
  ds_read_b128 v[164:167], v141 offset:21504
  v_smfmac_f32_16x16x64_bf16 v[44:47], v[24:27], a[208:215], v132
  v_cvt_pk_bf16_f32 v65, v56, v57
  s_waitcnt lgkmcnt(4)
  v_smfmac_f32_16x16x64_bf16 v[32:35], v[8:11], v[144:151], v132
  v_cvt_pk_bf16_f32 v67, v58, v59
  v_smfmac_f32_16x16x64_bf16 v[44:47], v[28:31], a[216:223], v132
  ds_read_b128 v[168:171], v141 offset:22528
  v_smfmac_f32_16x16x64_bf16 v[48:51], v[4:7], a[224:231], v132
  ds_read_b128 v[172:175], v141 offset:23552
  v_smfmac_f32_16x16x64_bf16 v[48:51], v[8:11], a[232:239], v132
  s_nop 1
  s_waitcnt lgkmcnt(4)
  v_smfmac_f32_16x16x64_bf16 v[32:35], v[12:15], v[152:159], v132
  s_nop 1
  v_smfmac_f32_16x16x64_bf16 v[48:51], v[12:15], a[240:247], v132
  ds_read_b128 v[144:147], v141 offset:24576
  v_smfmac_f32_16x16x64_bf16 v[48:51], v[16:19], a[248:255], v132
  ds_read_b128 v[148:151], v141 offset:25600
  v_smfmac_f32_16x16x64_bf16 v[48:51], v[20:23], v[176:183], v132
  v_cvt_pk_bf16_f32 v69, v44, v45
  s_waitcnt lgkmcnt(4)
  v_smfmac_f32_16x16x64_bf16 v[32:35], v[16:19], v[160:167], v132
  v_cvt_pk_bf16_f32 v71, v46, v47
  v_smfmac_f32_16x16x64_bf16 v[48:51], v[24:27], v[184:191], v132
  ds_read_b128 v[152:155], v141 offset:26624
  v_smfmac_f32_16x16x64_bf16 v[48:51], v[28:31], v[192:199], v132
  ds_read_b128 v[156:159], v141 offset:27648
  v_smfmac_f32_16x16x64_bf16 v[52:55], v[4:7], v[200:207], v132
  s_nop 1
  s_waitcnt lgkmcnt(4)
  v_smfmac_f32_16x16x64_bf16 v[32:35], v[20:23], v[168:175], v132
  s_nop 1
  v_smfmac_f32_16x16x64_bf16 v[52:55], v[8:11], v[208:215], v132
  s_nop 1
  v_smfmac_f32_16x16x64_bf16 v[52:55], v[12:15], v[216:223], v132
  v_cvt_pk_bf16_f32 v64, v48, v49
  v_smfmac_f32_16x16x64_bf16 v[52:55], v[16:19], v[224:231], v132
  v_cvt_pk_bf16_f32 v66, v50, v51
  s_waitcnt lgkmcnt(2)
  v_smfmac_f32_16x16x64_bf16 v[32:35], v[24:27], v[144:151], v132
  s_nop 1
  v_smfmac_f32_16x16x64_bf16 v[52:55], v[20:23], v[232:239], v132
  s_nop 1
  v_smfmac_f32_16x16x64_bf16 v[52:55], v[24:27], v[240:247], v132
  s_nop 1
  v_smfmac_f32_16x16x64_bf16 v[52:55], v[28:31], v[248:255], v132
  s_nop 1
  s_waitcnt lgkmcnt(0)
  v_smfmac_f32_16x16x64_bf16 v[32:35], v[28:31], v[152:159], v132
  s_nop 3
  v_cvt_pk_bf16_f32 v72, v52, v53
  v_cvt_pk_bf16_f32 v74, v54, v55
  s_nop 1
  v_cvt_pk_bf16_f32 v73, v32, v33
  v_cvt_pk_bf16_f32 v75, v34, v35
  buffer_load_dword v16, v131, s[8:11], s48 offen offset:0 sc1
  buffer_load_dword v17, v131, s[8:11], s48 offen offset:0 sc1
  buffer_load_dword v18, v131, s[8:11], s48 offen offset:0 sc1
L_nw_90:
  s_add_u32 s6, s6, 1
  s_cmp_gt_u32 s6, 262144
  s_cbranch_scc1 L_timeout
  buffer_load_dword v19, v131, s[8:11], s48 offen offset:0 sc1
  s_waitcnt vmcnt(3)
  v_cmp_ne_u32 vcc, s98, v16
  s_cbranch_vccz L_nok_91
  buffer_load_dword v16, v131, s[8:11], s48 offen offset:0 sc1
  s_waitcnt vmcnt(3)
  v_cmp_ne_u32 vcc, s98, v17
  s_cbranch_vccz L_nok_91
  buffer_load_dword v17, v131, s[8:11], s48 offen offset:0 sc1
  s_waitcnt vmcnt(3)
  v_cmp_ne_u32 vcc, s98, v18
  s_cbranch_vccz L_nok_91
  buffer_load_dword v18, v131, s[8:11], s48 offen offset:0 sc1
  s_waitcnt vmcnt(3)
  v_cmp_ne_u32 vcc, s98, v19
  s_cbranch_vccnz L_nw_90
L_nok_91:
L_b_gp_85:
  buffer_load_dwordx4 v[4:7], v135, s[8:11], s46 offen sc1
  buffer_load_dwordx4 v[8:11], v135, s[8:11], s46 offen offset:1280 sc1
  buffer_load_dwordx4 v[12:15], v136, s[8:11], s46 offen sc1
  s_add_u32 s6, s6, 1
  s_cmp_gt_u32 s6, 262144
  s_cbranch_scc1 L_timeout
  s_waitcnt vmcnt(2)
  v_smfmac_f32_16x16x64_bf16 v[108:111], v[4:7], v[76:83], v132
  s_nop 0
  v_smfmac_f32_16x16x64_bf16 v[112:115], v[4:7], v[84:91], v132
  v_max3_u32 v116, v4, v5, v6
  s_waitcnt vmcnt(1)
  v_smfmac_f32_16x16x64_bf16 v[108:111], v[8:11], v[92:99], v132
  v_max3_u32 v116, v116, v7, v8
  v_smfmac_f32_16x16x64_bf16 v[112:115], v[8:11], v[100:107], v132
  v_max3_u32 v117, v9, v10, v11
  s_waitcnt vmcnt(0)
  v_smfmac_f32_16x16x64_bf16 v[108:111], v[12:15], v[60:67], v132
  v_max3_u32 v118, v12, v13, v14
  v_smfmac_f32_16x16x64_bf16 v[112:115], v[12:15], v[68:75], v132
  v_max3_u32 v116, v116, v117, v15
  v_max_u32 v116, v116, v118
  v_cmp_eq_u32 vcc, -1, v116
  s_cbranch_vccnz L_b_ok_89
  s_nop 3
  v_permlane32_swap_b32 v108, v112
  v_permlane32_swap_b32 v109, v113
  v_permlane32_swap_b32 v110, v114
  v_permlane32_swap_b32 v111, v115
  v_pk_add_f32 v[108:109], v[108:109], v[112:113]
  v_pk_add_f32 v[110:111], v[110:111], v[114:115]
  ds_write_b128 v137, v[108:111]
  buffer_store_dword v129, v130, s[8:11], s48 offen offset:0
  s_add_u32 s33, s45, 8192
  s_cmp_ge_u32 s3, 2
  s_waitcnt lgkmcnt(0)
  s_barrier
  s_cbranch_scc1 L_b_idle_86
  ds_read2st64_b32 v[32:33], v138 offset0:0 offset1:4
  ds_read2st64_b32 v[36:37], v138 offset0:8 offset1:12
  ds_read2st64_b32 v[34:35], v139 offset0:0 offset1:4
  ds_read2st64_b32 v[38:39], v139 offset0:8 offset1:12
  s_waitcnt lgkmcnt(2)
  v_pk_add_f32 v[32:33], v[32:33], v[36:37]
  v_add_f32 v32, v32, v33
  s_waitcnt lgkmcnt(0)
  v_pk_add_f32 v[34:35], v[34:35], v[38:39]
  v_add_f32 v34, v34, v35
  v_cvt_pk_bf16_f32 v32, v32, v34
  v_min_u32 v32, -2, v32
  buffer_store_dword v32, v140, s[8:11], s33 offen
L_b_next_78:
  s_add_u32 s44, s44, 1
  s_add_u32 s45, s45, 8192
  s_add_u32 s46, s46, 10240
  s_add_u32 s47, s47, 458752
  s_add_u32 s48, s48, 16384
  s_barrier
  s_cmp_eq_u32 s44, 63
  s_cbranch_scc0 L_b_top_77
  s_cmp_ge_u32 s3, 2
  s_cbranch_scc1 L_b_last_79
  s_mov_b32 s33, 46391296
  buffer_store_dword v32, v140, s[8:11], s33 offen sc1
L_b_last_79:
  s_waitcnt vmcnt(0)
  s_endpgm
L_b_ok_89:
  s_nop 1
  v_mov_b64 v[108:109], 0
  v_mov_b64 v[110:111], 0
  v_mov_b64 v[112:113], 0
  v_mov_b64 v[114:115], 0
  s_branch L_b_gp_85
L_b_idle_86:
  s_branch L_b_next_78
L_b_slow_75:
  s_branch L_b_top_92
.p2align 6
  s_nop 0
  s_nop 0
  s_nop 0
L_b_top_92:
  v_mov_b64 v[32:33], 0
  v_mov_b64 v[34:35], 0
  v_mov_b64 v[36:37], 0
  v_mov_b64 v[38:39], 0
  v_mov_b64 v[40:41], 0
  v_mov_b64 v[42:43], 0
  v_mov_b64 v[44:45], 0
  v_mov_b64 v[46:47], 0
  v_mov_b64 v[48:49], 0
  v_mov_b64 v[50:51], 0
  v_mov_b64 v[52:53], 0
  v_mov_b64 v[54:55], 0
  v_mov_b64 v[56:57], 0
  v_mov_b64 v[58:59], 0
  v_mov_b64 v[108:109], 0
  v_mov_b64 v[110:111], 0
  v_mov_b64 v[112:113], 0
  v_mov_b64 v[114:115], 0
L_fm_103:
  buffer_load_dwordx4 v[144:147], v133, s[8:11], s45 offen sc1
  buffer_load_dwordx4 v[148:151], v134, s[8:11], s45 offen sc1
  s_add_u32 s6, s6, 1
  s_cmp_gt_u32 s6, 262144
  s_cbranch_scc1 L_timeout
  s_waitcnt vmcnt(0)
  ds_write_b128 v133, v[144:147] offset:0
  ds_write_b128 v134, v[148:151] offset:0
  v_max3_u32 v116, v144, v145, v146
  v_max3_u32 v117, v147, v148, v149
  v_max3_u32 v116, v116, v150, v151
  v_max_u32 v116, v116, v117
  v_cmp_eq_u32 vcc, -1, v116
  s_cbranch_vccnz L_fm_103
  s_waitcnt lgkmcnt(0)
  s_barrier
  ds_read_b128 v[4:7], v3 offset:0
  ds_read_b128 v[8:11], v3 offset:1024
  ds_read_b128 v[12:15], v3 offset:2048
  ds_read_b128 v[16:19], v3 offset:3072
  ds_read_b128 v[20:23], v3 offset:4096
  ds_read_b128 v[24:27], v3 offset:5120
  ds_read_b128 v[28:31], v3 offset:6144
  ds_read_b128 v[144:147], v141 offset:0
  ds_read_b128 v[148:151], v141 offset:1024
  ds_read_b128 v[152:155], v141 offset:2048
  ds_read_b128 v[156:159], v141 offset:3072
  s_add_u32 s33, s47, 0
  buffer_load_dwordx4 v[76:79], v3, s[8:11], s33 offen offset:0 sc1
  buffer_load_dwordx4 v[84:87], v3, s[8:11], s33 offen offset:1024 sc1
  s_waitcnt lgkmcnt(10)
  v_smfmac_f32_16x16x64_bf16 v[32:35], v[4:7], a[0:7], v132
  ds_read_b128 v[160:163], v141 offset:4096
  s_waitcnt lgkmcnt(10)
  v_smfmac_f32_16x16x64_bf16 v[32:35], v[8:11], a[8:15], v132
  ds_read_b128 v[164:167], v141 offset:5120
  s_waitcnt lgkmcnt(10)
  v_smfmac_f32_16x16x64_bf16 v[32:35], v[12:15], a[16:23], v132
  s_add_u32 s33, s47, 28672
  buffer_load_dwordx4 v[80:83], v3, s[8:11], s33 offen offset:0 sc1
  s_waitcnt lgkmcnt(4)
  v_smfmac_f32_16x16x64_bf16 v[56:59], v[4:7], v[144:151], v132
  buffer_load_dwordx4 v[88:91], v3, s[8:11], s33 offen offset:1024 sc1
  v_smfmac_f32_16x16x64_bf16 v[32:35], v[16:19], a[24:31], v132
  ds_read_b128 v[168:171], v141 offset:6144
  v_smfmac_f32_16x16x64_bf16 v[32:35], v[20:23], a[32:39], v132
  ds_read_b128 v[172:175], v141 offset:7168
  v_smfmac_f32_16x16x64_bf16 v[32:35], v[24:27], a[40:47], v132
  s_add_u32 s33, s47, 57344
  buffer_load_dwordx4 v[92:95], v3, s[8:11], s33 offen offset:0 sc1
  s_waitcnt lgkmcnt(4)
  v_smfmac_f32_16x16x64_bf16 v[56:59], v[8:11], v[152:159], v132
  buffer_load_dwordx4 v[100:103], v3, s[8:11], s33 offen offset:1024 sc1
  v_smfmac_f32_16x16x64_bf16 v[32:35], v[28:31], a[48:55], v132
  ds_read_b128 v[144:147], v141 offset:8192
  v_smfmac_f32_16x16x64_bf16 v[36:39], v[4:7], a[56:63], v132
  ds_read_b128 v[148:151], v141 offset:9216
  v_smfmac_f32_16x16x64_bf16 v[36:39], v[8:11], a[64:71], v132
  s_add_u32 s33, s47, 86016
  buffer_load_dwordx4 v[96:99], v3, s[8:11], s33 offen offset:0 sc1
  s_waitcnt lgkmcnt(4)
  v_smfmac_f32_16x16x64_bf16 v[56:59], v[12:15], v[160:167], v132
  buffer_load_dwordx4 v[104:107], v3, s[8:11], s33 offen offset:1024 sc1
  v_smfmac_f32_16x16x64_bf16 v[36:39], v[12:15], a[72:79], v132
  ds_read_b128 v[152:155], v141 offset:10240
  v_smfmac_f32_16x16x64_bf16 v[36:39], v[16:19], a[80:87], v132
  ds_read_b128 v[156:159], v141 offset:11264
  v_smfmac_f32_16x16x64_bf16 v[36:39], v[20:23], a[88:95], v132
  v_cvt_pk_bf16_f32 v60, v32, v33
  s_waitcnt lgkmcnt(4)
  v_smfmac_f32_16x16x64_bf16 v[56:59], v[16:19], v[168:175], v132
  v_cvt_pk_bf16_f32 v62, v34, v35
  v_smfmac_f32_16x16x64_bf16 v[36:39], v[24:27], a[96:103], v132
  ds_read_b128 v[160:163], v141 offset:12288
  v_smfmac_f32_16x16x64_bf16 v[36:39], v[28:31], a[104:111], v132
  ds_read_b128 v[164:167], v141 offset:13312
  v_smfmac_f32_16x16x64_bf16 v[40:43], v[4:7], a[112:119], v132
  v_mov_b64 v[32:33], 0
  s_waitcnt lgkmcnt(4)
  v_smfmac_f32_16x16x64_bf16 v[56:59], v[20:23], v[144:151], v132
  v_mov_b64 v[34:35], 0
  v_smfmac_f32_16x16x64_bf16 v[40:43], v[8:11], a[120:127], v132
  ds_read_b128 v[168:171], v141 offset:14336
  v_smfmac_f32_16x16x64_bf16 v[40:43], v[12:15], a[128:135], v132
  ds_read_b128 v[172:175], v141 offset:15360
  v_smfmac_f32_16x16x64_bf16 v[40:43], v[16:19], a[136:143], v132
  v_cvt_pk_bf16_f32 v68, v36, v37
  s_waitcnt lgkmcnt(4)
  v_smfmac_f32_16x16x64_bf16 v[56:59], v[24:27], v[152:159], v132
  v_cvt_pk_bf16_f32 v70, v38, v39
  v_smfmac_f32_16x16x64_bf16 v[40:43], v[20:23], a[144:151], v132
  ds_read_b128 v[144:147], v141 offset:16384
  v_smfmac_f32_16x16x64_bf16 v[40:43], v[24:27], a[152:159], v132
  ds_read_b128 v[148:151], v141 offset:17408
  v_smfmac_f32_16x16x64_bf16 v[40:43], v[28:31], a[160:167], v132
  s_nop 1
  s_waitcnt lgkmcnt(4)
  v_smfmac_f32_16x16x64_bf16 v[56:59], v[28:31], v[160:167], v132
  s_nop 1
  v_smfmac_f32_16x16x64_bf16 v[44:47], v[4:7], a[168:175], v132
  ds_read_b128 v[152:155], v141 offset:18432
  v_smfmac_f32_16x16x64_bf16 v[44:47], v[8:11], a[176:183], v132
  ds_read_b128 v[156:159], v141 offset:19456
  v_smfmac_f32_16x16x64_bf16 v[44:47], v[12:15], a[184:191], v132
  v_cvt_pk_bf16_f32 v61, v40, v41
  s_waitcnt lgkmcnt(4)
  v_smfmac_f32_16x16x64_bf16 v[32:35], v[4:7], v[168:175], v132
  v_cvt_pk_bf16_f32 v63, v42, v43
  v_smfmac_f32_16x16x64_bf16 v[44:47], v[16:19], a[192:199], v132
  ds_read_b128 v[160:163], v141 offset:20480
  v_smfmac_f32_16x16x64_bf16 v[44:47], v[20:23], a[200:207], v132
  ds_read_b128 v[164:167], v141 offset:21504
  v_smfmac_f32_16x16x64_bf16 v[44:47], v[24:27], a[208:215], v132
  v_cvt_pk_bf16_f32 v65, v56, v57
  s_waitcnt lgkmcnt(4)
  v_smfmac_f32_16x16x64_bf16 v[32:35], v[8:11], v[144:151], v132
  v_cvt_pk_bf16_f32 v67, v58, v59
  v_smfmac_f32_16x16x64_bf16 v[44:47], v[28:31], a[216:223], v132
  ds_read_b128 v[168:171], v141 offset:22528
  v_smfmac_f32_16x16x64_bf16 v[48:51], v[4:7], a[224:231], v132
  ds_read_b128 v[172:175], v141 offset:23552
  v_smfmac_f32_16x16x64_bf16 v[48:51], v[8:11], a[232:239], v132
  s_nop 1
  s_waitcnt lgkmcnt(4)
  v_smfmac_f32_16x16x64_bf16 v[32:35], v[12:15], v[152:159], v132
  s_nop 1
  v_smfmac_f32_16x16x64_bf16 v[48:51], v[12:15], a[240:247], v132
  ds_read_b128 v[144:147], v141 offset:24576
  v_smfmac_f32_16x16x64_bf16 v[48:51], v[16:19], a[248:255], v132
  ds_read_b128 v[148:151], v141 offset:25600
  v_smfmac_f32_16x16x64_bf16 v[48:51], v[20:23], v[176:183], v132
  v_cvt_pk_bf16_f32 v69, v44, v45
  s_waitcnt lgkmcnt(4)
  v_smfmac_f32_16x16x64_bf16 v[32:35], v[16:19], v[160:167], v132
  v_cvt_pk_bf16_f32 v71, v46, v47
  v_smfmac_f32_16x16x64_bf16 v[48:51], v[24:27], v[184:191], v132
  ds_read_b128 v[152:155], v141 offset:26624
  v_smfmac_f32_16x16x64_bf16 v[48:51], v[28:31], v[192:199], v132
  ds_read_b128 v[156:159], v141 offset:27648
  v_smfmac_f32_16x16x64_bf16 v[52:55], v[4:7], v[200:207], v132
  s_nop 1
  s_waitcnt lgkmcnt(4)
  v_smfmac_f32_16x16x64_bf16 v[32:35], v[20:23], v[168:175], v132
  s_nop 1
  v_smfmac_f32_16x16x64_bf16 v[52:55], v[8:11], v[208:215], v132
  s_nop 1
  v_smfmac_f32_16x16x64_bf16 v[52:55], v[12:15], v[216:223], v132
  v_cvt_pk_bf16_f32 v64, v48, v49
  v_smfmac_f32_16x16x64_bf16 v[52:55], v[16:19], v[224:231], v132
  v_cvt_pk_bf16_f32 v66, v50, v51
  s_waitcnt lgkmcnt(2)
  v_smfmac_f32_16x16x64_bf16 v[32:35], v[24:27], v[144:151], v132
  s_nop 1
  v_smfmac_f32_16x16x64_bf16 v[52:55], v[20:23], v[232:239], v132
  s_nop 1
  v_smfmac_f32_16x16x64_bf16 v[52:55], v[24:27], v[240:247], v132
  s_nop 1
  v_smfmac_f32_16x16x64_bf16 v[52:55], v[28:31], v[248:255], v132
  s_nop 1
  s_waitcnt lgkmcnt(0)
  v_smfmac_f32_16x16x64_bf16 v[32:35], v[28:31], v[152:159], v132
  s_nop 3
  v_cvt_pk_bf16_f32 v72, v52, v53
  v_cvt_pk_bf16_f32 v74, v54, v55
  s_nop 1
  v_cvt_pk_bf16_f32 v73, v32, v33
  v_cvt_pk_bf16_f32 v75, v34, v35
  buffer_load_dword v16, v131, s[8:11], s48 offen offset:0 sc1
  buffer_load_dword v17, v131, s[8:11], s48 offen offset:0 sc1
  buffer_load_dword v18, v131, s[8:11], s48 offen offset:0 sc1
L_nw_105:
  s_add_u32 s6, s6, 1
  s_cmp_gt_u32 s6, 262144
  s_cbranch_scc1 L_timeout
  buffer_load_dword v19, v131, s[8:11], s48 offen offset:0 sc1
  s_waitcnt vmcnt(3)
  v_cmp_ne_u32 vcc, s98, v16
  s_cbranch_vccz L_nok_106
  buffer_load_dword v16, v131, s[8:11], s48 offen offset:0 sc1
  s_waitcnt vmcnt(3)
  v_cmp_ne_u32 vcc, s98, v17
  s_cbranch_vccz L_nok_106
  buffer_load_dword v17, v131, s[8:11], s48 offen offset:0 sc1
  s_waitcnt vmcnt(3)
  v_cmp_ne_u32 vcc, s98, v18
  s_cbranch_vccz L_nok_106
  buffer_load_dword v18, v131, s[8:11], s48 offen offset:0 sc1
  s_waitcnt vmcnt(3)
  v_cmp_ne_u32 vcc, s98, v19
  s_cbranch_vccnz L_nw_105
L_nok_106:
L_b_gp_100:
  buffer_load_dwordx4 v[4:7], v135, s[8:11], s46 offen sc1
  buffer_load_dwordx4 v[8:11], v135, s[8:11], s46 offen offset:1280 sc1
  buffer_load_dwordx4 v[12:15], v136, s[8:11], s46 offen sc1
  s_add_u32 s6, s6, 1
  s_cmp_gt_u32 s6, 262144
  s_cbranch_scc1 L_timeout
  s_waitcnt vmcnt(2)
  v_smfmac_f32_16x16x64_bf16 v[108:111], v[4:7], v[76:83], v132
  s_nop 0
  v_smfmac_f32_16x16x64_bf16 v[112:115], v[4:7], v[84:91], v132
  v_max3_u32 v116, v4, v5, v6
  s_waitcnt vmcnt(1)
  v_smfmac_f32_16x16x64_bf16 v[108:111], v[8:11], v[92:99], v132
  v_max3_u32 v116, v116, v7, v8
  v_smfmac_f32_16x16x64_bf16 v[112:115], v[8:11], v[100:107], v132
  v_max3_u32 v117, v9, v10, v11
  s_waitcnt vmcnt(0)
  v_smfmac_f32_16x16x64_bf16 v[108:111], v[12:15], v[60:67], v132
  v_max3_u32 v118, v12, v13, v14
  v_smfmac_f32_16x16x64_bf16 v[112:115], v[12:15], v[68:75], v132
  v_max3_u32 v116, v116, v117, v15
  v_max_u32 v116, v116, v118
  v_cmp_eq_u32 vcc, -1, v116
  s_cbranch_vccnz L_b_ok_104
  s_nop 3
  v_permlane32_swap_b32 v108, v112
  v_permlane32_swap_b32 v109, v113
  v_permlane32_swap_b32 v110, v114
  v_permlane32_swap_b32 v111, v115
  v_pk_add_f32 v[108:109], v[108:109], v[112:113]
  v_pk_add_f32 v[110:111], v[110:111], v[114:115]
  ds_write_b128 v137, v[108:111]
  buffer_store_dword v129, v130, s[8:11], s48 offen offset:0 sc1
  s_add_u32 s33, s45, 8192
  s_cmp_ge_u32 s3, 2
  s_waitcnt lgkmcnt(0)
  s_barrier
  s_cbranch_scc1 L_b_idle_101
  ds_read2st64_b32 v[32:33], v138 offset0:0 offset1:4
  ds_read2st64_b32 v[36:37], v138 offset0:8 offset1:12
  ds_read2st64_b32 v[34:35], v139 offset0:0 offset1:4
  ds_read2st64_b32 v[38:39], v139 offset0:8 offset1:12
  s_waitcnt lgkmcnt(2)
  v_pk_add_f32 v[32:33], v[32:33], v[36:37]
  v_add_f32 v32, v32, v33
  s_waitcnt lgkmcnt(0)
  v_pk_add_f32 v[34:35], v[34:35], v[38:39]
  v_add_f32 v34, v34, v35
  v_cvt_pk_bf16_f32 v32, v32, v34
  v_min_u32 v32, -2, v32
  buffer_store_dword v32, v140, s[8:11], s33 offen sc1
L_b_next_93:
  s_add_u32 s44, s44, 1
  s_add_u32 s45, s45, 8192
  s_add_u32 s46, s46, 10240
  s_add_u32 s47, s47, 458752
  s_add_u32 s48, s48, 16384
  s_barrier
  s_cmp_eq_u32 s44, 63
  s_cbranch_scc0 L_b_top_92
  s_cmp_ge_u32 s3, 2
  s_cbranch_scc1 L_b_last_94
  s_mov_b32 s33, 46391296
  buffer_store_dword v32, v140, s[8:11], s33 offen sc1
L_b_last_94:
  s_waitcnt vmcnt(0)
  s_endpgm
L_b_ok_104:
  s_nop 1
  v_mov_b64 v[108:109], 0
  v_mov_b64 v[110:111], 0
  v_mov_b64 v[112:113], 0
  v_mov_b64 v[114:115], 0
  s_branch L_b_gp_100
L_b_idle_101:
  s_branch L_b_next_93
L_chain_f:
  v_lshlrev_b32 v21, 7, v1
  s_mov_b32 s46, 75857920
  v_lshlrev_b32 v4, 3, v3
  v_mov_b32 v5, 68
  v_min_u32 v7, 4224, v4
L_ws_108:
  s_sleep 40
  s_mov_b32 s35, 77721600
  buffer_load_dwordx2 v[8:9], v4, s[8:11], s35 offen sc1
  s_mov_b32 s35, 77729792
  buffer_load_dwordx2 v[10:11], v4, s[8:11], s35 offen sc1
  s_mov_b32 s35, 77737984
  buffer_load_dwordx2 v[12:13], v4, s[8:11], s35 offen sc1
  s_mov_b32 s35, 77746176
  buffer_load_dwordx2 v[14:15], v7, s[8:11], s35 offen sc1
  buffer_load_dwordx2 v[16:17], v21, s[8:11], s46 offen sc1
  buffer_load_dword v6, v5, s[12:15], 0 offen sc1
  s_add_u32 s6, s6, 1
  s_cmp_gt_u32 s6, 262144
  s_cbranch_scc1 L_timeout
  s_waitcnt vmcnt(0)
  v_readfirstlane_b32 s34, v6
  v_cmp_ne_u32 vcc, s98, v8
  v_cmp_ne_u32 s[36:37], s98, v9
  s_or_b64 vcc, vcc, s[36:37]
  v_cmp_ne_u32 s[36:37], s98, v10
  s_or_b64 vcc, vcc, s[36:37]
  v_cmp_ne_u32 s[36:37], s98, v11
  s_or_b64 vcc, vcc, s[36:37]
  v_cmp_ne_u32 s[36:37], s98, v12
  s_or_b64 vcc, vcc, s[36:37]
  v_cmp_ne_u32 s[36:37], s98, v13
  s_or_b64 vcc, vcc, s[36:37]
  v_cmp_ne_u32 s[36:37], s98, v14
  s_or_b64 vcc, vcc, s[36:37]
  v_cmp_ne_u32 s[36:37], s98, v15
  s_or_b64 vcc, vcc, s[36:37]
  v_cmp_ne_u32 s[36:37], s98, v16
  s_or_b64 vcc, vcc, s[36:37]
  v_cmp_ne_u32 s[36:37], s98, v17
  s_or_b64 vcc, vcc, s[36:37]
  s_cbranch_vccnz L_ws_108
  s_and_b32 s35, s34, 0xff
  s_cmp_eq_u32 s35, 32
  s_cbranch_scc0 L_ws_108
  s_waitcnt lgkmcnt(0)
  s_lshr_b32 s34, s34, 8
  s_cmp_eq_u32 s34, 0
  s_cbranch_scc0 L_f_go_107
L_f_go_107:
  s_mul_i32 s33, s3, 1792
  v_add_u32 v12, s33, v3
  v_min_u32 v13, 47, v0
  v_lshlrev_b32 v13, 4, v13
  s_add_u32 s33, s33, 1024
  v_add_u32 v13, s33, v13
  s_mul_i32 s33, s3, 7168
  v_lshlrev_b32 v20, 3, v3
  v_add_u32 v20, s33, v20
  s_mov_b32 s44, -2
  s_add_u32 s33, s44, 2
  s_min_u32 s33, s33, 63
  s_mul_i32 s33, s33, 28672
  s_add_u32 s33, s33, 14680064
  buffer_load_dword v16, v20, s[8:11], s33 offen sc1
  s_mov_b32 s44, -1
  s_add_u32 s33, s44, 2
  s_min_u32 s33, s33, 63
  s_mul_i32 s33, s33, 28672
  s_add_u32 s33, s33, 14680064
  buffer_load_dword v16, v20, s[8:11], s33 offen sc1
  s_mov_b32 s44, 0
  s_add_u32 s33, s44, 2
  s_min_u32 s33, s33, 63
  s_mul_i32 s33, s33, 28672
  s_add_u32 s33, s33, 14680064
  buffer_load_dword v16, v20, s[8:11], s33 offen sc1
  s_mov_b32 s44, 1
  s_mov_b32 s45, 46407680
  s_mov_b32 s46, 45883392
L_f_poll_109:
  buffer_load_dwordx4 v[4:7], v12, s[8:11], s45 offen sc1
  buffer_load_dwordx4 v[8:11], v13, s[8:11], s45 offen sc1
  s_add_u32 s6, s6, 1
  s_cmp_gt_u32 s6, 262144
  s_cbranch_scc1 L_timeout
  s_waitcnt vmcnt(0)
  v_max3_u32 v14, v4, v5, v6
  v_max3_u32 v15, v7, v8, v9
  v_max3_u32 v14, v14, v10, v11
  v_max_u32 v14, v14, v15
  v_cmp_eq_u32 vcc, -1, v14
  s_cbranch_vccz L_f_got_110
  s_sleep 0
  s_branch L_f_poll_109
L_f_got_110:
  buffer_store_dwordx4 v[4:7], v12, s[8:11], s46 offen sc1
  buffer_store_dwordx4 v[8:11], v13, s[8:11], s46 offen sc1
  s_add_u32 s33, s44, 2
  s_min_u32 s33, s33, 63
  s_mul_i32 s33, s33, 28672
  s_add_u32 s33, s33, 14680064
  buffer_load_dword v16, v20, s[8:11], s33 offen sc1
  s_add_u32 s44, s44, 1
  s_add_u32 s45, s45, 8192
  s_add_u32 s46, s46, 8192
  s_cmp_lt_u32 s44, 63
  s_cbranch_scc1 L_f_poll_109
  s_endpgm
L_chain_g:
  s_cmp_eq_u32 s3, 1
  s_cbranch_scc1 L_g_touch_111
  s_cmp_eq_u32 s3, 0
  s_cbranch_scc0 L_exit
  s_mov_b32 s44, 0
  s_mov_b32 s45, 47587392
  s_mov_b32 s46, 75886592
  v_lshlrev_b32 v6, 7, v1
  v_min_u32 v7, 55, v0
  v_lshlrev_b32 v7, 7, v7
  v_mov_b32 v14, s98
  v_mov_b32 v15, s98
  v_mov_b32 v5, 68
L_reg_113:
  s_sleep 16
  buffer_load_dword v4, v5, s[12:15], 0 offen sc1
  s_add_u32 s6, s6, 1
  s_cmp_gt_u32 s6, 262144
  s_cbranch_scc1 L_timeout
  s_waitcnt vmcnt(0)
  v_readfirstlane_b32 s34, v4
  s_and_b32 s35, s34, 0xff
  s_cmp_eq_u32 s35, 32
  s_cbranch_scc0 L_reg_113
  s_waitcnt lgkmcnt(0)
  s_lshr_b32 s34, s34, 8
  s_cmp_eq_u32 s34, 0
  s_cbranch_scc0 L_g_slow_112
L_g_top_114:
  s_cmp_eq_u32 s44, 2
  s_cbranch_scc0 L_g_go_116
  s_cmp_eq_u32 s3, 0
  s_cbranch_scc0 L_wpd_118
  v_and_b32 v4, 31, v0
  v_lshlrev_b32 v4, 7, v4
  s_mov_b32 s34, 77750272
L_wp_117:
  s_add_u32 s35, s34, 0
  buffer_load_dwordx2 v[8:9], v4, s[8:11], s35 offen sc1
  s_add_u32 s6, s6, 1
  s_cmp_gt_u32 s6, 262144
  s_cbranch_scc1 L_timeout
  s_waitcnt vmcnt(0)
  v_cmp_ne_u32 vcc, s98, v8
  v_cmp_ne_u32 s[36:37], s98, v9
  s_or_b64 vcc, vcc, s[36:37]
  s_cbranch_vccz L_wpd_118
  s_sleep 2
  s_branch L_wp_117
L_wpd_118:
L_g_go_116:
L_g_poll_119:
  buffer_load_dwordx2 v[10:11], v6, s[8:11], s46 offen sc1
  s_add_u32 s6, s6, 1
  s_cmp_gt_u32 s6, 262144
  s_cbranch_scc1 L_timeout
  s_waitcnt vmcnt(0)
  v_cmp_ne_u32 vcc, s98, v10
  v_cmp_ne_u32 s[36:37], s98, v11
  s_or_b64 vcc, vcc, s[36:37]
  s_cbranch_vccz L_g_ok_115
  s_sleep 2
  s_branch L_g_poll_119
L_g_ok_115:
  buffer_store_dwordx2 v[14:15], v7, s[8:11], s45 offen
  s_add_u32 s44, s44, 1
  s_add_u32 s45, s45, 16384
  s_add_u32 s46, s46, 28672
  s_cmp_lt_u32 s44, 63
  s_cbranch_scc1 L_g_top_114
  s_endpgm
L_g_slow_112:
L_g_top_120:
  s_cmp_eq_u32 s44, 2
  s_cbranch_scc0 L_g_go_122
  s_cmp_eq_u32 s3, 0
  s_cbranch_scc0 L_wpd_124
  v_and_b32 v4, 31, v0
  v_lshlrev_b32 v4, 7, v4
  s_mov_b32 s34, 77750272
L_wp_123:
  s_add_u32 s35, s34, 0
  buffer_load_dwordx2 v[8:9], v4, s[8:11], s35 offen sc1
  s_add_u32 s6, s6, 1
  s_cmp_gt_u32 s6, 262144
  s_cbranch_scc1 L_timeout
  s_waitcnt vmcnt(0)
  v_cmp_ne_u32 vcc, s98, v8
  v_cmp_ne_u32 s[36:37], s98, v9
  s_or_b64 vcc, vcc, s[36:37]
  s_cbranch_vccz L_wpd_124
  s_sleep 2
  s_branch L_wp_123
L_wpd_124:
L_g_go_122:
L_g_poll_125:
  buffer_load_dwordx2 v[10:11], v6, s[8:11], s46 offen sc1
  s_add_u32 s6, s6, 1
  s_cmp_gt_u32 s6, 262144
  s_cbranch_scc1 L_timeout
  s_waitcnt vmcnt(0)
  v_cmp_ne_u32 vcc, s98, v10
  v_cmp_ne_u32 s[36:37], s98, v11
  s_or_b64 vcc, vcc, s[36:37]
  s_cbranch_vccz L_g_ok_121
  s_sleep 2
  s_branch L_g_poll_125
L_g_ok_121:
  buffer_store_dwordx2 v[14:15], v7, s[8:11], s45 offen sc1
  s_add_u32 s44, s44, 1
  s_add_u32 s45, s45, 16384
  s_add_u32 s46, s46, 28672
  s_cmp_lt_u32 s44, 63
  s_cbranch_scc1 L_g_top_120
  s_endpgm
L_g_touch_111:
  v_lshlrev_b32 v20, 7, v1
  s_mov_b32 s46, 75857920
  v_lshlrev_b32 v4, 3, v3
  v_mov_b32 v5, 68
  v_min_u32 v7, 4224, v4
L_ws_127:
  s_sleep 40
  s_mov_b32 s35, 77721600
  buffer_load_dwordx2 v[8:9], v4, s[8:11], s35 offen sc1
  s_mov_b32 s35, 77729792
  buffer_load_dwordx2 v[10:11], v4, s[8:11], s35 offen sc1
  s_mov_b32 s35, 77737984
  buffer_load_dwordx2 v[12:13], v4, s[8:11], s35 offen sc1
  s_mov_b32 s35, 77746176
  buffer_load_dwordx2 v[14:15], v7, s[8:11], s35 offen sc1
  buffer_load_dwordx2 v[16:17], v20, s[8:11], s46 offen sc1
  buffer_load_dword v6, v5, s[12:15], 0 offen sc1
  s_add_u32 s6, s6, 1
  s_cmp_gt_u32 s6, 262144
  s_cbranch_scc1 L_timeout
  s_waitcnt vmcnt(0)
  v_readfirstlane_b32 s34, v6
  v_cmp_ne_u32 vcc, s98, v8
  v_cmp_ne_u32 s[36:37], s98, v9
  s_or_b64 vcc, vcc, s[36:37]
  v_cmp_ne_u32 s[36:37], s98, v10
  s_or_b64 vcc, vcc, s[36:37]
  v_cmp_ne_u32 s[36:37], s98, v11
  s_or_b64 vcc, vcc, s[36:37]
  v_cmp_ne_u32 s[36:37], s98, v12
  s_or_b64 vcc, vcc, s[36:37]
  v_cmp_ne_u32 s[36:37], s98, v13
  s_or_b64 vcc, vcc, s[36:37]
  v_cmp_ne_u32 s[36:37], s98, v14
  s_or_b64 vcc, vcc, s[36:37]
  v_cmp_ne_u32 s[36:37], s98, v15
  s_or_b64 vcc, vcc, s[36:37]
  v_cmp_ne_u32 s[36:37], s98, v16
  s_or_b64 vcc, vcc, s[36:37]
  v_cmp_ne_u32 s[36:37], s98, v17
  s_or_b64 vcc, vcc, s[36:37]
  s_cbranch_vccnz L_ws_127
  s_and_b32 s35, s34, 0xff
  s_cmp_eq_u32 s35, 32
  s_cbranch_scc0 L_ws_127
  s_waitcnt lgkmcnt(0)
  s_lshr_b32 s34, s34, 8
  s_cmp_eq_u32 s34, 0
  s_cbranch_scc0 L_t_go_126
L_t_go_126:
  v_lshlrev_b32 v6, 3, v3
  v_mov_b32 v7, 0
  v_min_u32 v8, 1920, v6
  s_mov_b32 s44, -3
  s_add_u32 s33, s44, 3
  s_min_u32 s33, s33, 63
  s_mul_i32 s33, s33, 16384
  s_add_u32 s33, s33, 47579136
  buffer_load_dword v10, v6, s[8:11], s33 offen sc1
  s_add_u32 s33, s33, 8192
  buffer_load_dword v10, v6, s[8:11], s33 offen sc1
  s_add_u32 s33, s33, 8192
  s_add_u32 s33, s44, 3
  s_min_u32 s33, s33, 62
  s_mul_i32 s33, s33, 10240
  s_add_u32 s33, s33, 46923776
  buffer_load_dword v10, v6, s[8:11], s33 offen sc1
  s_add_u32 s33, s33, 8192
  buffer_load_dword v10, v8, s[8:11], s33 offen sc1
  s_add_u32 s33, s33, 8192
  s_add_u32 s33, s44, 3
  s_min_u32 s33, s33, 63
  s_mul_i32 s33, s33, 8192
  s_add_u32 s33, s33, 46399488
  buffer_load_dword v10, v6, s[8:11], s33 offen sc1
  s_add_u32 s33, s33, 8192
  s_mov_b32 s44, -2
  s_add_u32 s33, s44, 3
  s_min_u32 s33, s33, 63
  s_mul_i32 s33, s33, 16384
  s_add_u32 s33, s33, 47579136
  buffer_load_dword v10, v6, s[8:11], s33 offen sc1
  s_add_u32 s33, s33, 8192
  buffer_load_dword v10, v6, s[8:11], s33 offen sc1
  s_add_u32 s33, s33, 8192
  s_add_u32 s33, s44, 3
  s_min_u32 s33, s33, 62
  s_mul_i32 s33, s33, 10240
  s_add_u32 s33, s33, 46923776
  buffer_load_dword v10, v6, s[8:11], s33 offen sc1
  s_add_u32 s33, s33, 8192
  buffer_load_dword v10, v8, s[8:11], s33 offen sc1
  s_add_u32 s33, s33, 8192
  s_add_u32 s33, s44, 3
  s_min_u32 s33, s33, 63
  s_mul_i32 s33, s33, 8192
  s_add_u32 s33, s33, 46399488
  buffer_load_dword v10, v6, s[8:11], s33 offen sc1
  s_add_u32 s33, s33, 8192
  s_mov_b32 s44, -1
  s_add_u32 s33, s44, 3
  s_min_u32 s33, s33, 63
  s_mul_i32 s33, s33, 16384
  s_add_u32 s33, s33, 47579136
  buffer_load_dword v10, v6, s[8:11], s33 offen sc1
  s_add_u32 s33, s33, 8192
  buffer_load_dword v10, v6, s[8:11], s33 offen sc1
  s_add_u32 s33, s33, 8192
  s_add_u32 s33, s44, 3
  s_min_u32 s33, s33, 62
  s_mul_i32 s33, s33, 10240
  s_add_u32 s33, s33, 46923776
  buffer_load_dword v10, v6, s[8:11], s33 offen sc1
  s_add_u32 s33, s33, 8192
  buffer_load_dword v10, v8, s[8:11], s33 offen sc1
  s_add_u32 s33, s33, 8192
  s_add_u32 s33, s44, 3
  s_min_u32 s33, s33, 63
  s_mul_i32 s33, s33, 8192
  s_add_u32 s33, s33, 46399488
  buffer_load_dword v10, v6, s[8:11], s33 offen sc1
  s_add_u32 s33, s33, 8192
  s_mov_b32 s44, 0
  s_add_u32 s33, s44, 3
  s_min_u32 s33, s33, 63
  s_mul_i32 s33, s33, 16384
  s_add_u32 s33, s33, 47579136
  buffer_load_dword v10, v6, s[8:11], s33 offen sc1
  s_add_u32 s33, s33, 8192
  buffer_load_dword v10, v6, s[8:11], s33 offen sc1
  s_add_u32 s33, s33, 8192
  s_add_u32 s33, s44, 3
  s_min_u32 s33, s33, 62
  s_mul_i32 s33, s33, 10240
  s_add_u32 s33, s33, 46923776
  buffer_load_dword v10, v6, s[8:11], s33 offen sc1
  s_add_u32 s33, s33, 8192
  buffer_load_dword v10, v8, s[8:11], s33 offen sc1
  s_add_u32 s33, s33, 8192
  s_add_u32 s33, s44, 3
  s_min_u32 s33, s33, 63
  s_mul_i32 s33, s33, 8192
  s_add_u32 s33, s33, 46399488
  buffer_load_dword v10, v6, s[8:11], s33 offen sc1
  s_add_u32 s33, s33, 8192
  s_mov_b32 s44, 1
  s_mov_b32 s46, 46407680
L_t_poll_128:
  buffer_load_dword v9, v7, s[8:11], s46 offen sc1
  s_add_u32 s6, s6, 1
  s_cmp_gt_u32 s6, 262144
  s_cbranch_scc1 L_timeout
  s_waitcnt vmcnt(0)
  v_cmp_eq_u32 vcc, -1, v9
  s_cbranch_vccz L_t_got_129
  s_sleep 2
  s_branch L_t_poll_128
L_t_got_129:
  s_add_u32 s33, s44, 3
  s_min_u32 s33, s33, 63
  s_mul_i32 s33, s33, 16384
  s_add_u32 s33, s33, 47579136
  buffer_load_dword v10, v6, s[8:11], s33 offen sc1
  s_add_u32 s33, s33, 8192
  buffer_load_dword v10, v6, s[8:11], s33 offen sc1
  s_add_u32 s33, s33, 8192
  s_add_u32 s33, s44, 3
  s_min_u32 s33, s33, 62
  s_mul_i32 s33, s33, 10240
  s_add_u32 s33, s33, 46923776
  buffer_load_dword v10, v6, s[8:11], s33 offen sc1
  s_add_u32 s33, s33, 8192
  buffer_load_dword v10, v8, s[8:11], s33 offen sc1
  s_add_u32 s33, s33, 8192
  s_add_u32 s33, s44, 3
  s_min_u32 s33, s33, 63
  s_mul_i32 s33, s33, 8192
  s_add_u32 s33, s33, 46399488
  buffer_load_dword v10, v6, s[8:11], s33 offen sc1
  s_add_u32 s33, s33, 8192
  s_add_u32 s44, s44, 1
  s_add_u32 s46, s46, 8192
  s_cmp_lt_u32 s44, 61
  s_cbranch_scc1 L_t_poll_128
  s_endpgm
L_y:
  s_mov_b32 s44, s31
  s_mul_i32 s46, s3, 7168
  s_mul_i32 s45, s31, 28672
  s_add_u32 s45, s45, s46
  s_add_u32 s45, s45, 12845056
  s_mul_i32 s35, s30, 401408
  s_mul_i32 s36, s3, 100352
  s_add_u32 s35, s35, s36
  s_add_u32 s35, s35, 6422528
  s_mul_i32 s33, s3, 7
  v_min_u32 v4, 6, v0
  v_add_u32 v4, s33, v4
  v_lshrrev_b32 v4, 2, v4
  s_mul_i32 s33, s30, 7
  s_add_u32 s33, s33, 112
  v_add_u32 v4, s33, v4
  v_lshlrev_b32 v4, 7, v4
  v_add_u32 v4, 1863680, v4
  v_and_b32 v5, 1, v0
  v_lshlrev_b32 v5, 7, v5
  v_add_u32 v5, 1892352, v5
  v_cmp_gt_u32 vcc, 32, v0
  s_nop 1
  v_cndmask_b32 v4, v5, v4, vcc
  s_mov_b32 s38, 0
  s_mov_b32 s39, 75857920
L_lp_130:
  buffer_load_dwordx2 v[6:7], v4, s[8:11], s39 offen sc1
  s_add_u32 s6, s6, 1
  s_cmp_gt_u32 s6, 262144
  s_cbranch_scc1 L_timeout
  s_waitcnt vmcnt(0)
  v_cmp_eq_u32 vcc, s98, v6
  v_cmp_eq_u32 s[42:43], s98, v7
  s_and_b64 vcc, vcc, s[42:43]
  s_and_b32 s40, vcc_lo, 127
  s_cmp_eq_u32 vcc_hi, -1
  s_cselect_b32 s42, 128, 0
  s_or_b32 s40, s40, s42
  s_andn2_b32 s40, s40, s38
  s_bitcmp1_b32 s40, 0
  s_cbranch_scc0 L_lps_131
  s_waitcnt vmcnt(49)
  s_add_u32 s41, s35, 0
  buffer_load_dwordx4 a[0:3], v3, s[8:11], s41 offen offset:0 sc1
  buffer_load_dwordx4 a[4:7], v3, s[8:11], s41 offen offset:1024 sc1
  buffer_load_dwordx4 a[8:11], v3, s[8:11], s41 offen offset:2048 sc1
  buffer_load_dwordx4 a[12:15], v3, s[8:11], s41 offen offset:3072 sc1
  s_add_u32 s41, s35, 4096
  buffer_load_dwordx4 a[16:19], v3, s[8:11], s41 offen offset:0 sc1
  buffer_load_dwordx4 a[20:23], v3, s[8:11], s41 offen offset:1024 sc1
  buffer_load_dwordx4 a[24:27], v3, s[8:11], s41 offen offset:2048 sc1
  buffer_load_dwordx4 a[28:31], v3, s[8:11], s41 offen offset:3072 sc1
  s_add_u32 s41, s35, 8192
  buffer_load_dwordx4 a[32:35], v3, s[8:11], s41 offen offset:0 sc1
  buffer_load_dwordx4 a[36:39], v3, s[8:11], s41 offen offset:1024 sc1
  buffer_load_dwordx4 a[40:43], v3, s[8:11], s41 offen offset:2048 sc1
  buffer_load_dwordx4 a[44:47], v3, s[8:11], s41 offen offset:3072 sc1
  s_add_u32 s41, s35, 12288
  buffer_load_dwordx4 a[48:51], v3, s[8:11], s41 offen offset:0 sc1
  buffer_load_dwordx4 a[52:55], v3, s[8:11], s41 offen offset:1024 sc1
L_lps_131:
  s_bitcmp1_b32 s40, 1
  s_cbranch_scc0 L_lps_132
  s_waitcnt vmcnt(49)
  s_add_u32 s41, s35, 14336
  buffer_load_dwordx4 a[56:59], v3, s[8:11], s41 offen offset:0 sc1
  buffer_load_dwordx4 a[60:63], v3, s[8:11], s41 offen offset:1024 sc1
  buffer_load_dwordx4 a[64:67], v3, s[8:11], s41 offen offset:2048 sc1
  buffer_load_dwordx4 a[68:71], v3, s[8:11], s41 offen offset:3072 sc1
  s_add_u32 s41, s35, 18432
  buffer_load_dwordx4 a[72:75], v3, s[8:11], s41 offen offset:0 sc1
  buffer_load_dwordx4 a[76:79], v3, s[8:11], s41 offen offset:1024 sc1
  buffer_load_dwordx4 a[80:83], v3, s[8:11], s41 offen offset:2048 sc1
  buffer_load_dwordx4 a[84:87], v3, s[8:11], s41 offen offset:3072 sc1
  s_add_u32 s41, s35, 22528
  buffer_load_dwordx4 a[88:91], v3, s[8:11], s41 offen offset:0 sc1
  buffer_load_dwordx4 a[92:95], v3, s[8:11], s41 offen offset:1024 sc1
  buffer_load_dwordx4 a[96:99], v3, s[8:11], s41 offen offset:2048 sc1
  buffer_load_dwordx4 a[100:103], v3, s[8:11], s41 offen offset:3072 sc1
  s_add_u32 s41, s35, 26624
  buffer_load_dwordx4 a[104:107], v3, s[8:11], s41 offen offset:0 sc1
  buffer_load_dwordx4 a[108:111], v3, s[8:11], s41 offen offset:1024 sc1
L_lps_132:
  s_bitcmp1_b32 s40, 2
  s_cbranch_scc0 L_lps_133
  s_waitcnt vmcnt(49)
  s_add_u32 s41, s35, 28672
  buffer_load_dwordx4 a[112:115], v3, s[8:11], s41 offen offset:0 sc1
  buffer_load_dwordx4 a[116:119], v3, s[8:11], s41 offen offset:1024 sc1
  buffer_load_dwordx4 a[120:123], v3, s[8:11], s41 offen offset:2048 sc1
  buffer_load_dwordx4 a[124:127], v3, s[8:11], s41 offen offset:3072 sc1
  s_add_u32 s41, s35, 32768
  buffer_load_dwordx4 a[128:131], v3, s[8:11], s41 offen offset:0 sc1
  buffer_load_dwordx4 a[132:135], v3, s[8:11], s41 offen offset:1024 sc1
  buffer_load_dwordx4 a[136:139], v3, s[8:11], s41 offen offset:2048 sc1
  buffer_load_dwordx4 a[140:143], v3, s[8:11], s41 offen offset:3072 sc1
  s_add_u32 s41, s35, 36864
  buffer_load_dwordx4 a[144:147], v3, s[8:11], s41 offen offset:0 sc1
  buffer_load_dwordx4 a[148:151], v3, s[8:11], s41 offen offset:1024 sc1
  buffer_load_dwordx4 a[152:155], v3, s[8:11], s41 offen offset:2048 sc1
  buffer_load_dwordx4 a[156:159], v3, s[8:11], s41 offen offset:3072 sc1
  s_add_u32 s41, s35, 40960
  buffer_load_dwordx4 a[160:163], v3, s[8:11], s41 offen offset:0 sc1
  buffer_load_dwordx4 a[164:167], v3, s[8:11], s41 offen offset:1024 sc1
L_lps_133:
  s_bitcmp1_b32 s40, 3
  s_cbranch_scc0 L_lps_134
  s_waitcnt vmcnt(49)
  s_add_u32 s41, s35, 43008
  buffer_load_dwordx4 a[168:171], v3, s[8:11], s41 offen offset:0 sc1
  buffer_load_dwordx4 a[172:175], v3, s[8:11], s41 offen offset:1024 sc1
  buffer_load_dwordx4 a[176:179], v3, s[8:11], s41 offen offset:2048 sc1
  buffer_load_dwordx4 a[180:183], v3, s[8:11], s41 offen offset:3072 sc1
  s_add_u32 s41, s35, 47104
  buffer_load_dwordx4 a[184:187], v3, s[8:11], s41 offen offset:0 sc1
  buffer_load_dwordx4 a[188:191], v3, s[8:11], s41 offen offset:1024 sc1
  buffer_load_dwordx4 a[192:195], v3, s[8:11], s41 offen offset:2048 sc1
  buffer_load_dwordx4 a[196:199], v3, s[8:11], s41 offen offset:3072 sc1
  s_add_u32 s41, s35, 51200
  buffer_load_dwordx4 a[200:203], v3, s[8:11], s41 offen offset:0 sc1
  buffer_load_dwordx4 a[204:207], v3, s[8:11], s41 offen offset:1024 sc1
  buffer_load_dwordx4 a[208:211], v3, s[8:11], s41 offen offset:2048 sc1
  buffer_load_dwordx4 a[212:215], v3, s[8:11], s41 offen offset:3072 sc1
  s_add_u32 s41, s35, 55296
  buffer_load_dwordx4 a[216:219], v3, s[8:11], s41 offen offset:0 sc1
  buffer_load_dwordx4 a[220:223], v3, s[8:11], s41 offen offset:1024 sc1
L_lps_134:
  s_bitcmp1_b32 s40, 4
  s_cbranch_scc0 L_lps_135
  s_waitcnt vmcnt(49)
  s_add_u32 s41, s35, 57344
  buffer_load_dwordx4 a[224:227], v3, s[8:11], s41 offen offset:0 sc1
  buffer_load_dwordx4 a[228:231], v3, s[8:11], s41 offen offset:1024 sc1
  buffer_load_dwordx4 a[232:235], v3, s[8:11], s41 offen offset:2048 sc1
  buffer_load_dwordx4 a[236:239], v3, s[8:11], s41 offen offset:3072 sc1
  s_add_u32 s41, s35, 61440
  buffer_load_dwordx4 a[240:243], v3, s[8:11], s41 offen offset:0 sc1
  buffer_load_dwordx4 a[244:247], v3, s[8:11], s41 offen offset:1024 sc1
  buffer_load_dwordx4 a[248:251], v3, s[8:11], s41 offen offset:2048 sc1
  buffer_load_dwordx4 a[252:255], v3, s[8:11], s41 offen offset:3072 sc1
  s_add_u32 s41, s35, 65536
  buffer_load_dwordx4 v[120:123], v3, s[8:11], s41 offen offset:0 sc1
  buffer_load_dwordx4 v[124:127], v3, s[8:11], s41 offen offset:1024 sc1
  buffer_load_dwordx4 v[128:131], v3, s[8:11], s41 offen offset:2048 sc1
  buffer_load_dwordx4 v[132:135], v3, s[8:11], s41 offen offset:3072 sc1
  s_add_u32 s41, s35, 69632
  buffer_load_dwordx4 v[136:139], v3, s[8:11], s41 offen offset:0 sc1
  buffer_load_dwordx4 v[140:143], v3, s[8:11], s41 offen offset:1024 sc1
L_lps_135:
  s_bitcmp1_b32 s40, 5
  s_cbranch_scc0 L_lps_136
  s_waitcnt vmcnt(49)
  s_add_u32 s41, s35, 71680
  buffer_load_dwordx4 v[144:147], v3, s[8:11], s41 offen offset:0 sc1
  buffer_load_dwordx4 v[148:151], v3, s[8:11], s41 offen offset:1024 sc1
  buffer_load_dwordx4 v[152:155], v3, s[8:11], s41 offen offset:2048 sc1
  buffer_load_dwordx4 v[156:159], v3, s[8:11], s41 offen offset:3072 sc1
  s_add_u32 s41, s35, 75776
  buffer_load_dwordx4 v[160:163], v3, s[8:11], s41 offen offset:0 sc1
  buffer_load_dwordx4 v[164:167], v3, s[8:11], s41 offen offset:1024 sc1
  buffer_load_dwordx4 v[168:171], v3, s[8:11], s41 offen offset:2048 sc1
  buffer_load_dwordx4 v[172:175], v3, s[8:11], s41 offen offset:3072 sc1
  s_add_u32 s41, s35, 79872
  buffer_load_dwordx4 v[176:179], v3, s[8:11], s41 offen offset:0 sc1
  buffer_load_dwordx4 v[180:183], v3, s[8:11], s41 offen offset:1024 sc1
  buffer_load_dwordx4 v[184:187], v3, s[8:11], s41 offen offset:2048 sc1
  buffer_load_dwordx4 v[188:191], v3, s[8:11], s41 offen offset:3072 sc1
  s_add_u32 s41, s35, 83968
  buffer_load_dwordx4 v[192:195], v3, s[8:11], s41 offen offset:0 sc1
  buffer_load_dwordx4 v[196:199], v3, s[8:11], s41 offen offset:1024 sc1
L_lps_136:
  s_bitcmp1_b32 s40, 6
  s_cbranch_scc0 L_lps_137
  s_waitcnt vmcnt(49)
  s_add_u32 s41, s35, 86016
  buffer_load_dwordx4 v[200:203], v3, s[8:11], s41 offen offset:0 sc1
  buffer_load_dwordx4 v[204:207], v3, s[8:11], s41 offen offset:1024 sc1
  buffer_load_dwordx4 v[208:211], v3, s[8:11], s41 offen offset:2048 sc1
  buffer_load_dwordx4 v[212:215], v3, s[8:11], s41 offen offset:3072 sc1
  s_add_u32 s41, s35, 90112
  buffer_load_dwordx4 v[216:219], v3, s[8:11], s41 offen offset:0 sc1
  buffer_load_dwordx4 v[220:223], v3, s[8:11], s41 offen offset:1024 sc1
  buffer_load_dwordx4 v[224:227], v3, s[8:11], s41 offen offset:2048 sc1
  buffer_load_dwordx4 v[228:231], v3, s[8:11], s41 offen offset:3072 sc1
  s_add_u32 s41, s35, 94208
  buffer_load_dwordx4 v[232:235], v3, s[8:11], s41 offen offset:0 sc1
  buffer_load_dwordx4 v[236:239], v3, s[8:11], s41 offen offset:1024 sc1
  buffer_load_dwordx4 v[240:243], v3, s[8:11], s41 offen offset:2048 sc1
  buffer_load_dwordx4 v[244:247], v3, s[8:11], s41 offen offset:3072 sc1
  s_add_u32 s41, s35, 98304
  buffer_load_dwordx4 v[248:251], v3, s[8:11], s41 offen offset:0 sc1
  buffer_load_dwordx4 v[252:255], v3, s[8:11], s41 offen offset:1024 sc1
L_lps_137:
  s_bitcmp1_b32 s40, 7
  s_cbranch_scc0 L_lps_138
  s_waitcnt vmcnt(56)
  s_add_u32 s33, s46, 0
  s_mov_b32 m0, s33
  s_add_u32 s34, s45, 0
  buffer_load_dwordx4 v3, s[8:11], s34 offen offset:0 sc1 lds
  buffer_load_dwordx4 v3, s[8:11], s34 offen offset:1024 sc1 lds
  buffer_load_dwordx4 v3, s[8:11], s34 offen offset:2048 sc1 lds
  buffer_load_dwordx4 v3, s[8:11], s34 offen offset:3072 sc1 lds
  s_add_u32 s33, s46, 4096
  s_mov_b32 m0, s33
  s_add_u32 s34, s45, 4096
  buffer_load_dwordx4 v3, s[8:11], s34 offen offset:0 sc1 lds
  buffer_load_dwordx4 v3, s[8:11], s34 offen offset:1024 sc1 lds
  buffer_load_dwordx4 v3, s[8:11], s34 offen offset:2048 sc1 lds
L_lps_138:
  s_or_b32 s38, s38, s40
  s_and_b32 s38, s38, 255
  s_cmp_eq_u32 s38, 255
  s_cbranch_scc1 L_lpo_139
  s_sleep 2
  s_branch L_lp_130
L_lpo_139:
  s_lshl_b32 s33, s31, 4
  s_add_u32 s33, s33, s30
  s_mul_i32 s47, s33, 28672
  s_add_u32 s47, s47, 16515072
  s_mul_i32 s33, s3, 7168
  s_add_u32 s47, s47, s33
  s_mul_i32 s48, s31, 28672
  s_lshl_b32 s33, s30, 7
  s_add_u32 s48, s48, s33
  s_add_u32 s48, s48, 75857920
  v_lshrrev_b32 v4, 1, v1
  v_add_u32 v4, 0, v4
  v_lshrrev_b32 v5, 3, v4
  v_lshlrev_b32 v5, 1, v5
  v_xor_b32 v5, v5, v2
  v_lshl_add_u32 v5, v4, 2, v5
  v_lshlrev_b32 v76, 4, v5
  v_and_b32 v4, 1, v1
  v_mul_u32_u24 v4, 14336, v4
  v_add_u32 v76, v76, v4
  v_lshrrev_b32 v4, 1, v1
  v_add_u32 v4, 8, v4
  v_lshrrev_b32 v5, 3, v4
  v_lshlrev_b32 v5, 1, v5
  v_xor_b32 v5, v5, v2
  v_lshl_add_u32 v5, v4, 2, v5
  v_lshlrev_b32 v77, 4, v5
  v_and_b32 v4, 1, v1
  v_mul_u32_u24 v4, 14336, v4
  v_add_u32 v77, v77, v4
  s_waitcnt vmcnt(0)
  s_barrier
L_y_top_140:
  s_add_u32 s33, s44, 3
  s_cmp_ge_u32 s33, 64
  s_cbranch_scc1 L_y_nodma_141
  s_cmp_lt_u32 s44, 3
  s_cbranch_scc1 L_y_nodma_141
  s_add_u32 s45, s45, 86016
  s_xor_b32 s46, s46, 0x8000
  s_add_u32 s33, s46, 0
  s_mov_b32 m0, s33
  s_add_u32 s34, s45, 0
  buffer_load_dwordx4 v3, s[8:11], s34 offen offset:0 sc1 lds
  buffer_load_dwordx4 v3, s[8:11], s34 offen offset:1024 sc1 lds
  buffer_load_dwordx4 v3, s[8:11], s34 offen offset:2048 sc1 lds
  buffer_load_dwordx4 v3, s[8:11], s34 offen offset:3072 sc1 lds
  s_add_u32 s33, s46, 4096
  s_mov_b32 m0, s33
  s_add_u32 s34, s45, 4096
  buffer_load_dwordx4 v3, s[8:11], s34 offen offset:0 sc1 lds
  buffer_load_dwordx4 v3, s[8:11], s34 offen offset:1024 sc1 lds
  buffer_load_dwordx4 v3, s[8:11], s34 offen offset:2048 sc1 lds
L_y_nodma_141:
  ds_read_b128 v[32:35], v76 offset:0
  ds_read_b128 v[36:39], v76 offset:1024
  ds_read_b128 v[40:43], v76 offset:2048
  ds_read_b128 v[44:47], v76 offset:3072
  s_waitcnt lgkmcnt(3)
  v_mfma_f32_16x16x32_bf16 v[4:7], v[32:35], a[0:3], 0
  v_mfma_f32_16x16x32_bf16 v[8:11], v[32:35], a[56:59], 0
  v_mfma_f32_16x16x32_bf16 v[12:15], v[32:35], a[112:115], 0
  v_mfma_f32_16x16x32_bf16 v[16:19], v[32:35], a[168:171], 0
  v_mfma_f32_16x16x32_bf16 v[20:23], v[32:35], a[224:227], 0
  v_mfma_f32_16x16x32_bf16 v[24:27], v[32:35], v[144:147], 0
  v_mfma_f32_16x16x32_bf16 v[28:31], v[32:35], v[200:203], 0
  ds_read_b128 v[32:35], v76 offset:4096
  s_waitcnt lgkmcnt(3)
  v_mfma_f32_16x16x32_bf16 v[4:7], v[36:39], a[4:7], v[4:7]
  v_mfma_f32_16x16x32_bf16 v[8:11], v[36:39], a[60:63], v[8:11]
  v_mfma_f32_16x16x32_bf16 v[12:15], v[36:39], a[116:119], v[12:15]
  v_mfma_f32_16x16x32_bf16 v[16:19], v[36:39], a[172:175], v[16:19]
  v_mfma_f32_16x16x32_bf16 v[20:23], v[36:39], a[228:231], v[20:23]
  v_mfma_f32_16x16x32_bf16 v[24:27], v[36:39], v[148:151], v[24:27]
  v_mfma_f32_16x16x32_bf16 v[28:31], v[36:39], v[204:207], v[28:31]
  ds_read_b128 v[36:39], v76 offset:5120
  s_waitcnt lgkmcnt(3)
  v_mfma_f32_16x16x32_bf16 v[4:7], v[40:43], a[8:11], v[4:7]
  v_mfma_f32_16x16x32_bf16 v[8:11], v[40:43], a[64:67], v[8:11]
  v_mfma_f32_16x16x32_bf16 v[12:15], v[40:43], a[120:123], v[12:15]
  v_mfma_f32_16x16x32_bf16 v[16:19], v[40:43], a[176:179], v[16:19]
  v_mfma_f32_16x16x32_bf16 v[20:23], v[40:43], a[232:235], v[20:23]
  v_mfma_f32_16x16x32_bf16 v[24:27], v[40:43], v[152:155], v[24:27]
  v_mfma_f32_16x16x32_bf16 v[28:31], v[40:43], v[208:211], v[28:31]
  ds_read_b128 v[40:43], v76 offset:6144
  s_waitcnt lgkmcnt(3)
  v_mfma_f32_16x16x32_bf16 v[4:7], v[44:47], a[12:15], v[4:7]
  v_mfma_f32_16x16x32_bf16 v[8:11], v[44:47], a[68:71], v[8:11]
  v_mfma_f32_16x16x32_bf16 v[12:15], v[44:47], a[124:127], v[12:15]
  v_mfma_f32_16x16x32_bf16 v[16:19], v[44:47], a[180:183], v[16:19]
  v_mfma_f32_16x16x32_bf16 v[20:23], v[44:47], a[236:239], v[20:23]
  v_mfma_f32_16x16x32_bf16 v[24:27], v[44:47], v[156:159], v[24:27]
  v_mfma_f32_16x16x32_bf16 v[28:31], v[44:47], v[212:215], v[28:31]
  ds_read_b128 v[44:47], v76 offset:7168
  s_waitcnt lgkmcnt(3)
  v_mfma_f32_16x16x32_bf16 v[4:7], v[32:35], a[16:19], v[4:7]
  v_mfma_f32_16x16x32_bf16 v[8:11], v[32:35], a[72:75], v[8:11]
  v_mfma_f32_16x16x32_bf16 v[12:15], v[32:35], a[128:131], v[12:15]
  v_mfma_f32_16x16x32_bf16 v[16:19], v[32:35], a[184:187], v[16:19]
  v_mfma_f32_16x16x32_bf16 v[20:23], v[32:35], a[240:243], v[20:23]
  v_mfma_f32_16x16x32_bf16 v[24:27], v[32:35], v[160:163], v[24:27]
  v_mfma_f32_16x16x32_bf16 v[28:31], v[32:35], v[216:219], v[28:31]
  ds_read_b128 v[32:35], v76 offset:8192
  s_waitcnt lgkmcnt(3)
  v_mfma_f32_16x16x32_bf16 v[4:7], v[36:39], a[20:23], v[4:7]
  v_mfma_f32_16x16x32_bf16 v[8:11], v[36:39], a[76:79], v[8:11]
  v_mfma_f32_16x16x32_bf16 v[12:15], v[36:39], a[132:135], v[12:15]
  v_mfma_f32_16x16x32_bf16 v[16:19], v[36:39], a[188:191], v[16:19]
  v_mfma_f32_16x16x32_bf16 v[20:23], v[36:39], a[244:247], v[20:23]
  v_mfma_f32_16x16x32_bf16 v[24:27], v[36:39], v[164:167], v[24:27]
  v_mfma_f32_16x16x32_bf16 v[28:31], v[36:39], v[220:223], v[28:31]
  ds_read_b128 v[36:39], v76 offset:9216
  s_waitcnt lgkmcnt(3)
  v_mfma_f32_16x16x32_bf16 v[4:7], v[40:43], a[24:27], v[4:7]
  v_mfma_f32_16x16x32_bf16 v[8:11], v[40:43], a[80:83], v[8:11]
  v_mfma_f32_16x16x32_bf16 v[12:15], v[40:43], a[136:139], v[12:15]
  v_mfma_f32_16x16x32_bf16 v[16:19], v[40:43], a[192:195], v[16:19]
  v_mfma_f32_16x16x32_bf16 v[20:23], v[40:43], a[248:251], v[20:23]
  v_mfma_f32_16x16x32_bf16 v[24:27], v[40:43], v[168:171], v[24:27]
  v_mfma_f32_16x16x32_bf16 v[28:31], v[40:43], v[224:227], v[28:31]
  ds_read_b128 v[40:43], v76 offset:10240
  s_waitcnt lgkmcnt(3)
  v_mfma_f32_16x16x32_bf16 v[4:7], v[44:47], a[28:31], v[4:7]
  v_mfma_f32_16x16x32_bf16 v[8:11], v[44:47], a[84:87], v[8:11]
  v_mfma_f32_16x16x32_bf16 v[12:15], v[44:47], a[140:143], v[12:15]
  v_mfma_f32_16x16x32_bf16 v[16:19], v[44:47], a[196:199], v[16:19]
  v_mfma_f32_16x16x32_bf16 v[20:23], v[44:47], a[252:255], v[20:23]
  v_mfma_f32_16x16x32_bf16 v[24:27], v[44:47], v[172:175], v[24:27]
  v_mfma_f32_16x16x32_bf16 v[28:31], v[44:47], v[228:231], v[28:31]
  ds_read_b128 v[44:47], v76 offset:11264
  s_waitcnt lgkmcnt(3)
  v_mfma_f32_16x16x32_bf16 v[4:7], v[32:35], a[32:35], v[4:7]
  v_mfma_f32_16x16x32_bf16 v[8:11], v[32:35], a[88:91], v[8:11]
  v_mfma_f32_16x16x32_bf16 v[12:15], v[32:35], a[144:147], v[12:15]
  v_mfma_f32_16x16x32_bf16 v[16:19], v[32:35], a[200:203], v[16:19]
  v_mfma_f32_16x16x32_bf16 v[20:23], v[32:35], v[120:123], v[20:23]
  v_mfma_f32_16x16x32_bf16 v[24:27], v[32:35], v[176:179], v[24:27]
  v_mfma_f32_16x16x32_bf16 v[28:31], v[32:35], v[232:235], v[28:31]
  ds_read_b128 v[32:35], v76 offset:12288
  s_waitcnt lgkmcnt(3)
  v_mfma_f32_16x16x32_bf16 v[4:7], v[36:39], a[36:39], v[4:7]
  v_mfma_f32_16x16x32_bf16 v[8:11], v[36:39], a[92:95], v[8:11]
  v_mfma_f32_16x16x32_bf16 v[12:15], v[36:39], a[148:151], v[12:15]
  v_mfma_f32_16x16x32_bf16 v[16:19], v[36:39], a[204:207], v[16:19]
  v_mfma_f32_16x16x32_bf16 v[20:23], v[36:39], v[124:127], v[20:23]
  v_mfma_f32_16x16x32_bf16 v[24:27], v[36:39], v[180:183], v[24:27]
  v_mfma_f32_16x16x32_bf16 v[28:31], v[36:39], v[236:239], v[28:31]
  ds_read_b128 v[36:39], v76 offset:13312
  s_waitcnt lgkmcnt(3)
  v_mfma_f32_16x16x32_bf16 v[4:7], v[40:43], a[40:43], v[4:7]
  v_mfma_f32_16x16x32_bf16 v[8:11], v[40:43], a[96:99], v[8:11]
  v_mfma_f32_16x16x32_bf16 v[12:15], v[40:43], a[152:155], v[12:15]
  v_mfma_f32_16x16x32_bf16 v[16:19], v[40:43], a[208:211], v[16:19]
  v_mfma_f32_16x16x32_bf16 v[20:23], v[40:43], v[128:131], v[20:23]
  v_mfma_f32_16x16x32_bf16 v[24:27], v[40:43], v[184:187], v[24:27]
  v_mfma_f32_16x16x32_bf16 v[28:31], v[40:43], v[240:243], v[28:31]
  ds_read_b128 v[40:43], v77 offset:0
  s_waitcnt lgkmcnt(3)
  v_mfma_f32_16x16x32_bf16 v[4:7], v[44:47], a[44:47], v[4:7]
  v_mfma_f32_16x16x32_bf16 v[8:11], v[44:47], a[100:103], v[8:11]
  v_mfma_f32_16x16x32_bf16 v[12:15], v[44:47], a[156:159], v[12:15]
  v_mfma_f32_16x16x32_bf16 v[16:19], v[44:47], a[212:215], v[16:19]
  v_mfma_f32_16x16x32_bf16 v[20:23], v[44:47], v[132:135], v[20:23]
  v_mfma_f32_16x16x32_bf16 v[24:27], v[44:47], v[188:191], v[24:27]
  v_mfma_f32_16x16x32_bf16 v[28:31], v[44:47], v[244:247], v[28:31]
  ds_read_b128 v[44:47], v77 offset:1024
  s_waitcnt lgkmcnt(3)
  v_mfma_f32_16x16x32_bf16 v[4:7], v[32:35], a[48:51], v[4:7]
  v_mfma_f32_16x16x32_bf16 v[8:11], v[32:35], a[104:107], v[8:11]
  v_mfma_f32_16x16x32_bf16 v[12:15], v[32:35], a[160:163], v[12:15]
  v_mfma_f32_16x16x32_bf16 v[16:19], v[32:35], a[216:219], v[16:19]
  v_mfma_f32_16x16x32_bf16 v[20:23], v[32:35], v[136:139], v[20:23]
  v_mfma_f32_16x16x32_bf16 v[24:27], v[32:35], v[192:195], v[24:27]
  v_mfma_f32_16x16x32_bf16 v[28:31], v[32:35], v[248:251], v[28:31]
  ds_read_b128 v[32:35], v77 offset:2048
  s_waitcnt lgkmcnt(3)
  v_mfma_f32_16x16x32_bf16 v[4:7], v[36:39], a[52:55], v[4:7]
  v_mfma_f32_16x16x32_bf16 v[8:11], v[36:39], a[108:111], v[8:11]
  v_mfma_f32_16x16x32_bf16 v[12:15], v[36:39], a[164:167], v[12:15]
  v_mfma_f32_16x16x32_bf16 v[16:19], v[36:39], a[220:223], v[16:19]
  v_mfma_f32_16x16x32_bf16 v[20:23], v[36:39], v[140:143], v[20:23]
  v_mfma_f32_16x16x32_bf16 v[24:27], v[36:39], v[196:199], v[24:27]
  v_mfma_f32_16x16x32_bf16 v[28:31], v[36:39], v[252:255], v[28:31]
  s_nop 1
  v_cvt_pk_bf16_f32 v48, v4, v5
  v_cvt_pk_bf16_f32 v49, v6, v7
  v_cvt_pk_bf16_f32 v52, v8, v9
  v_cvt_pk_bf16_f32 v53, v10, v11
  v_cvt_pk_bf16_f32 v56, v12, v13
  v_cvt_pk_bf16_f32 v57, v14, v15
  v_cvt_pk_bf16_f32 v60, v16, v17
  v_cvt_pk_bf16_f32 v61, v18, v19
  v_cvt_pk_bf16_f32 v64, v20, v21
  v_cvt_pk_bf16_f32 v65, v22, v23
  v_cvt_pk_bf16_f32 v68, v24, v25
  v_cvt_pk_bf16_f32 v69, v26, v27
  v_cvt_pk_bf16_f32 v72, v28, v29
  v_cvt_pk_bf16_f32 v73, v30, v31
  ds_read_b128 v[36:39], v77 offset:3072
  s_waitcnt lgkmcnt(3)
  v_mfma_f32_16x16x32_bf16 v[4:7], v[40:43], a[0:3], 0
  v_mfma_f32_16x16x32_bf16 v[8:11], v[40:43], a[56:59], 0
  v_mfma_f32_16x16x32_bf16 v[12:15], v[40:43], a[112:115], 0
  v_mfma_f32_16x16x32_bf16 v[16:19], v[40:43], a[168:171], 0
  v_mfma_f32_16x16x32_bf16 v[20:23], v[40:43], a[224:227], 0
  v_mfma_f32_16x16x32_bf16 v[24:27], v[40:43], v[144:147], 0
  v_mfma_f32_16x16x32_bf16 v[28:31], v[40:43], v[200:203], 0
  ds_read_b128 v[40:43], v77 offset:4096
  s_waitcnt lgkmcnt(3)
  v_mfma_f32_16x16x32_bf16 v[4:7], v[44:47], a[4:7], v[4:7]
  v_mfma_f32_16x16x32_bf16 v[8:11], v[44:47], a[60:63], v[8:11]
  v_mfma_f32_16x16x32_bf16 v[12:15], v[44:47], a[116:119], v[12:15]
  v_mfma_f32_16x16x32_bf16 v[16:19], v[44:47], a[172:175], v[16:19]
  v_mfma_f32_16x16x32_bf16 v[20:23], v[44:47], a[228:231], v[20:23]
  v_mfma_f32_16x16x32_bf16 v[24:27], v[44:47], v[148:151], v[24:27]
  v_mfma_f32_16x16x32_bf16 v[28:31], v[44:47], v[204:207], v[28:31]
  ds_read_b128 v[44:47], v77 offset:5120
  s_waitcnt lgkmcnt(3)
  v_mfma_f32_16x16x32_bf16 v[4:7], v[32:35], a[8:11], v[4:7]
  v_mfma_f32_16x16x32_bf16 v[8:11], v[32:35], a[64:67], v[8:11]
  v_mfma_f32_16x16x32_bf16 v[12:15], v[32:35], a[120:123], v[12:15]
  v_mfma_f32_16x16x32_bf16 v[16:19], v[32:35], a[176:179], v[16:19]
  v_mfma_f32_16x16x32_bf16 v[20:23], v[32:35], a[232:235], v[20:23]
  v_mfma_f32_16x16x32_bf16 v[24:27], v[32:35], v[152:155], v[24:27]
  v_mfma_f32_16x16x32_bf16 v[28:31], v[32:35], v[208:211], v[28:31]
  ds_read_b128 v[32:35], v77 offset:6144
  s_waitcnt lgkmcnt(3)
  v_mfma_f32_16x16x32_bf16 v[4:7], v[36:39], a[12:15], v[4:7]
  v_mfma_f32_16x16x32_bf16 v[8:11], v[36:39], a[68:71], v[8:11]
  v_mfma_f32_16x16x32_bf16 v[12:15], v[36:39], a[124:127], v[12:15]
  v_mfma_f32_16x16x32_bf16 v[16:19], v[36:39], a[180:183], v[16:19]
  v_mfma_f32_16x16x32_bf16 v[20:23], v[36:39], a[236:239], v[20:23]
  v_mfma_f32_16x16x32_bf16 v[24:27], v[36:39], v[156:159], v[24:27]
  v_mfma_f32_16x16x32_bf16 v[28:31], v[36:39], v[212:215], v[28:31]
  ds_read_b128 v[36:39], v77 offset:7168
  s_waitcnt lgkmcnt(3)
  v_mfma_f32_16x16x32_bf16 v[4:7], v[40:43], a[16:19], v[4:7]
  v_mfma_f32_16x16x32_bf16 v[8:11], v[40:43], a[72:75], v[8:11]
  v_mfma_f32_16x16x32_bf16 v[12:15], v[40:43], a[128:131], v[12:15]
  v_mfma_f32_16x16x32_bf16 v[16:19], v[40:43], a[184:187], v[16:19]
  v_mfma_f32_16x16x32_bf16 v[20:23], v[40:43], a[240:243], v[20:23]
  v_mfma_f32_16x16x32_bf16 v[24:27], v[40:43], v[160:163], v[24:27]
  v_mfma_f32_16x16x32_bf16 v[28:31], v[40:43], v[216:219], v[28:31]
  ds_read_b128 v[40:43], v77 offset:8192
  s_waitcnt lgkmcnt(3)
  v_mfma_f32_16x16x32_bf16 v[4:7], v[44:47], a[20:23], v[4:7]
  v_mfma_f32_16x16x32_bf16 v[8:11], v[44:47], a[76:79], v[8:11]
  v_mfma_f32_16x16x32_bf16 v[12:15], v[44:47], a[132:135], v[12:15]
  v_mfma_f32_16x16x32_bf16 v[16:19], v[44:47], a[188:191], v[16:19]
  v_mfma_f32_16x16x32_bf16 v[20:23], v[44:47], a[244:247], v[20:23]
  v_mfma_f32_16x16x32_bf16 v[24:27], v[44:47], v[164:167], v[24:27]
  v_mfma_f32_16x16x32_bf16 v[28:31], v[44:47], v[220:223], v[28:31]
  ds_read_b128 v[44:47], v77 offset:9216
  s_waitcnt lgkmcnt(3)
  v_mfma_f32_16x16x32_bf16 v[4:7], v[32:35], a[24:27], v[4:7]
  v_mfma_f32_16x16x32_bf16 v[8:11], v[32:35], a[80:83], v[8:11]
  v_mfma_f32_16x16x32_bf16 v[12:15], v[32:35], a[136:139], v[12:15]
  v_mfma_f32_16x16x32_bf16 v[16:19], v[32:35], a[192:195], v[16:19]
  v_mfma_f32_16x16x32_bf16 v[20:23], v[32:35], a[248:251], v[20:23]
  v_mfma_f32_16x16x32_bf16 v[24:27], v[32:35], v[168:171], v[24:27]
  v_mfma_f32_16x16x32_bf16 v[28:31], v[32:35], v[224:227], v[28:31]
  ds_read_b128 v[32:35], v77 offset:10240
  s_waitcnt lgkmcnt(3)
  v_mfma_f32_16x16x32_bf16 v[4:7], v[36:39], a[28:31], v[4:7]
  v_mfma_f32_16x16x32_bf16 v[8:11], v[36:39], a[84:87], v[8:11]
  v_mfma_f32_16x16x32_bf16 v[12:15], v[36:39], a[140:143], v[12:15]
  v_mfma_f32_16x16x32_bf16 v[16:19], v[36:39], a[196:199], v[16:19]
  v_mfma_f32_16x16x32_bf16 v[20:23], v[36:39], a[252:255], v[20:23]
  v_mfma_f32_16x16x32_bf16 v[24:27], v[36:39], v[172:175], v[24:27]
  v_mfma_f32_16x16x32_bf16 v[28:31], v[36:39], v[228:231], v[28:31]
  ds_read_b128 v[36:39], v77 offset:11264
  s_waitcnt lgkmcnt(3)
  v_mfma_f32_16x16x32_bf16 v[4:7], v[40:43], a[32:35], v[4:7]
  v_mfma_f32_16x16x32_bf16 v[8:11], v[40:43], a[88:91], v[8:11]
  v_mfma_f32_16x16x32_bf16 v[12:15], v[40:43], a[144:147], v[12:15]
  v_mfma_f32_16x16x32_bf16 v[16:19], v[40:43], a[200:203], v[16:19]
  v_mfma_f32_16x16x32_bf16 v[20:23], v[40:43], v[120:123], v[20:23]
  v_mfma_f32_16x16x32_bf16 v[24:27], v[40:43], v[176:179], v[24:27]
  v_mfma_f32_16x16x32_bf16 v[28:31], v[40:43], v[232:235], v[28:31]
  ds_read_b128 v[40:43], v77 offset:12288
  s_waitcnt lgkmcnt(3)
  v_mfma_f32_16x16x32_bf16 v[4:7], v[44:47], a[36:39], v[4:7]
  v_mfma_f32_16x16x32_bf16 v[8:11], v[44:47], a[92:95], v[8:11]
  v_mfma_f32_16x16x32_bf16 v[12:15], v[44:47], a[148:151], v[12:15]
  v_mfma_f32_16x16x32_bf16 v[16:19], v[44:47], a[204:207], v[16:19]
  v_mfma_f32_16x16x32_bf16 v[20:23], v[44:47], v[124:127], v[20:23]
  v_mfma_f32_16x16x32_bf16 v[24:27], v[44:47], v[180:183], v[24:27]
  v_mfma_f32_16x16x32_bf16 v[28:31], v[44:47], v[236:239], v[28:31]
  ds_read_b128 v[44:47], v77 offset:13312
  s_waitcnt lgkmcnt(3)
  v_mfma_f32_16x16x32_bf16 v[4:7], v[32:35], a[40:43], v[4:7]
  v_mfma_f32_16x16x32_bf16 v[8:11], v[32:35], a[96:99], v[8:11]
  v_mfma_f32_16x16x32_bf16 v[12:15], v[32:35], a[152:155], v[12:15]
  v_mfma_f32_16x16x32_bf16 v[16:19], v[32:35], a[208:211], v[16:19]
  v_mfma_f32_16x16x32_bf16 v[20:23], v[32:35], v[128:131], v[20:23]
  v_mfma_f32_16x16x32_bf16 v[24:27], v[32:35], v[184:187], v[24:27]
  v_mfma_f32_16x16x32_bf16 v[28:31], v[32:35], v[240:243], v[28:31]
  s_waitcnt lgkmcnt(2)
  v_mfma_f32_16x16x32_bf16 v[4:7], v[36:39], a[44:47], v[4:7]
  v_mfma_f32_16x16x32_bf16 v[8:11], v[36:39], a[100:103], v[8:11]
  v_mfma_f32_16x16x32_bf16 v[12:15], v[36:39], a[156:159], v[12:15]
  v_mfma_f32_16x16x32_bf16 v[16:19], v[36:39], a[212:215], v[16:19]
  v_mfma_f32_16x16x32_bf16 v[20:23], v[36:39], v[132:135], v[20:23]
  v_mfma_f32_16x16x32_bf16 v[24:27], v[36:39], v[188:191], v[24:27]
  v_mfma_f32_16x16x32_bf16 v[28:31], v[36:39], v[244:247], v[28:31]
  s_waitcnt lgkmcnt(1)
  v_mfma_f32_16x16x32_bf16 v[4:7], v[40:43], a[48:51], v[4:7]
  v_mfma_f32_16x16x32_bf16 v[8:11], v[40:43], a[104:107], v[8:11]
  v_mfma_f32_16x16x32_bf16 v[12:15], v[40:43], a[160:163], v[12:15]
  v_mfma_f32_16x16x32_bf16 v[16:19], v[40:43], a[216:219], v[16:19]
  v_mfma_f32_16x16x32_bf16 v[20:23], v[40:43], v[136:139], v[20:23]
  v_mfma_f32_16x16x32_bf16 v[24:27], v[40:43], v[192:195], v[24:27]
  v_mfma_f32_16x16x32_bf16 v[28:31], v[40:43], v[248:251], v[28:31]
  s_waitcnt lgkmcnt(0)
  v_mfma_f32_16x16x32_bf16 v[4:7], v[44:47], a[52:55], v[4:7]
  v_mfma_f32_16x16x32_bf16 v[8:11], v[44:47], a[108:111], v[8:11]
  v_mfma_f32_16x16x32_bf16 v[12:15], v[44:47], a[164:167], v[12:15]
  v_mfma_f32_16x16x32_bf16 v[16:19], v[44:47], a[220:223], v[16:19]
  v_mfma_f32_16x16x32_bf16 v[20:23], v[44:47], v[140:143], v[20:23]
  v_mfma_f32_16x16x32_bf16 v[24:27], v[44:47], v[196:199], v[24:27]
  v_mfma_f32_16x16x32_bf16 v[28:31], v[44:47], v[252:255], v[28:31]
  s_nop 1
  v_cvt_pk_bf16_f32 v50, v4, v5
  v_cvt_pk_bf16_f32 v51, v6, v7
  v_cvt_pk_bf16_f32 v54, v8, v9
  v_cvt_pk_bf16_f32 v55, v10, v11
  v_cvt_pk_bf16_f32 v58, v12, v13
  v_cvt_pk_bf16_f32 v59, v14, v15
  v_cvt_pk_bf16_f32 v62, v16, v17
  v_cvt_pk_bf16_f32 v63, v18, v19
  v_cvt_pk_bf16_f32 v66, v20, v21
  v_cvt_pk_bf16_f32 v67, v22, v23
  v_cvt_pk_bf16_f32 v70, v24, v25
  v_cvt_pk_bf16_f32 v71, v26, v27
  v_cvt_pk_bf16_f32 v74, v28, v29
  v_cvt_pk_bf16_f32 v75, v30, v31
  s_add_u32 s33, s47, 4096
  buffer_store_dwordx4 v[48:51], v3, s[8:11], s47 offen offset:0 sc1
  buffer_store_dwordx4 v[52:55], v3, s[8:11], s47 offen offset:1024 sc1
  buffer_store_dwordx4 v[56:59], v3, s[8:11], s47 offen offset:2048 sc1
  buffer_store_dwordx4 v[60:63], v3, s[8:11], s47 offen offset:3072 sc1
  buffer_store_dwordx4 v[64:67], v3, s[8:11], s33 offen offset:0 sc1
  buffer_store_dwordx4 v[68:71], v3, s[8:11], s33 offen offset:1024 sc1
  buffer_store_dwordx4 v[72:75], v3, s[8:11], s33 offen offset:2048 sc1
  v_xor_b32 v76, 0x8000, v76
  v_xor_b32 v77, 0x8000, v77
  s_waitcnt vmcnt(0)
  s_barrier
  s_cmp_eq_u32 s3, 0
  s_cbranch_scc0 L_y_nofl_142
  v_mov_b32 v78, s98
  v_lshrrev_b32 v79, 2, v3
  v_and_b32 v79, 124, v79
  buffer_store_dword v78, v79, s[8:11], s48 offen sc1
L_y_nofl_142:
  s_cmp_lt_u32 s44, 3
  s_cbranch_scc0 L_y_later_144
  s_cmp_eq_u32 s3, 0
  s_cbranch_scc0 L_wpd_146
  v_and_b32 v4, 31, v0
  v_lshlrev_b32 v4, 7, v4
  s_mov_b32 s34, 77750272
L_wp_145:
  s_add_u32 s35, s34, 0
  buffer_load_dwordx2 v[8:9], v4, s[8:11], s35 offen sc1
  s_add_u32 s6, s6, 1
  s_cmp_gt_u32 s6, 262144
  s_cbranch_scc1 L_timeout
  s_waitcnt vmcnt(0)
  v_cmp_ne_u32 vcc, s98, v8
  v_cmp_ne_u32 s[36:37], s98, v9
  s_or_b64 vcc, vcc, s[36:37]
  s_cbranch_vccz L_wpd_146
  s_sleep 2
  s_branch L_wp_145
L_wpd_146:
  s_barrier
  s_add_u32 s45, s45, 86016
  s_xor_b32 s46, s46, 0x8000
  s_add_u32 s33, s46, 0
  s_mov_b32 m0, s33
  s_add_u32 s34, s45, 0
  buffer_load_dwordx4 v3, s[8:11], s34 offen offset:0 sc1 lds
  buffer_load_dwordx4 v3, s[8:11], s34 offen offset:1024 sc1 lds
  buffer_load_dwordx4 v3, s[8:11], s34 offen offset:2048 sc1 lds
  buffer_load_dwordx4 v3, s[8:11], s34 offen offset:3072 sc1 lds
  s_add_u32 s33, s46, 4096
  s_mov_b32 m0, s33
  s_add_u32 s34, s45, 4096
  buffer_load_dwordx4 v3, s[8:11], s34 offen offset:0 sc1 lds
  buffer_load_dwordx4 v3, s[8:11], s34 offen offset:1024 sc1 lds
  buffer_load_dwordx4 v3, s[8:11], s34 offen offset:2048 sc1 lds
  s_waitcnt vmcnt(0)
  s_barrier
L_y_later_144:
  s_add_u32 s44, s44, 3
  s_cmp_ge_u32 s44, 64
  s_cbranch_scc1 L_y_done_143
  s_add_u32 s47, s47, 1376256
  s_add_u32 s48, s48, 86016
  s_branch L_y_top_140
L_y_done_143:
  s_cmp_eq_u32 s3, 0
  s_cbranch_scc0 L_wpd_148
  v_lshlrev_b32 v4, 7, v0
  s_mov_b32 s34, 77721600
L_wp_147:
  s_add_u32 s35, s34, 0
  buffer_load_dwordx2 v[8:9], v4, s[8:11], s35 offen sc1
  s_add_u32 s35, s34, 8192
  buffer_load_dwordx2 v[10:11], v4, s[8:11], s35 offen sc1
  s_add_u32 s35, s34, 16384
  buffer_load_dwordx2 v[12:13], v4, s[8:11], s35 offen sc1
  s_add_u32 s35, s34, 24576
  buffer_load_dwordx2 v[14:15], v4, s[8:11], s35 offen sc1
  s_add_u32 s6, s6, 1
  s_cmp_gt_u32 s6, 262144
  s_cbranch_scc1 L_timeout
  s_waitcnt vmcnt(0)
  v_cmp_ne_u32 vcc, s98, v8
  v_cmp_ne_u32 s[36:37], s98, v9
  s_or_b64 vcc, vcc, s[36:37]
  v_cmp_ne_u32 s[36:37], s98, v10
  s_or_b64 vcc, vcc, s[36:37]
  v_cmp_ne_u32 s[36:37], s98, v11
  s_or_b64 vcc, vcc, s[36:37]
  v_cmp_ne_u32 s[36:37], s98, v12
  s_or_b64 vcc, vcc, s[36:37]
  v_cmp_ne_u32 s[36:37], s98, v13
  s_or_b64 vcc, vcc, s[36:37]
  v_cmp_ne_u32 s[36:37], s98, v14
  s_or_b64 vcc, vcc, s[36:37]
  v_cmp_ne_u32 s[36:37], s98, v15
  s_or_b64 vcc, vcc, s[36:37]
  s_cbranch_vccz L_wpd_148
  s_sleep 2
  s_branch L_wp_147
L_wpd_148:
  s_barrier
  s_add_u32 s31, s31, 33
  s_mul_i32 s33, s3, 1792
  v_add_u32 v91, s33, v3
  v_min_u32 v92, 47, v0
  v_lshlrev_b32 v92, 4, v92
  s_add_u32 s33, s33, 1024
  v_add_u32 v92, s33, v92
  v_mov_b32 v90, 0x44444444
  v_mov_b32 v4, 0xeeeeeeee
  v_cmp_gt_u32 vcc, 8, v1
  s_nop 1
  v_cndmask_b32 v90, v4, v90, vcc
  v_lshlrev_b32 v93, 3, v0
  s_mov_b32 s44, s31
  s_lshl_b32 s45, s44, 13
  s_add_u32 s45, s45, 45875200
  s_lshl_b32 s33, s44, 4
  s_add_u32 s33, s33, s30
  s_mul_i32 s46, s33, 14336
  s_mul_i32 s33, s3, 3584
  s_add_u32 s46, s46, s33
  s_add_u32 s46, s46, 48627712
  s_mul_i32 s47, s44, 28672
  s_lshl_b32 s33, s30, 7
  s_add_u32 s47, s47, s33
  s_add_u32 s47, s47, 75859968
L_z_top_149:
  v_mov_b64 v[32:33], 0
  v_mov_b64 v[34:35], 0
  v_mov_b64 v[36:37], 0
  v_mov_b64 v[38:39], 0
  v_mov_b64 v[40:41], 0
  v_mov_b64 v[42:43], 0
  v_mov_b64 v[44:45], 0
  v_mov_b64 v[46:47], 0
  v_mov_b64 v[48:49], 0
  v_mov_b64 v[50:51], 0
  v_mov_b64 v[52:53], 0
  v_mov_b64 v[54:55], 0
  v_mov_b64 v[56:57], 0
  v_mov_b64 v[58:59], 0
L_fm_151:
  buffer_load_dwordx4 v[60:63], v91, s[8:11], s45 offen sc1
  buffer_load_dwordx4 v[64:67], v92, s[8:11], s45 offen sc1
  s_add_u32 s6, s6, 1
  s_cmp_gt_u32 s6, 262144
  s_cbranch_scc1 L_timeout
  s_waitcnt vmcnt(0)
  ds_write_b128 v91, v[60:63] offset:0
  ds_write_b128 v92, v[64:67] offset:0
  v_max3_u32 v94, v60, v61, v62
  v_max3_u32 v95, v63, v64, v65
  v_max3_u32 v94, v94, v66, v67
  v_max_u32 v94, v94, v95
  v_cmp_eq_u32 vcc, -1, v94
  s_cbranch_vccnz L_fm_151
  s_waitcnt lgkmcnt(0)
  s_barrier
  ds_read_b128 v[4:7], v3 offset:0
  ds_read_b128 v[8:11], v3 offset:1024
  ds_read_b128 v[12:15], v3 offset:2048
  ds_read_b128 v[16:19], v3 offset:3072
  ds_read_b128 v[20:23], v3 offset:4096
  ds_read_b128 v[24:27], v3 offset:5120
  ds_read_b128 v[28:31], v3 offset:6144
  s_waitcnt lgkmcnt(6)
  v_smfmac_f32_16x16x64_bf16 v[32:35], v[4:7], a[0:7], v90
  s_waitcnt lgkmcnt(5)
  v_smfmac_f32_16x16x64_bf16 v[32:35], v[8:11], a[8:15], v90
  s_waitcnt lgkmcnt(4)
  v_smfmac_f32_16x16x64_bf16 v[32:35], v[12:15], a[16:23], v90
  s_waitcnt lgkmcnt(3)
  v_smfmac_f32_16x16x64_bf16 v[32:35], v[16:19], a[24:31], v90
  s_waitcnt lgkmcnt(2)
  v_smfmac_f32_16x16x64_bf16 v[32:35], v[20:23], a[32:39], v90
  s_waitcnt lgkmcnt(1)
  v_smfmac_f32_16x16x64_bf16 v[32:35], v[24:27], a[40:47], v90
  s_waitcnt lgkmcnt(0)
  v_smfmac_f32_16x16x64_bf16 v[32:35], v[28:31], a[48:55], v90
  v_smfmac_f32_16x16x64_bf16 v[36:39], v[4:7], a[56:63], v90
  v_smfmac_f32_16x16x64_bf16 v[36:39], v[8:11], a[64:71], v90
  v_smfmac_f32_16x16x64_bf16 v[36:39], v[12:15], a[72:79], v90
  v_smfmac_f32_16x16x64_bf16 v[36:39], v[16:19], a[80:87], v90
  v_smfmac_f32_16x16x64_bf16 v[36:39], v[20:23], a[88:95], v90
  v_smfmac_f32_16x16x64_bf16 v[36:39], v[24:27], a[96:103], v90
  v_smfmac_f32_16x16x64_bf16 v[36:39], v[28:31], a[104:111], v90
  v_smfmac_f32_16x16x64_bf16 v[40:43], v[4:7], a[112:119], v90
  v_smfmac_f32_16x16x64_bf16 v[40:43], v[8:11], a[120:127], v90
  v_smfmac_f32_16x16x64_bf16 v[40:43], v[12:15], a[128:135], v90
  v_smfmac_f32_16x16x64_bf16 v[40:43], v[16:19], a[136:143], v90
  v_smfmac_f32_16x16x64_bf16 v[40:43], v[20:23], a[144:151], v90
  v_smfmac_f32_16x16x64_bf16 v[40:43], v[24:27], a[152:159], v90
  v_smfmac_f32_16x16x64_bf16 v[40:43], v[28:31], a[160:167], v90
  v_smfmac_f32_16x16x64_bf16 v[44:47], v[4:7], a[168:175], v90
  v_smfmac_f32_16x16x64_bf16 v[44:47], v[8:11], a[176:183], v90
  v_smfmac_f32_16x16x64_bf16 v[44:47], v[12:15], a[184:191], v90
  v_smfmac_f32_16x16x64_bf16 v[44:47], v[16:19], a[192:199], v90
  v_smfmac_f32_16x16x64_bf16 v[44:47], v[20:23], a[200:207], v90
  v_smfmac_f32_16x16x64_bf16 v[44:47], v[24:27], a[208:215], v90
  v_smfmac_f32_16x16x64_bf16 v[44:47], v[28:31], a[216:223], v90
  v_smfmac_f32_16x16x64_bf16 v[48:51], v[4:7], a[224:231], v90
  v_smfmac_f32_16x16x64_bf16 v[48:51], v[8:11], a[232:239], v90
  v_smfmac_f32_16x16x64_bf16 v[48:51], v[12:15], a[240:247], v90
  v_smfmac_f32_16x16x64_bf16 v[48:51], v[16:19], a[248:255], v90
  v_smfmac_f32_16x16x64_bf16 v[48:51], v[20:23], v[120:127], v90
  v_smfmac_f32_16x16x64_bf16 v[48:51], v[24:27], v[128:135], v90
  v_smfmac_f32_16x16x64_bf16 v[48:51], v[28:31], v[136:143], v90
  v_smfmac_f32_16x16x64_bf16 v[52:55], v[4:7], v[144:151], v90
  v_smfmac_f32_16x16x64_bf16 v[52:55], v[8:11], v[152:159], v90
  v_smfmac_f32_16x16x64_bf16 v[52:55], v[12:15], v[160:167], v90
  v_smfmac_f32_16x16x64_bf16 v[52:55], v[16:19], v[168:175], v90
  v_smfmac_f32_16x16x64_bf16 v[52:55], v[20:23], v[176:183], v90
  v_smfmac_f32_16x16x64_bf16 v[52:55], v[24:27], v[184:191], v90
  v_smfmac_f32_16x16x64_bf16 v[52:55], v[28:31], v[192:199], v90
  v_smfmac_f32_16x16x64_bf16 v[56:59], v[4:7], v[200:207], v90
  v_smfmac_f32_16x16x64_bf16 v[56:59], v[8:11], v[208:215], v90
  v_smfmac_f32_16x16x64_bf16 v[56:59], v[12:15], v[216:223], v90
  v_smfmac_f32_16x16x64_bf16 v[56:59], v[16:19], v[224:231], v90
  v_smfmac_f32_16x16x64_bf16 v[56:59], v[20:23], v[232:239], v90
  v_smfmac_f32_16x16x64_bf16 v[56:59], v[24:27], v[240:247], v90
  v_smfmac_f32_16x16x64_bf16 v[56:59], v[28:31], v[248:255], v90
  v_cvt_pk_bf16_f32 v76, v32, v33
  v_cvt_pk_bf16_f32 v77, v34, v35
  v_min_u32 v76, -2, v76
  v_min_u32 v77, -2, v77
  buffer_store_dwordx2 v[76:77], v93, s[8:11], s46 offen offset:0 sc1
  v_cvt_pk_bf16_f32 v78, v36, v37
  v_cvt_pk_bf16_f32 v79, v38, v39
  v_min_u32 v78, -2, v78
  v_min_u32 v79, -2, v79
  buffer_store_dwordx2 v[78:79], v93, s[8:11], s46 offen offset:512 sc1
  v_cvt_pk_bf16_f32 v80, v40, v41
  v_cvt_pk_bf16_f32 v81, v42, v43
  v_min_u32 v80, -2, v80
  v_min_u32 v81, -2, v81
  buffer_store_dwordx2 v[80:81], v93, s[8:11], s46 offen offset:1024 sc1
  v_cvt_pk_bf16_f32 v82, v44, v45
  v_cvt_pk_bf16_f32 v83, v46, v47
  v_min_u32 v82, -2, v82
  v_min_u32 v83, -2, v83
  buffer_store_dwordx2 v[82:83], v93, s[8:11], s46 offen offset:1536 sc1
  v_cvt_pk_bf16_f32 v84, v48, v49
  v_cvt_pk_bf16_f32 v85, v50, v51
  v_min_u32 v84, -2, v84
  v_min_u32 v85, -2, v85
  buffer_store_dwordx2 v[84:85], v93, s[8:11], s46 offen offset:2048 sc1
  v_cvt_pk_bf16_f32 v86, v52, v53
  v_cvt_pk_bf16_f32 v87, v54, v55
  v_min_u32 v86, -2, v86
  v_min_u32 v87, -2, v87
  buffer_store_dwordx2 v[86:87], v93, s[8:11], s46 offen offset:2560 sc1
  v_cvt_pk_bf16_f32 v88, v56, v57
  v_cvt_pk_bf16_f32 v89, v58, v59
  v_min_u32 v88, -2, v88
  v_min_u32 v89, -2, v89
  buffer_store_dwordx2 v[88:89], v93, s[8:11], s46 offen offset:3072 sc1
  s_cmp_ge_u32 s44, 61
  s_cbranch_scc1 L_nd_152
  s_waitcnt vmcnt(0)
L_nd_152:
  s_cmp_eq_u32 s3, 0
  s_barrier
  s_cbranch_scc0 L_z_nofl_150
  v_mov_b32 v94, s98
  v_lshrrev_b32 v95, 2, v3
  v_and_b32 v95, 124, v95
  buffer_store_dword v94, v95, s[8:11], s47 offen sc1
L_z_nofl_150:
  s_add_u32 s44, s44, 3
  s_add_u32 s45, s45, 24576
  s_add_u32 s46, s46, 688128
  s_add_u32 s47, s47, 86016
  s_cmp_lt_u32 s44, 64
  s_cbranch_scc1 L_z_top_149
  s_endpgm
L_z:
  s_cmp_eq_u32 s3, 0
  s_cbranch_scc0 L_afy_153
  v_lshlrev_b32 v4, 7, v1
  s_mov_b32 s34, 75857920
L_wf_154:
  buffer_load_dwordx2 v[6:7], v4, s[8:11], s34 offen sc1
  s_add_u32 s6, s6, 1
  s_cmp_gt_u32 s6, 262144
  s_cbranch_scc1 L_timeout
  s_waitcnt vmcnt(0)
  v_cmp_ne_u32 vcc, s98, v6
  v_cmp_ne_u32 s[36:37], s98, v7
  s_or_b64 vcc, vcc, s[36:37]
  s_cbranch_vccz L_wfok_155
  s_sleep 16
  s_branch L_wf_154
L_wfok_155:
L_afy_153:
  s_barrier
  s_cmp_eq_u32 s3, 0
  s_cbranch_scc0 L_wpd_157
  v_lshlrev_b32 v4, 7, v0
  s_mov_b32 s34, 77721600
L_wp_156:
  s_add_u32 s35, s34, 0
  buffer_load_dwordx2 v[8:9], v4, s[8:11], s35 offen sc1
  s_add_u32 s35, s34, 8192
  buffer_load_dwordx2 v[10:11], v4, s[8:11], s35 offen sc1
  s_add_u32 s35, s34, 16384
  buffer_load_dwordx2 v[12:13], v4, s[8:11], s35 offen sc1
  s_add_u32 s35, s34, 24576
  buffer_load_dwordx2 v[14:15], v4, s[8:11], s35 offen sc1
  s_add_u32 s6, s6, 1
  s_cmp_gt_u32 s6, 262144
  s_cbranch_scc1 L_timeout
  s_waitcnt vmcnt(0)
  v_cmp_ne_u32 vcc, s98, v8
  v_cmp_ne_u32 s[36:37], s98, v9
  s_or_b64 vcc, vcc, s[36:37]
  v_cmp_ne_u32 s[36:37], s98, v10
  s_or_b64 vcc, vcc, s[36:37]
  v_cmp_ne_u32 s[36:37], s98, v11
  s_or_b64 vcc, vcc, s[36:37]
  v_cmp_ne_u32 s[36:37], s98, v12
  s_or_b64 vcc, vcc, s[36:37]
  v_cmp_ne_u32 s[36:37], s98, v13
  s_or_b64 vcc, vcc, s[36:37]
  v_cmp_ne_u32 s[36:37], s98, v14
  s_or_b64 vcc, vcc, s[36:37]
  v_cmp_ne_u32 s[36:37], s98, v15
  s_or_b64 vcc, vcc, s[36:37]
  s_cbranch_vccz L_wpd_157
  s_sleep 2
  s_branch L_wp_156
L_wpd_157:
  s_barrier
  s_mul_i32 s35, s30, 401408
  s_mul_i32 s36, s3, 100352
  s_add_u32 s35, s35, s36
  s_add_u32 s35, s35, 6422528
  s_add_u32 s37, s35, 0
  buffer_load_dwordx4 a[0:3], v3, s[8:11], s37 offen offset:0 sc1
  buffer_load_dwordx4 a[4:7], v3, s[8:11], s37 offen offset:1024 sc1
  buffer_load_dwordx4 a[8:11], v3, s[8:11], s37 offen offset:2048 sc1
  buffer_load_dwordx4 a[12:15], v3, s[8:11], s37 offen offset:3072 sc1
  s_add_u32 s37, s37, 4096
  buffer_load_dwordx4 a[16:19], v3, s[8:11], s37 offen offset:0 sc1
  buffer_load_dwordx4 a[20:23], v3, s[8:11], s37 offen offset:1024 sc1
  buffer_load_dwordx4 a[24:27], v3, s[8:11], s37 offen offset:2048 sc1
  buffer_load_dwordx4 a[28:31], v3, s[8:11], s37 offen offset:3072 sc1
  s_add_u32 s37, s37, 4096
  buffer_load_dwordx4 a[32:35], v3, s[8:11], s37 offen offset:0 sc1
  buffer_load_dwordx4 a[36:39], v3, s[8:11], s37 offen offset:1024 sc1
  buffer_load_dwordx4 a[40:43], v3, s[8:11], s37 offen offset:2048 sc1
  buffer_load_dwordx4 a[44:47], v3, s[8:11], s37 offen offset:3072 sc1
  s_add_u32 s37, s37, 4096
  buffer_load_dwordx4 a[48:51], v3, s[8:11], s37 offen offset:0 sc1
  buffer_load_dwordx4 a[52:55], v3, s[8:11], s37 offen offset:1024 sc1
  s_add_u32 s37, s35, 14336
  buffer_load_dwordx4 a[56:59], v3, s[8:11], s37 offen offset:0 sc1
  buffer_load_dwordx4 a[60:63], v3, s[8:11], s37 offen offset:1024 sc1
  buffer_load_dwordx4 a[64:67], v3, s[8:11], s37 offen offset:2048 sc1
  buffer_load_dwordx4 a[68:71], v3, s[8:11], s37 offen offset:3072 sc1
  s_add_u32 s37, s37, 4096
  buffer_load_dwordx4 a[72:75], v3, s[8:11], s37 offen offset:0 sc1
  buffer_load_dwordx4 a[76:79], v3, s[8:11], s37 offen offset:1024 sc1
  buffer_load_dwordx4 a[80:83], v3, s[8:11], s37 offen offset:2048 sc1
  buffer_load_dwordx4 a[84:87], v3, s[8:11], s37 offen offset:3072 sc1
  s_add_u32 s37, s37, 4096
  buffer_load_dwordx4 a[88:91], v3, s[8:11], s37 offen offset:0 sc1
  buffer_load_dwordx4 a[92:95], v3, s[8:11], s37 offen offset:1024 sc1
  buffer_load_dwordx4 a[96:99], v3, s[8:11], s37 offen offset:2048 sc1
  buffer_load_dwordx4 a[100:103], v3, s[8:11], s37 offen offset:3072 sc1
  s_add_u32 s37, s37, 4096
  buffer_load_dwordx4 a[104:107], v3, s[8:11], s37 offen offset:0 sc1
  buffer_load_dwordx4 a[108:111], v3, s[8:11], s37 offen offset:1024 sc1
  s_add_u32 s37, s35, 28672
  buffer_load_dwordx4 a[112:115], v3, s[8:11], s37 offen offset:0 sc1
  buffer_load_dwordx4 a[116:119], v3, s[8:11], s37 offen offset:1024 sc1
  buffer_load_dwordx4 a[120:123], v3, s[8:11], s37 offen offset:2048 sc1
  buffer_load_dwordx4 a[124:127], v3, s[8:11], s37 offen offset:3072 sc1
  s_add_u32 s37, s37, 4096
  buffer_load_dwordx4 a[128:131], v3, s[8:11], s37 offen offset:0 sc1
  buffer_load_dwordx4 a[132:135], v3, s[8:11], s37 offen offset:1024 sc1
  buffer_load_dwordx4 a[136:139], v3, s[8:11], s37 offen offset:2048 sc1
  buffer_load_dwordx4 a[140:143], v3, s[8:11], s37 offen offset:3072 sc1
  s_add_u32 s37, s37, 4096
  buffer_load_dwordx4 a[144:147], v3, s[8:11], s37 offen offset:0 sc1
  buffer_load_dwordx4 a[148:151], v3, s[8:11], s37 offen offset:1024 sc1
  buffer_load_dwordx4 a[152:155], v3, s[8:11], s37 offen offset:2048 sc1
  buffer_load_dwordx4 a[156:159], v3, s[8:11], s37 offen offset:3072 sc1
  s_add_u32 s37, s37, 4096
  buffer_load_dwordx4 a[160:163], v3, s[8:11], s37 offen offset:0 sc1
  buffer_load_dwordx4 a[164:167], v3, s[8:11], s37 offen offset:1024 sc1
  s_add_u32 s37, s35, 43008
  buffer_load_dwordx4 a[168:171], v3, s[8:11], s37 offen offset:0 sc1
  buffer_load_dwordx4 a[172:175], v3, s[8:11], s37 offen offset:1024 sc1
  buffer_load_dwordx4 a[176:179], v3, s[8:11], s37 offen offset:2048 sc1
  buffer_load_dwordx4 a[180:183], v3, s[8:11], s37 offen offset:3072 sc1
  s_add_u32 s37, s37, 4096
  buffer_load_dwordx4 a[184:187], v3, s[8:11], s37 offen offset:0 sc1
  buffer_load_dwordx4 a[188:191], v3, s[8:11], s37 offen offset:1024 sc1
  buffer_load_dwordx4 a[192:195], v3, s[8:11], s37 offen offset:2048 sc1
  buffer_load_dwordx4 a[196:199], v3, s[8:11], s37 offen offset:3072 sc1
  s_add_u32 s37, s37, 4096
  buffer_load_dwordx4 a[200:203], v3, s[8:11], s37 offen offset:0 sc1
  buffer_load_dwordx4 a[204:207], v3, s[8:11], s37 offen offset:1024 sc1
  buffer_load_dwordx4 a[208:211], v3, s[8:11], s37 offen offset:2048 sc1
  buffer_load_dwordx4 a[212:215], v3, s[8:11], s37 offen offset:3072 sc1
  s_add_u32 s37, s37, 4096
  buffer_load_dwordx4 a[216:219], v3, s[8:11], s37 offen offset:0 sc1
  buffer_load_dwordx4 a[220:223], v3, s[8:11], s37 offen offset:1024 sc1
  s_add_u32 s37, s35, 57344
  buffer_load_dwordx4 a[224:227], v3, s[8:11], s37 offen offset:0 sc1
  buffer_load_dwordx4 a[228:231], v3, s[8:11], s37 offen offset:1024 sc1
  buffer_load_dwordx4 a[232:235], v3, s[8:11], s37 offen offset:2048 sc1
  buffer_load_dwordx4 a[236:239], v3, s[8:11], s37 offen offset:3072 sc1
  s_add_u32 s37, s37, 4096
  buffer_load_dwordx4 a[240:243], v3, s[8:11], s37 offen offset:0 sc1
  buffer_load_dwordx4 a[244:247], v3, s[8:11], s37 offen offset:1024 sc1
  buffer_load_dwordx4 a[248:251], v3, s[8:11], s37 offen offset:2048 sc1
  s_waitcnt vmcnt(62)
  buffer_load_dwordx4 a[252:255], v3, s[8:11], s37 offen offset:3072 sc1
  s_add_u32 s37, s37, 4096
  s_waitcnt vmcnt(62)
  buffer_load_dwordx4 v[120:123], v3, s[8:11], s37 offen offset:0 sc1
  s_waitcnt vmcnt(62)
  buffer_load_dwordx4 v[124:127], v3, s[8:11], s37 offen offset:1024 sc1
  s_waitcnt vmcnt(62)
  buffer_load_dwordx4 v[128:131], v3, s[8:11], s37 offen offset:2048 sc1
  s_waitcnt vmcnt(62)
  buffer_load_dwordx4 v[132:135], v3, s[8:11], s37 offen offset:3072 sc1
  s_add_u32 s37, s37, 4096
  s_waitcnt vmcnt(62)
  buffer_load_dwordx4 v[136:139], v3, s[8:11], s37 offen offset:0 sc1
  s_waitcnt vmcnt(62)
  buffer_load_dwordx4 v[140:143], v3, s[8:11], s37 offen offset:1024 sc1
  s_add_u32 s37, s35, 71680
  s_waitcnt vmcnt(62)
  buffer_load_dwordx4 v[144:147], v3, s[8:11], s37 offen offset:0 sc1
  s_waitcnt vmcnt(62)
  buffer_load_dwordx4 v[148:151], v3, s[8:11], s37 offen offset:1024 sc1
  s_waitcnt vmcnt(62)
  buffer_load_dwordx4 v[152:155], v3, s[8:11], s37 offen offset:2048 sc1
  s_waitcnt vmcnt(62)
  buffer_load_dwordx4 v[156:159], v3, s[8:11], s37 offen offset:3072 sc1
  s_add_u32 s37, s37, 4096
  s_waitcnt vmcnt(62)
  buffer_load_dwordx4 v[160:163], v3, s[8:11], s37 offen offset:0 sc1
  s_waitcnt vmcnt(62)
  buffer_load_dwordx4 v[164:167], v3, s[8:11], s37 offen offset:1024 sc1
  s_waitcnt vmcnt(62)
  buffer_load_dwordx4 v[168:171], v3, s[8:11], s37 offen offset:2048 sc1
  s_waitcnt vmcnt(62)
  buffer_load_dwordx4 v[172:175], v3, s[8:11], s37 offen offset:3072 sc1
  s_add_u32 s37, s37, 4096
  s_waitcnt vmcnt(62)
  buffer_load_dwordx4 v[176:179], v3, s[8:11], s37 offen offset:0 sc1
  s_waitcnt vmcnt(62)
  buffer_load_dwordx4 v[180:183], v3, s[8:11], s37 offen offset:1024 sc1
  s_waitcnt vmcnt(62)
  buffer_load_dwordx4 v[184:187], v3, s[8:11], s37 offen offset:2048 sc1
  s_waitcnt vmcnt(62)
  buffer_load_dwordx4 v[188:191], v3, s[8:11], s37 offen offset:3072 sc1
  s_add_u32 s37, s37, 4096
  s_waitcnt vmcnt(62)
  buffer_load_dwordx4 v[192:195], v3, s[8:11], s37 offen offset:0 sc1
  s_waitcnt vmcnt(62)
  buffer_load_dwordx4 v[196:199], v3, s[8:11], s37 offen offset:1024 sc1
  s_add_u32 s37, s35, 86016
  s_waitcnt vmcnt(62)
  buffer_load_dwordx4 v[200:203], v3, s[8:11], s37 offen offset:0 sc1
  s_waitcnt vmcnt(62)
  buffer_load_dwordx4 v[204:207], v3, s[8:11], s37 offen offset:1024 sc1
  s_waitcnt vmcnt(62)
  buffer_load_dwordx4 v[208:211], v3, s[8:11], s37 offen offset:2048 sc1
  s_waitcnt vmcnt(62)
  buffer_load_dwordx4 v[212:215], v3, s[8:11], s37 offen offset:3072 sc1
  s_add_u32 s37, s37, 4096
  s_waitcnt vmcnt(62)
  buffer_load_dwordx4 v[216:219], v3, s[8:11], s37 offen offset:0 sc1
  s_waitcnt vmcnt(62)
  buffer_load_dwordx4 v[220:223], v3, s[8:11], s37 offen offset:1024 sc1
  s_waitcnt vmcnt(62)
  buffer_load_dwordx4 v[224:227], v3, s[8:11], s37 offen offset:2048 sc1
  s_waitcnt vmcnt(62)
  buffer_load_dwordx4 v[228:231], v3, s[8:11], s37 offen offset:3072 sc1
  s_add_u32 s37, s37, 4096
  s_waitcnt vmcnt(62)
  buffer_load_dwordx4 v[232:235], v3, s[8:11], s37 offen offset:0 sc1
  s_waitcnt vmcnt(62)
  buffer_load_dwordx4 v[236:239], v3, s[8:11], s37 offen offset:1024 sc1
  s_waitcnt vmcnt(62)
  buffer_load_dwordx4 v[240:243], v3, s[8:11], s37 offen offset:2048 sc1
  s_waitcnt vmcnt(62)
  buffer_load_dwordx4 v[244:247], v3, s[8:11], s37 offen offset:3072 sc1
  s_add_u32 s37, s37, 4096
  s_waitcnt vmcnt(62)
  buffer_load_dwordx4 v[248:251], v3, s[8:11], s37 offen offset:0 sc1
  s_waitcnt vmcnt(62)
  buffer_load_dwordx4 v[252:255], v3, s[8:11], s37 offen offset:1024 sc1
  s_mul_i32 s33, s3, 1792
  v_add_u32 v91, s33, v3
  v_min_u32 v92, 47, v0
  v_lshlrev_b32 v92, 4, v92
  s_add_u32 s33, s33, 1024
  v_add_u32 v92, s33, v92
  v_mov_b32 v90, 0x44444444
  v_mov_b32 v4, 0xeeeeeeee
  v_cmp_gt_u32 vcc, 8, v1
  s_nop 1
  v_cndmask_b32 v90, v4, v90, vcc
  v_lshlrev_b32 v93, 3, v0
  s_mov_b32 s44, 0
  s_lshl_b32 s45, s44, 13
  s_add_u32 s45, s45, 45875200
  s_lshl_b32 s33, s44, 4
  s_add_u32 s33, s33, s30
  s_mul_i32 s46, s33, 14336
  s_mul_i32 s33, s3, 3584
  s_add_u32 s46, s46, s33
  s_add_u32 s46, s46, 48627712
  s_mul_i32 s47, s44, 28672
  s_lshl_b32 s33, s30, 7
  s_add_u32 s47, s47, s33
  s_add_u32 s47, s47, 75831296
L_z_top_158:
  v_mov_b64 v[32:33], 0
  v_mov_b64 v[34:35], 0
  v_mov_b64 v[36:37], 0
  v_mov_b64 v[38:39], 0
  v_mov_b64 v[40:41], 0
  v_mov_b64 v[42:43], 0
  v_mov_b64 v[44:45], 0
  v_mov_b64 v[46:47], 0
  v_mov_b64 v[48:49], 0
  v_mov_b64 v[50:51], 0
  v_mov_b64 v[52:53], 0
  v_mov_b64 v[54:55], 0
  v_mov_b64 v[56:57], 0
  v_mov_b64 v[58:59], 0
L_fm_160:
  buffer_load_dwordx4 v[60:63], v91, s[8:11], s45 offen sc1
  buffer_load_dwordx4 v[64:67], v92, s[8:11], s45 offen sc1
  s_add_u32 s6, s6, 1
  s_cmp_gt_u32 s6, 262144
  s_cbranch_scc1 L_timeout
  s_waitcnt vmcnt(0)
  ds_write_b128 v91, v[60:63] offset:0
  ds_write_b128 v92, v[64:67] offset:0
  v_max3_u32 v94, v60, v61, v62
  v_max3_u32 v95, v63, v64, v65
  v_max3_u32 v94, v94, v66, v67
  v_max_u32 v94, v94, v95
  v_cmp_eq_u32 vcc, -1, v94
  s_cbranch_vccnz L_fm_160
  s_waitcnt lgkmcnt(0)
  s_barrier
  ds_read_b128 v[4:7], v3 offset:0
  ds_read_b128 v[8:11], v3 offset:1024
  ds_read_b128 v[12:15], v3 offset:2048
  ds_read_b128 v[16:19], v3 offset:3072
  ds_read_b128 v[20:23], v3 offset:4096
  ds_read_b128 v[24:27], v3 offset:5120
  ds_read_b128 v[28:31], v3 offset:6144
  s_cmp_eq_u32 s3, 0
  s_cbranch_scc0 L_z_nofl_159
  s_cmp_eq_u32 s44, 0
  s_cbranch_scc1 L_z_nofl_159
  v_mov_b32 v94, s98
  v_lshrrev_b32 v95, 2, v3
  v_and_b32 v95, 124, v95
  buffer_store_dword v94, v95, s[8:11], s47 offen sc1
L_z_nofl_159:
  s_waitcnt lgkmcnt(6)
  v_smfmac_f32_16x16x64_bf16 v[32:35], v[4:7], a[0:7], v90
  s_waitcnt lgkmcnt(5)
  v_smfmac_f32_16x16x64_bf16 v[32:35], v[8:11], a[8:15], v90
  s_waitcnt lgkmcnt(4)
  v_smfmac_f32_16x16x64_bf16 v[32:35], v[12:15], a[16:23], v90
  s_waitcnt lgkmcnt(3)
  v_smfmac_f32_16x16x64_bf16 v[32:35], v[16:19], a[24:31], v90
  s_waitcnt lgkmcnt(2)
  v_smfmac_f32_16x16x64_bf16 v[32:35], v[20:23], a[32:39], v90
  s_waitcnt lgkmcnt(1)
  v_smfmac_f32_16x16x64_bf16 v[32:35], v[24:27], a[40:47], v90
  s_waitcnt lgkmcnt(0)
  v_smfmac_f32_16x16x64_bf16 v[32:35], v[28:31], a[48:55], v90
  v_smfmac_f32_16x16x64_bf16 v[36:39], v[4:7], a[56:63], v90
  v_smfmac_f32_16x16x64_bf16 v[36:39], v[8:11], a[64:71], v90
  v_smfmac_f32_16x16x64_bf16 v[36:39], v[12:15], a[72:79], v90
  v_smfmac_f32_16x16x64_bf16 v[36:39], v[16:19], a[80:87], v90
  v_smfmac_f32_16x16x64_bf16 v[36:39], v[20:23], a[88:95], v90
  v_smfmac_f32_16x16x64_bf16 v[36:39], v[24:27], a[96:103], v90
  v_smfmac_f32_16x16x64_bf16 v[36:39], v[28:31], a[104:111], v90
  v_smfmac_f32_16x16x64_bf16 v[40:43], v[4:7], a[112:119], v90
  v_smfmac_f32_16x16x64_bf16 v[40:43], v[8:11], a[120:127], v90
  v_smfmac_f32_16x16x64_bf16 v[40:43], v[12:15], a[128:135], v90
  v_smfmac_f32_16x16x64_bf16 v[40:43], v[16:19], a[136:143], v90
  v_smfmac_f32_16x16x64_bf16 v[40:43], v[20:23], a[144:151], v90
  v_smfmac_f32_16x16x64_bf16 v[40:43], v[24:27], a[152:159], v90
  v_smfmac_f32_16x16x64_bf16 v[40:43], v[28:31], a[160:167], v90
  v_smfmac_f32_16x16x64_bf16 v[44:47], v[4:7], a[168:175], v90
  v_smfmac_f32_16x16x64_bf16 v[44:47], v[8:11], a[176:183], v90
  v_smfmac_f32_16x16x64_bf16 v[44:47], v[12:15], a[184:191], v90
  v_smfmac_f32_16x16x64_bf16 v[44:47], v[16:19], a[192:199], v90
  v_smfmac_f32_16x16x64_bf16 v[44:47], v[20:23], a[200:207], v90
  v_smfmac_f32_16x16x64_bf16 v[44:47], v[24:27], a[208:215], v90
  v_smfmac_f32_16x16x64_bf16 v[44:47], v[28:31], a[216:223], v90
  v_smfmac_f32_16x16x64_bf16 v[48:51], v[4:7], a[224:231], v90
  v_smfmac_f32_16x16x64_bf16 v[48:51], v[8:11], a[232:239], v90
  v_smfmac_f32_16x16x64_bf16 v[48:51], v[12:15], a[240:247], v90
  v_smfmac_f32_16x16x64_bf16 v[48:51], v[16:19], a[248:255], v90
  v_smfmac_f32_16x16x64_bf16 v[48:51], v[20:23], v[120:127], v90
  v_smfmac_f32_16x16x64_bf16 v[48:51], v[24:27], v[128:135], v90
  v_smfmac_f32_16x16x64_bf16 v[48:51], v[28:31], v[136:143], v90
  v_smfmac_f32_16x16x64_bf16 v[52:55], v[4:7], v[144:151], v90
  v_smfmac_f32_16x16x64_bf16 v[52:55], v[8:11], v[152:159], v90
  v_smfmac_f32_16x16x64_bf16 v[52:55], v[12:15], v[160:167], v90
  v_smfmac_f32_16x16x64_bf16 v[52:55], v[16:19], v[168:175], v90
  v_smfmac_f32_16x16x64_bf16 v[52:55], v[20:23], v[176:183], v90
  v_smfmac_f32_16x16x64_bf16 v[52:55], v[24:27], v[184:191], v90
  v_smfmac_f32_16x16x64_bf16 v[52:55], v[28:31], v[192:199], v90
  v_smfmac_f32_16x16x64_bf16 v[56:59], v[4:7], v[200:207], v90
  v_smfmac_f32_16x16x64_bf16 v[56:59], v[8:11], v[208:215], v90
  v_smfmac_f32_16x16x64_bf16 v[56:59], v[12:15], v[216:223], v90
  v_smfmac_f32_16x16x64_bf16 v[56:59], v[16:19], v[224:231], v90
  v_smfmac_f32_16x16x64_bf16 v[56:59], v[20:23], v[232:239], v90
  v_smfmac_f32_16x16x64_bf16 v[56:59], v[24:27], v[240:247], v90
  v_smfmac_f32_16x16x64_bf16 v[56:59], v[28:31], v[248:255], v90
  s_barrier
  v_cvt_pk_bf16_f32 v76, v32, v33
  v_cvt_pk_bf16_f32 v77, v34, v35
  buffer_store_dwordx2 v[76:77], v93, s[8:11], s46 offen offset:0 sc1
  v_cvt_pk_bf16_f32 v78, v36, v37
  v_cvt_pk_bf16_f32 v79, v38, v39
  buffer_store_dwordx2 v[78:79], v93, s[8:11], s46 offen offset:512 sc1
  v_cvt_pk_bf16_f32 v80, v40, v41
  v_cvt_pk_bf16_f32 v81, v42, v43
  buffer_store_dwordx2 v[80:81], v93, s[8:11], s46 offen offset:1024 sc1
  v_cvt_pk_bf16_f32 v82, v44, v45
  v_cvt_pk_bf16_f32 v83, v46, v47
  buffer_store_dwordx2 v[82:83], v93, s[8:11], s46 offen offset:1536 sc1
  v_cvt_pk_bf16_f32 v84, v48, v49
  v_cvt_pk_bf16_f32 v85, v50, v51
  buffer_store_dwordx2 v[84:85], v93, s[8:11], s46 offen offset:2048 sc1
  v_cvt_pk_bf16_f32 v86, v52, v53
  v_cvt_pk_bf16_f32 v87, v54, v55
  buffer_store_dwordx2 v[86:87], v93, s[8:11], s46 offen offset:2560 sc1
  v_cvt_pk_bf16_f32 v88, v56, v57
  v_cvt_pk_bf16_f32 v89, v58, v59
  buffer_store_dwordx2 v[88:89], v93, s[8:11], s46 offen offset:3072 sc1
  s_add_u32 s44, s44, 1
  s_add_u32 s45, s45, 8192
  s_add_u32 s46, s46, 229376
  s_add_u32 s47, s47, 28672
  s_cmp_lt_u32 s44, 33
  s_cbranch_scc1 L_z_top_158
  s_waitcnt vmcnt(0)
  s_barrier
  v_mov_b32 v94, s98
  v_lshrrev_b32 v95, 2, v3
  v_and_b32 v95, 124, v95
  buffer_store_dword v94, v95, s[8:11], s47 offen sc1
  s_mov_b32 s31, 63
  s_cmp_lt_u32 s30, 14
  s_cbranch_scc1 L_x2
  s_endpgm
L_x1:
  s_cmp_eq_u32 s3, 0
  s_cbranch_scc0 L_afy_161
  v_lshlrev_b32 v4, 7, v1
  s_mov_b32 s34, 75857920
L_wf_162:
  buffer_load_dwordx2 v[6:7], v4, s[8:11], s34 offen sc1
  s_add_u32 s6, s6, 1
  s_cmp_gt_u32 s6, 262144
  s_cbranch_scc1 L_timeout
  s_waitcnt vmcnt(0)
  v_cmp_ne_u32 vcc, s98, v6
  v_cmp_ne_u32 s[36:37], s98, v7
  s_or_b64 vcc, vcc, s[36:37]
  s_cbranch_vccz L_wfok_163
  s_sleep 16
  s_branch L_wf_162
L_wfok_163:
L_afy_161:
  s_barrier
  s_cmp_eq_u32 s3, 0
  s_cbranch_scc0 L_wpd_165
  v_lshlrev_b32 v4, 7, v0
  s_mov_b32 s34, 77721600
L_wp_164:
  s_add_u32 s35, s34, 0
  buffer_load_dwordx2 v[8:9], v4, s[8:11], s35 offen sc1
  s_add_u32 s35, s34, 8192
  buffer_load_dwordx2 v[10:11], v4, s[8:11], s35 offen sc1
  s_add_u32 s35, s34, 16384
  buffer_load_dwordx2 v[12:13], v4, s[8:11], s35 offen sc1
  s_add_u32 s35, s34, 24576
  buffer_load_dwordx2 v[14:15], v4, s[8:11], s35 offen sc1
  s_add_u32 s6, s6, 1
  s_cmp_gt_u32 s6, 262144
  s_cbranch_scc1 L_timeout
  s_waitcnt vmcnt(0)
  v_cmp_ne_u32 vcc, s98, v8
  v_cmp_ne_u32 s[36:37], s98, v9
  s_or_b64 vcc, vcc, s[36:37]
  v_cmp_ne_u32 s[36:37], s98, v10
  s_or_b64 vcc, vcc, s[36:37]
  v_cmp_ne_u32 s[36:37], s98, v11
  s_or_b64 vcc, vcc, s[36:37]
  v_cmp_ne_u32 s[36:37], s98, v12
  s_or_b64 vcc, vcc, s[36:37]
  v_cmp_ne_u32 s[36:37], s98, v13
  s_or_b64 vcc, vcc, s[36:37]
  v_cmp_ne_u32 s[36:37], s98, v14
  s_or_b64 vcc, vcc, s[36:37]
  v_cmp_ne_u32 s[36:37], s98, v15
  s_or_b64 vcc, vcc, s[36:37]
  s_cbranch_vccz L_wpd_165
  s_sleep 2
  s_branch L_wp_164
L_wpd_165:
  s_barrier
  s_mov_b32 s44, s31
  s_mul_i32 s35, s3, 7168
  s_add_u32 s46, s35, 32768
  s_mul_i32 s45, s31, 28672
  s_add_u32 s45, s45, s35
  s_add_u32 s45, s45, 12845056
  s_add_u32 s33, s46, 0
  s_mov_b32 m0, s33
  s_add_u32 s34, s45, 0
  buffer_load_dwordx4 v3, s[8:11], s34 offen offset:0 sc1 lds
  buffer_load_dwordx4 v3, s[8:11], s34 offen offset:1024 sc1 lds
  buffer_load_dwordx4 v3, s[8:11], s34 offen offset:2048 sc1 lds
  buffer_load_dwordx4 v3, s[8:11], s34 offen offset:3072 sc1 lds
  s_add_u32 s33, s46, 4096
  s_mov_b32 m0, s33
  s_add_u32 s34, s45, 4096
  buffer_load_dwordx4 v3, s[8:11], s34 offen offset:0 sc1 lds
  buffer_load_dwordx4 v3, s[8:11], s34 offen offset:1024 sc1 lds
  buffer_load_dwordx4 v3, s[8:11], s34 offen offset:2048 sc1 lds
  s_and_b32 s50, s3, 1
  s_mul_i32 s33, s3, 7
  s_add_u32 s51, s33, s50
  s_lshr_b32 s51, s51, 1
  s_mul_i32 s34, s30, 401408
  s_mul_i32 s33, s3, 100352
  s_add_u32 s34, s34, s33
  s_mul_i32 s35, s50, 14336
  s_add_u32 s35, s35, s34
  s_add_u32 s36, s34, 86016
  s_cmp_eq_u32 s50, 0
  s_cselect_b32 s36, s36, s34
  s_cselect_b64 s[72:73], 0, -1
  s_add_u32 s37, s35, 0
  buffer_load_dwordx4 a[0:3], v3, s[8:11], s37 offen offset:0 sc1
  buffer_load_dwordx4 a[4:7], v3, s[8:11], s37 offen offset:1024 sc1
  buffer_load_dwordx4 a[8:11], v3, s[8:11], s37 offen offset:2048 sc1
  buffer_load_dwordx4 a[12:15], v3, s[8:11], s37 offen offset:3072 sc1
  s_add_u32 s37, s37, 4096
  buffer_load_dwordx4 a[16:19], v3, s[8:11], s37 offen offset:0 sc1
  buffer_load_dwordx4 a[20:23], v3, s[8:11], s37 offen offset:1024 sc1
  buffer_load_dwordx4 a[24:27], v3, s[8:11], s37 offen offset:2048 sc1
  buffer_load_dwordx4 a[28:31], v3, s[8:11], s37 offen offset:3072 sc1
  s_add_u32 s37, s37, 4096
  buffer_load_dwordx4 a[32:35], v3, s[8:11], s37 offen offset:0 sc1
  buffer_load_dwordx4 a[36:39], v3, s[8:11], s37 offen offset:1024 sc1
  buffer_load_dwordx4 a[40:43], v3, s[8:11], s37 offen offset:2048 sc1
  buffer_load_dwordx4 a[44:47], v3, s[8:11], s37 offen offset:3072 sc1
  s_add_u32 s37, s37, 4096
  buffer_load_dwordx4 a[48:51], v3, s[8:11], s37 offen offset:0 sc1
  buffer_load_dwordx4 a[52:55], v3, s[8:11], s37 offen offset:1024 sc1
  s_add_u32 s37, s35, 14336
  buffer_load_dwordx4 a[56:59], v3, s[8:11], s37 offen offset:0 sc1
  buffer_load_dwordx4 a[60:63], v3, s[8:11], s37 offen offset:1024 sc1
  buffer_load_dwordx4 a[64:67], v3, s[8:11], s37 offen offset:2048 sc1
  buffer_load_dwordx4 a[68:71], v3, s[8:11], s37 offen offset:3072 sc1
  s_add_u32 s37, s37, 4096
  buffer_load_dwordx4 a[72:75], v3, s[8:11], s37 offen offset:0 sc1
  buffer_load_dwordx4 a[76:79], v3, s[8:11], s37 offen offset:1024 sc1
  buffer_load_dwordx4 a[80:83], v3, s[8:11], s37 offen offset:2048 sc1
  buffer_load_dwordx4 a[84:87], v3, s[8:11], s37 offen offset:3072 sc1
  s_add_u32 s37, s37, 4096
  buffer_load_dwordx4 a[88:91], v3, s[8:11], s37 offen offset:0 sc1
  buffer_load_dwordx4 a[92:95], v3, s[8:11], s37 offen offset:1024 sc1
  buffer_load_dwordx4 a[96:99], v3, s[8:11], s37 offen offset:2048 sc1
  buffer_load_dwordx4 a[100:103], v3, s[8:11], s37 offen offset:3072 sc1
  s_add_u32 s37, s37, 4096
  buffer_load_dwordx4 a[104:107], v3, s[8:11], s37 offen offset:0 sc1
  buffer_load_dwordx4 a[108:111], v3, s[8:11], s37 offen offset:1024 sc1
  s_add_u32 s37, s35, 28672
  buffer_load_dwordx4 a[112:115], v3, s[8:11], s37 offen offset:0 sc1
  buffer_load_dwordx4 a[116:119], v3, s[8:11], s37 offen offset:1024 sc1
  buffer_load_dwordx4 a[120:123], v3, s[8:11], s37 offen offset:2048 sc1
  buffer_load_dwordx4 a[124:127], v3, s[8:11], s37 offen offset:3072 sc1
  s_add_u32 s37, s37, 4096
  buffer_load_dwordx4 a[128:131], v3, s[8:11], s37 offen offset:0 sc1
  buffer_load_dwordx4 a[132:135], v3, s[8:11], s37 offen offset:1024 sc1
  buffer_load_dwordx4 a[136:139], v3, s[8:11], s37 offen offset:2048 sc1
  buffer_load_dwordx4 a[140:143], v3, s[8:11], s37 offen offset:3072 sc1
  s_add_u32 s37, s37, 4096
  buffer_load_dwordx4 a[144:147], v3, s[8:11], s37 offen offset:0 sc1
  buffer_load_dwordx4 a[148:151], v3, s[8:11], s37 offen offset:1024 sc1
  buffer_load_dwordx4 a[152:155], v3, s[8:11], s37 offen offset:2048 sc1
  buffer_load_dwordx4 a[156:159], v3, s[8:11], s37 offen offset:3072 sc1
  s_add_u32 s37, s37, 4096
  buffer_load_dwordx4 a[160:163], v3, s[8:11], s37 offen offset:0 sc1
  buffer_load_dwordx4 a[164:167], v3, s[8:11], s37 offen offset:1024 sc1
  s_add_u32 s37, s35, 43008
  buffer_load_dwordx4 a[168:171], v3, s[8:11], s37 offen offset:0 sc1
  buffer_load_dwordx4 a[172:175], v3, s[8:11], s37 offen offset:1024 sc1
  buffer_load_dwordx4 a[176:179], v3, s[8:11], s37 offen offset:2048 sc1
  buffer_load_dwordx4 a[180:183], v3, s[8:11], s37 offen offset:3072 sc1
  s_add_u32 s37, s37, 4096
  buffer_load_dwordx4 a[184:187], v3, s[8:11], s37 offen offset:0 sc1
  buffer_load_dwordx4 a[188:191], v3, s[8:11], s37 offen offset:1024 sc1
  buffer_load_dwordx4 a[192:195], v3, s[8:11], s37 offen offset:2048 sc1
  buffer_load_dwordx4 a[196:199], v3, s[8:11], s37 offen offset:3072 sc1
  s_add_u32 s37, s37, 4096
  buffer_load_dwordx4 a[200:203], v3, s[8:11], s37 offen offset:0 sc1
  buffer_load_dwordx4 a[204:207], v3, s[8:11], s37 offen offset:1024 sc1
  buffer_load_dwordx4 a[208:211], v3, s[8:11], s37 offen offset:2048 sc1
  buffer_load_dwordx4 a[212:215], v3, s[8:11], s37 offen offset:3072 sc1
  s_add_u32 s37, s37, 4096
  buffer_load_dwordx4 a[216:219], v3, s[8:11], s37 offen offset:0 sc1
  buffer_load_dwordx4 a[220:223], v3, s[8:11], s37 offen offset:1024 sc1
  s_add_u32 s37, s35, 57344
  s_waitcnt vmcnt(62)
  buffer_load_dwordx4 a[224:227], v3, s[8:11], s37 offen offset:0 sc1
  s_waitcnt vmcnt(62)
  buffer_load_dwordx4 a[228:231], v3, s[8:11], s37 offen offset:1024 sc1
  s_waitcnt vmcnt(62)
  buffer_load_dwordx4 a[232:235], v3, s[8:11], s37 offen offset:2048 sc1
  s_waitcnt vmcnt(62)
  buffer_load_dwordx4 a[236:239], v3, s[8:11], s37 offen offset:3072 sc1
  s_add_u32 s37, s37, 4096
  s_waitcnt vmcnt(62)
  buffer_load_dwordx4 a[240:243], v3, s[8:11], s37 offen offset:0 sc1
  s_waitcnt vmcnt(62)
  buffer_load_dwordx4 a[244:247], v3, s[8:11], s37 offen offset:1024 sc1
  s_waitcnt vmcnt(62)
  buffer_load_dwordx4 a[248:251], v3, s[8:11], s37 offen offset:2048 sc1
  s_waitcnt vmcnt(62)
  buffer_load_dwordx4 a[252:255], v3, s[8:11], s37 offen offset:3072 sc1
  s_add_u32 s37, s37, 4096
  s_waitcnt vmcnt(62)
  buffer_load_dwordx4 v[120:123], v3, s[8:11], s37 offen offset:0 sc1
  s_waitcnt vmcnt(62)
  buffer_load_dwordx4 v[124:127], v3, s[8:11], s37 offen offset:1024 sc1
  s_waitcnt vmcnt(62)
  buffer_load_dwordx4 v[128:131], v3, s[8:11], s37 offen offset:2048 sc1
  s_waitcnt vmcnt(62)
  buffer_load_dwordx4 v[132:135], v3, s[8:11], s37 offen offset:3072 sc1
  s_add_u32 s37, s37, 4096
  s_waitcnt vmcnt(62)
  buffer_load_dwordx4 v[136:139], v3, s[8:11], s37 offen offset:0 sc1
  s_waitcnt vmcnt(62)
  buffer_load_dwordx4 v[140:143], v3, s[8:11], s37 offen offset:1024 sc1
  s_add_u32 s37, s35, 71680
  s_waitcnt vmcnt(62)
  buffer_load_dwordx4 v[144:147], v3, s[8:11], s37 offen offset:0 sc1
  s_waitcnt vmcnt(62)
  buffer_load_dwordx4 v[148:151], v3, s[8:11], s37 offen offset:1024 sc1
  s_waitcnt vmcnt(62)
  buffer_load_dwordx4 v[152:155], v3, s[8:11], s37 offen offset:2048 sc1
  s_waitcnt vmcnt(62)
  buffer_load_dwordx4 v[156:159], v3, s[8:11], s37 offen offset:3072 sc1
  s_add_u32 s37, s37, 4096
  s_waitcnt vmcnt(62)
  buffer_load_dwordx4 v[160:163], v3, s[8:11], s37 offen offset:0 sc1
  s_waitcnt vmcnt(62)
  buffer_load_dwordx4 v[164:167], v3, s[8:11], s37 offen offset:1024 sc1
  s_waitcnt vmcnt(62)
  buffer_load_dwordx4 v[168:171], v3, s[8:11], s37 offen offset:2048 sc1
  s_waitcnt vmcnt(62)
  buffer_load_dwordx4 v[172:175], v3, s[8:11], s37 offen offset:3072 sc1
  s_add_u32 s37, s37, 4096
  s_waitcnt vmcnt(62)
  buffer_load_dwordx4 v[176:179], v3, s[8:11], s37 offen offset:0 sc1
  s_waitcnt vmcnt(62)
  buffer_load_dwordx4 v[180:183], v3, s[8:11], s37 offen offset:1024 sc1
  s_waitcnt vmcnt(62)
  buffer_load_dwordx4 v[184:187], v3, s[8:11], s37 offen offset:2048 sc1
  s_waitcnt vmcnt(62)
  buffer_load_dwordx4 v[188:191], v3, s[8:11], s37 offen offset:3072 sc1
  s_add_u32 s37, s37, 4096
  s_waitcnt vmcnt(62)
  buffer_load_dwordx4 v[192:195], v3, s[8:11], s37 offen offset:0 sc1
  s_waitcnt vmcnt(62)
  buffer_load_dwordx4 v[196:199], v3, s[8:11], s37 offen offset:1024 sc1
  s_mov_b32 s37, s36
  s_waitcnt vmcnt(62)
  buffer_load_dwordx4 v[200:203], v3, s[8:11], s37 offen offset:0 sc1
  s_waitcnt vmcnt(62)
  buffer_load_dwordx4 v[204:207], v3, s[8:11], s37 offen offset:1024 sc1
  s_waitcnt vmcnt(62)
  buffer_load_dwordx4 v[208:211], v3, s[8:11], s37 offen offset:2048 sc1
  s_waitcnt vmcnt(62)
  buffer_load_dwordx4 v[212:215], v3, s[8:11], s37 offen offset:3072 sc1
  s_add_u32 s37, s37, 4096
  s_waitcnt vmcnt(62)
  buffer_load_dwordx4 v[216:219], v3, s[8:11], s37 offen offset:0 sc1
  s_waitcnt vmcnt(62)
  buffer_load_dwordx4 v[220:223], v3, s[8:11], s37 offen offset:1024 sc1
  s_waitcnt vmcnt(62)
  buffer_load_dwordx4 v[224:227], v3, s[8:11], s37 offen offset:2048 sc1
  s_waitcnt vmcnt(62)
  buffer_load_dwordx4 v[228:231], v3, s[8:11], s37 offen offset:3072 sc1
  s_add_u32 s37, s37, 4096
  s_waitcnt vmcnt(62)
  buffer_load_dwordx4 v[232:235], v3, s[8:11], s37 offen offset:0 sc1
  s_waitcnt vmcnt(62)
  buffer_load_dwordx4 v[236:239], v3, s[8:11], s37 offen offset:1024 sc1
  s_waitcnt vmcnt(62)
  buffer_load_dwordx4 v[240:243], v3, s[8:11], s37 offen offset:2048 sc1
  s_waitcnt vmcnt(62)
  buffer_load_dwordx4 v[244:247], v3, s[8:11], s37 offen offset:3072 sc1
  s_add_u32 s37, s37, 4096
  s_waitcnt vmcnt(62)
  buffer_load_dwordx4 v[248:251], v3, s[8:11], s37 offen offset:0 sc1
  s_waitcnt vmcnt(62)
  buffer_load_dwordx4 v[252:255], v3, s[8:11], s37 offen offset:1024 sc1
  s_mul_i32 s33, s3, 1792
  v_add_u32 v89, s33, v3
  v_min_u32 v90, 47, v0
  v_lshlrev_b32 v90, 4, v90
  s_add_u32 s33, s33, 1024
  v_add_u32 v90, s33, v90
  v_mov_b32 v88, 0
  v_mov_b32 v102, 0xceabfb8f
  v_lshrrev_b32 v4, 3, v1
  v_lshlrev_b32 v4, 1, v4
  v_xor_b32 v4, v4, v2
  v_lshl_add_u32 v4, v1, 2, v4
  v_lshlrev_b32 v91, 4, v4
  v_lshrrev_b32 v4, 1, v1
  v_add_u32 v4, 0, v4
  v_lshrrev_b32 v5, 3, v4
  v_lshlrev_b32 v5, 1, v5
  v_xor_b32 v5, v5, v2
  v_lshl_add_u32 v5, v4, 2, v5
  v_lshlrev_b32 v92, 4, v5
  v_and_b32 v4, 1, v1
  v_mul_u32_u24 v4, 14336, v4
  v_add_u32 v92, v92, v4
  v_lshrrev_b32 v4, 1, v1
  v_add_u32 v4, 8, v4
  v_lshrrev_b32 v5, 3, v4
  v_lshlrev_b32 v5, 1, v5
  v_xor_b32 v5, v5, v2
  v_lshl_add_u32 v5, v4, 2, v5
  v_lshlrev_b32 v93, 4, v5
  v_and_b32 v4, 1, v1
  v_mul_u32_u24 v4, 14336, v4
  v_add_u32 v93, v93, v4
  v_add_u32 v91, 32768, v91
  s_lshl_b32 s33, s51, 10
  s_add_u32 s33, s33, 32768
  s_lshl_b32 s34, s50, 12
  s_sub_u32 s34, 3072, s34
  v_add_u32 v92, s33, v92
  v_add_u32 v94, s34, v92
  v_add_u32 v93, s33, v93
  v_add_u32 v95, s34, v93
  v_and_b32 v4, 7, v1
  v_lshlrev_b32 v4, 4, v4
  v_lshrrev_b32 v5, 1, v2
  v_lshl_add_u32 v4, v5, 8, v4
  v_and_b32 v5, 1, v2
  v_lshl_add_u32 v4, v5, 3, v4
  s_lshl_b32 s33, s51, 9
  v_add_u32 v96, s33, v4
  v_add_u32 v97, 1024, v96
  s_lshl_b32 s34, s50, 11
  s_sub_u32 s34, 1536, s34
  v_add_u32 v98, s34, v96
  s_lshl_b32 s33, s3, 10
  v_add_u32 v99, s33, v3
  s_lshl_b32 s33, s50, 12
  v_add_u32 v100, s33, v3
  v_lshlrev_b32 v101, 3, v0
  s_lshl_b32 s33, s50, 4
  v_add_u32 v5, s33, v1
  v_lshl_add_u32 v4, v2, 1, 0
  v_cmp_le_u32 s[56:57], v4, v5
  v_lshl_add_u32 v4, v2, 1, 16
  v_cmp_le_u32 s[58:59], v4, v5
  v_lshl_add_u32 v4, v2, 1, 1
  v_cmp_le_u32 s[60:61], v4, v5
  v_lshl_add_u32 v4, v2, 1, 17
  v_cmp_le_u32 s[62:63], v4, v5
  v_lshl_add_u32 v4, v2, 1, 8
  v_cmp_le_u32 s[64:65], v4, v5
  v_lshl_add_u32 v4, v2, 1, 24
  v_cmp_le_u32 s[66:67], v4, v5
  v_lshl_add_u32 v4, v2, 1, 9
  v_cmp_le_u32 s[68:69], v4, v5
  v_lshl_add_u32 v4, v2, 1, 25
  v_cmp_le_u32 s[70:71], v4, v5
  s_lshl_b32 s47, s31, 13
  s_add_u32 s47, s47, 45875200
  s_lshl_b32 s33, s31, 4
  s_add_u32 s33, s33, s30
  s_lshl_b32 s33, s33, 1
  s_add_u32 s33, s33, s50
  s_mul_i32 s48, s33, 1536
  s_add_u32 s48, s48, 63307776
  s_lshl_b32 s33, s30, 1
  s_add_u32 s33, s33, s50
  s_lshl_b32 s33, s33, 7
  s_mul_i32 s49, s31, 28672
  s_add_u32 s49, s49, s33
  s_add_u32 s49, s49, 75862016
  s_waitcnt vmcnt(0)
L_x1_top_166:
  s_barrier
  s_add_u32 s33, s44, 3
  s_cmp_ge_u32 s33, 64
  s_cbranch_scc1 L_x1_nodma_167
  s_add_u32 s45, s45, 86016
  s_xor_b32 s46, s46, 0x18000
  s_add_u32 s33, s46, 0
  s_mov_b32 m0, s33
  s_add_u32 s34, s45, 0
  buffer_load_dwordx4 v3, s[8:11], s34 offen offset:0 sc1 lds
  buffer_load_dwordx4 v3, s[8:11], s34 offen offset:1024 sc1 lds
  buffer_load_dwordx4 v3, s[8:11], s34 offen offset:2048 sc1 lds
  buffer_load_dwordx4 v3, s[8:11], s34 offen offset:3072 sc1 lds
  s_add_u32 s33, s46, 4096
  s_mov_b32 m0, s33
  s_add_u32 s34, s45, 4096
  buffer_load_dwordx4 v3, s[8:11], s34 offen offset:0 sc1 lds
  buffer_load_dwordx4 v3, s[8:11], s34 offen offset:1024 sc1 lds
  buffer_load_dwordx4 v3, s[8:11], s34 offen offset:2048 sc1 lds
L_x1_nodma_167:
  ds_read_b128 v[32:35], v91 offset:0
  ds_read_b128 v[36:39], v91 offset:1024
  ds_read_b128 v[40:43], v91 offset:2048
  ds_read_b128 v[44:47], v91 offset:3072
  s_waitcnt lgkmcnt(3)
  v_mfma_f32_16x16x32_bf16 v[4:7], a[0:3], v[32:35], 0
  v_mfma_f32_16x16x32_bf16 v[8:11], a[56:59], v[32:35], 0
  v_mfma_f32_16x16x32_bf16 v[12:15], a[112:115], v[32:35], 0
  v_mfma_f32_16x16x32_bf16 v[16:19], a[168:171], v[32:35], 0
  v_mfma_f32_16x16x32_bf16 v[20:23], a[224:227], v[32:35], 0
  v_mfma_f32_16x16x32_bf16 v[24:27], v[144:147], v[32:35], 0
  v_mfma_f32_16x16x32_bf16 v[28:31], v[200:203], v[32:35], 0
  ds_read_b128 v[32:35], v91 offset:4096
  s_waitcnt lgkmcnt(3)
  v_mfma_f32_16x16x32_bf16 v[4:7], a[4:7], v[36:39], v[4:7]
  v_mfma_f32_16x16x32_bf16 v[8:11], a[60:63], v[36:39], v[8:11]
  v_mfma_f32_16x16x32_bf16 v[12:15], a[116:119], v[36:39], v[12:15]
  v_mfma_f32_16x16x32_bf16 v[16:19], a[172:175], v[36:39], v[16:19]
  v_mfma_f32_16x16x32_bf16 v[20:23], a[228:231], v[36:39], v[20:23]
  v_mfma_f32_16x16x32_bf16 v[24:27], v[148:151], v[36:39], v[24:27]
  v_mfma_f32_16x16x32_bf16 v[28:31], v[204:207], v[36:39], v[28:31]
  ds_read_b128 v[36:39], v91 offset:5120
  s_waitcnt lgkmcnt(3)
  v_mfma_f32_16x16x32_bf16 v[4:7], a[8:11], v[40:43], v[4:7]
  v_mfma_f32_16x16x32_bf16 v[8:11], a[64:67], v[40:43], v[8:11]
  v_mfma_f32_16x16x32_bf16 v[12:15], a[120:123], v[40:43], v[12:15]
  v_mfma_f32_16x16x32_bf16 v[16:19], a[176:179], v[40:43], v[16:19]
  v_mfma_f32_16x16x32_bf16 v[20:23], a[232:235], v[40:43], v[20:23]
  v_mfma_f32_16x16x32_bf16 v[24:27], v[152:155], v[40:43], v[24:27]
  v_mfma_f32_16x16x32_bf16 v[28:31], v[208:211], v[40:43], v[28:31]
  ds_read_b128 v[40:43], v91 offset:6144
  s_waitcnt lgkmcnt(3)
  v_mfma_f32_16x16x32_bf16 v[4:7], a[12:15], v[44:47], v[4:7]
  v_mfma_f32_16x16x32_bf16 v[8:11], a[68:71], v[44:47], v[8:11]
  v_mfma_f32_16x16x32_bf16 v[12:15], a[124:127], v[44:47], v[12:15]
  v_mfma_f32_16x16x32_bf16 v[16:19], a[180:183], v[44:47], v[16:19]
  v_mfma_f32_16x16x32_bf16 v[20:23], a[236:239], v[44:47], v[20:23]
  v_mfma_f32_16x16x32_bf16 v[24:27], v[156:159], v[44:47], v[24:27]
  v_mfma_f32_16x16x32_bf16 v[28:31], v[212:215], v[44:47], v[28:31]
  ds_read_b128 v[44:47], v91 offset:7168
  s_waitcnt lgkmcnt(3)
  v_mfma_f32_16x16x32_bf16 v[4:7], a[16:19], v[32:35], v[4:7]
  v_mfma_f32_16x16x32_bf16 v[8:11], a[72:75], v[32:35], v[8:11]
  v_mfma_f32_16x16x32_bf16 v[12:15], a[128:131], v[32:35], v[12:15]
  v_mfma_f32_16x16x32_bf16 v[16:19], a[184:187], v[32:35], v[16:19]
  v_mfma_f32_16x16x32_bf16 v[20:23], a[240:243], v[32:35], v[20:23]
  v_mfma_f32_16x16x32_bf16 v[24:27], v[160:163], v[32:35], v[24:27]
  v_mfma_f32_16x16x32_bf16 v[28:31], v[216:219], v[32:35], v[28:31]
  ds_read_b128 v[32:35], v91 offset:8192
  s_waitcnt lgkmcnt(3)
  v_mfma_f32_16x16x32_bf16 v[4:7], a[20:23], v[36:39], v[4:7]
  v_mfma_f32_16x16x32_bf16 v[8:11], a[76:79], v[36:39], v[8:11]
  v_mfma_f32_16x16x32_bf16 v[12:15], a[132:135], v[36:39], v[12:15]
  v_mfma_f32_16x16x32_bf16 v[16:19], a[188:191], v[36:39], v[16:19]
  v_mfma_f32_16x16x32_bf16 v[20:23], a[244:247], v[36:39], v[20:23]
  v_mfma_f32_16x16x32_bf16 v[24:27], v[164:167], v[36:39], v[24:27]
  v_mfma_f32_16x16x32_bf16 v[28:31], v[220:223], v[36:39], v[28:31]
  ds_read_b128 v[36:39], v91 offset:9216
  s_waitcnt lgkmcnt(3)
  v_mfma_f32_16x16x32_bf16 v[4:7], a[24:27], v[40:43], v[4:7]
  v_mfma_f32_16x16x32_bf16 v[8:11], a[80:83], v[40:43], v[8:11]
  v_mfma_f32_16x16x32_bf16 v[12:15], a[136:139], v[40:43], v[12:15]
  v_mfma_f32_16x16x32_bf16 v[16:19], a[192:195], v[40:43], v[16:19]
  v_mfma_f32_16x16x32_bf16 v[20:23], a[248:251], v[40:43], v[20:23]
  v_mfma_f32_16x16x32_bf16 v[24:27], v[168:171], v[40:43], v[24:27]
  v_mfma_f32_16x16x32_bf16 v[28:31], v[224:227], v[40:43], v[28:31]
  ds_read_b128 v[40:43], v91 offset:10240
  s_waitcnt lgkmcnt(3)
  v_mfma_f32_16x16x32_bf16 v[4:7], a[28:31], v[44:47], v[4:7]
  v_mfma_f32_16x16x32_bf16 v[8:11], a[84:87], v[44:47], v[8:11]
  v_mfma_f32_16x16x32_bf16 v[12:15], a[140:143], v[44:47], v[12:15]
  v_mfma_f32_16x16x32_bf16 v[16:19], a[196:199], v[44:47], v[16:19]
  v_mfma_f32_16x16x32_bf16 v[20:23], a[252:255], v[44:47], v[20:23]
  v_mfma_f32_16x16x32_bf16 v[24:27], v[172:175], v[44:47], v[24:27]
  v_mfma_f32_16x16x32_bf16 v[28:31], v[228:231], v[44:47], v[28:31]
  ds_read_b128 v[44:47], v91 offset:11264
  s_waitcnt lgkmcnt(3)
  v_mfma_f32_16x16x32_bf16 v[4:7], a[32:35], v[32:35], v[4:7]
  v_mfma_f32_16x16x32_bf16 v[8:11], a[88:91], v[32:35], v[8:11]
  v_mfma_f32_16x16x32_bf16 v[12:15], a[144:147], v[32:35], v[12:15]
  v_mfma_f32_16x16x32_bf16 v[16:19], a[200:203], v[32:35], v[16:19]
  v_mfma_f32_16x16x32_bf16 v[20:23], v[120:123], v[32:35], v[20:23]
  v_mfma_f32_16x16x32_bf16 v[24:27], v[176:179], v[32:35], v[24:27]
  v_mfma_f32_16x16x32_bf16 v[28:31], v[232:235], v[32:35], v[28:31]
  ds_read_b128 v[32:35], v91 offset:12288
  s_waitcnt lgkmcnt(3)
  v_mfma_f32_16x16x32_bf16 v[4:7], a[36:39], v[36:39], v[4:7]
  v_mfma_f32_16x16x32_bf16 v[8:11], a[92:95], v[36:39], v[8:11]
  v_mfma_f32_16x16x32_bf16 v[12:15], a[148:151], v[36:39], v[12:15]
  v_mfma_f32_16x16x32_bf16 v[16:19], a[204:207], v[36:39], v[16:19]
  v_mfma_f32_16x16x32_bf16 v[20:23], v[124:127], v[36:39], v[20:23]
  v_mfma_f32_16x16x32_bf16 v[24:27], v[180:183], v[36:39], v[24:27]
  v_mfma_f32_16x16x32_bf16 v[28:31], v[236:239], v[36:39], v[28:31]
  ds_read_b128 v[36:39], v91 offset:13312
  s_waitcnt lgkmcnt(3)
  v_mfma_f32_16x16x32_bf16 v[4:7], a[40:43], v[40:43], v[4:7]
  v_mfma_f32_16x16x32_bf16 v[8:11], a[96:99], v[40:43], v[8:11]
  v_mfma_f32_16x16x32_bf16 v[12:15], a[152:155], v[40:43], v[12:15]
  v_mfma_f32_16x16x32_bf16 v[16:19], a[208:211], v[40:43], v[16:19]
  v_mfma_f32_16x16x32_bf16 v[20:23], v[128:131], v[40:43], v[20:23]
  v_mfma_f32_16x16x32_bf16 v[24:27], v[184:187], v[40:43], v[24:27]
  v_mfma_f32_16x16x32_bf16 v[28:31], v[240:243], v[40:43], v[28:31]
  ds_read_b128 v[40:43], v91 offset:14336
  s_waitcnt lgkmcnt(3)
  v_mfma_f32_16x16x32_bf16 v[4:7], a[44:47], v[44:47], v[4:7]
  v_mfma_f32_16x16x32_bf16 v[8:11], a[100:103], v[44:47], v[8:11]
  v_mfma_f32_16x16x32_bf16 v[12:15], a[156:159], v[44:47], v[12:15]
  v_mfma_f32_16x16x32_bf16 v[16:19], a[212:215], v[44:47], v[16:19]
  v_mfma_f32_16x16x32_bf16 v[20:23], v[132:135], v[44:47], v[20:23]
  v_mfma_f32_16x16x32_bf16 v[24:27], v[188:191], v[44:47], v[24:27]
  v_mfma_f32_16x16x32_bf16 v[28:31], v[244:247], v[44:47], v[28:31]
  ds_read_b128 v[44:47], v91 offset:15360
  s_waitcnt lgkmcnt(3)
  v_mfma_f32_16x16x32_bf16 v[4:7], a[48:51], v[32:35], v[4:7]
  v_mfma_f32_16x16x32_bf16 v[8:11], a[104:107], v[32:35], v[8:11]
  v_mfma_f32_16x16x32_bf16 v[12:15], a[160:163], v[32:35], v[12:15]
  v_mfma_f32_16x16x32_bf16 v[16:19], a[216:219], v[32:35], v[16:19]
  v_mfma_f32_16x16x32_bf16 v[20:23], v[136:139], v[32:35], v[20:23]
  v_mfma_f32_16x16x32_bf16 v[24:27], v[192:195], v[32:35], v[24:27]
  v_mfma_f32_16x16x32_bf16 v[28:31], v[248:251], v[32:35], v[28:31]
  ds_read_b128 v[32:35], v91 offset:16384
  s_waitcnt lgkmcnt(3)
  v_mfma_f32_16x16x32_bf16 v[4:7], a[52:55], v[36:39], v[4:7]
  v_mfma_f32_16x16x32_bf16 v[8:11], a[108:111], v[36:39], v[8:11]
  v_mfma_f32_16x16x32_bf16 v[12:15], a[164:167], v[36:39], v[12:15]
  v_mfma_f32_16x16x32_bf16 v[16:19], a[220:223], v[36:39], v[16:19]
  v_mfma_f32_16x16x32_bf16 v[20:23], v[140:143], v[36:39], v[20:23]
  v_mfma_f32_16x16x32_bf16 v[24:27], v[196:199], v[36:39], v[24:27]
  v_mfma_f32_16x16x32_bf16 v[28:31], v[252:255], v[36:39], v[28:31]
  s_nop 1
  v_cvt_pk_bf16_f32 v48, v4, v5
  v_cvt_pk_bf16_f32 v49, v6, v7
  v_cvt_pk_bf16_f32 v50, v8, v9
  v_cvt_pk_bf16_f32 v51, v10, v11
  v_cvt_pk_bf16_f32 v52, v12, v13
  v_cvt_pk_bf16_f32 v53, v14, v15
  v_cvt_pk_bf16_f32 v54, v16, v17
  v_cvt_pk_bf16_f32 v55, v18, v19
  v_cvt_pk_bf16_f32 v56, v20, v21
  v_cvt_pk_bf16_f32 v57, v22, v23
  v_cvt_pk_bf16_f32 v58, v24, v25
  v_cvt_pk_bf16_f32 v59, v26, v27
  v_cvt_pk_bf16_f32 v103, v28, v29
  v_cvt_pk_bf16_f32 v104, v30, v31
  v_cndmask_b32 v60, v103, v88, s[72:73]
  v_cndmask_b32 v62, v88, v103, s[72:73]
  v_cndmask_b32 v61, v104, v88, s[72:73]
  v_cndmask_b32 v63, v88, v104, s[72:73]
  ds_read_b128 v[36:39], v91 offset:17408
  s_waitcnt lgkmcnt(3)
  v_mfma_f32_16x16x32_bf16 v[4:7], a[0:3], v[40:43], 0
  v_mfma_f32_16x16x32_bf16 v[8:11], a[56:59], v[40:43], 0
  v_mfma_f32_16x16x32_bf16 v[12:15], a[112:115], v[40:43], 0
  v_mfma_f32_16x16x32_bf16 v[16:19], a[168:171], v[40:43], 0
  v_mfma_f32_16x16x32_bf16 v[20:23], a[224:227], v[40:43], 0
  v_mfma_f32_16x16x32_bf16 v[24:27], v[144:147], v[40:43], 0
  v_mfma_f32_16x16x32_bf16 v[28:31], v[200:203], v[40:43], 0
  ds_read_b128 v[40:43], v91 offset:18432
  s_waitcnt lgkmcnt(3)
  v_mfma_f32_16x16x32_bf16 v[4:7], a[4:7], v[44:47], v[4:7]
  v_mfma_f32_16x16x32_bf16 v[8:11], a[60:63], v[44:47], v[8:11]
  v_mfma_f32_16x16x32_bf16 v[12:15], a[116:119], v[44:47], v[12:15]
  v_mfma_f32_16x16x32_bf16 v[16:19], a[172:175], v[44:47], v[16:19]
  v_mfma_f32_16x16x32_bf16 v[20:23], a[228:231], v[44:47], v[20:23]
  v_mfma_f32_16x16x32_bf16 v[24:27], v[148:151], v[44:47], v[24:27]
  v_mfma_f32_16x16x32_bf16 v[28:31], v[204:207], v[44:47], v[28:31]
  ds_read_b128 v[44:47], v91 offset:19456
  s_waitcnt lgkmcnt(3)
  v_mfma_f32_16x16x32_bf16 v[4:7], a[8:11], v[32:35], v[4:7]
  v_mfma_f32_16x16x32_bf16 v[8:11], a[64:67], v[32:35], v[8:11]
  v_mfma_f32_16x16x32_bf16 v[12:15], a[120:123], v[32:35], v[12:15]
  v_mfma_f32_16x16x32_bf16 v[16:19], a[176:179], v[32:35], v[16:19]
  v_mfma_f32_16x16x32_bf16 v[20:23], a[232:235], v[32:35], v[20:23]
  v_mfma_f32_16x16x32_bf16 v[24:27], v[152:155], v[32:35], v[24:27]
  v_mfma_f32_16x16x32_bf16 v[28:31], v[208:211], v[32:35], v[28:31]
  ds_read_b128 v[32:35], v91 offset:20480
  s_waitcnt lgkmcnt(3)
  v_mfma_f32_16x16x32_bf16 v[4:7], a[12:15], v[36:39], v[4:7]
  v_mfma_f32_16x16x32_bf16 v[8:11], a[68:71], v[36:39], v[8:11]
  v_mfma_f32_16x16x32_bf16 v[12:15], a[124:127], v[36:39], v[12:15]
  v_mfma_f32_16x16x32_bf16 v[16:19], a[180:183], v[36:39], v[16:19]
  v_mfma_f32_16x16x32_bf16 v[20:23], a[236:239], v[36:39], v[20:23]
  v_mfma_f32_16x16x32_bf16 v[24:27], v[156:159], v[36:39], v[24:27]
  v_mfma_f32_16x16x32_bf16 v[28:31], v[212:215], v[36:39], v[28:31]
  ds_read_b128 v[36:39], v91 offset:21504
  s_waitcnt lgkmcnt(3)
  v_mfma_f32_16x16x32_bf16 v[4:7], a[16:19], v[40:43], v[4:7]
  v_mfma_f32_16x16x32_bf16 v[8:11], a[72:75], v[40:43], v[8:11]
  v_mfma_f32_16x16x32_bf16 v[12:15], a[128:131], v[40:43], v[12:15]
  v_mfma_f32_16x16x32_bf16 v[16:19], a[184:187], v[40:43], v[16:19]
  v_mfma_f32_16x16x32_bf16 v[20:23], a[240:243], v[40:43], v[20:23]
  v_mfma_f32_16x16x32_bf16 v[24:27], v[160:163], v[40:43], v[24:27]
  v_mfma_f32_16x16x32_bf16 v[28:31], v[216:219], v[40:43], v[28:31]
  ds_read_b128 v[40:43], v91 offset:22528
  s_waitcnt lgkmcnt(3)
  v_mfma_f32_16x16x32_bf16 v[4:7], a[20:23], v[44:47], v[4:7]
  v_mfma_f32_16x16x32_bf16 v[8:11], a[76:79], v[44:47], v[8:11]
  v_mfma_f32_16x16x32_bf16 v[12:15], a[132:135], v[44:47], v[12:15]
  v_mfma_f32_16x16x32_bf16 v[16:19], a[188:191], v[44:47], v[16:19]
  v_mfma_f32_16x16x32_bf16 v[20:23], a[244:247], v[44:47], v[20:23]
  v_mfma_f32_16x16x32_bf16 v[24:27], v[164:167], v[44:47], v[24:27]
  v_mfma_f32_16x16x32_bf16 v[28:31], v[220:223], v[44:47], v[28:31]
  ds_read_b128 v[44:47], v91 offset:23552
  s_waitcnt lgkmcnt(3)
  v_mfma_f32_16x16x32_bf16 v[4:7], a[24:27], v[32:35], v[4:7]
  v_mfma_f32_16x16x32_bf16 v[8:11], a[80:83], v[32:35], v[8:11]
  v_mfma_f32_16x16x32_bf16 v[12:15], a[136:139], v[32:35], v[12:15]
  v_mfma_f32_16x16x32_bf16 v[16:19], a[192:195], v[32:35], v[16:19]
  v_mfma_f32_16x16x32_bf16 v[20:23], a[248:251], v[32:35], v[20:23]
  v_mfma_f32_16x16x32_bf16 v[24:27], v[168:171], v[32:35], v[24:27]
  v_mfma_f32_16x16x32_bf16 v[28:31], v[224:227], v[32:35], v[28:31]
  ds_read_b128 v[32:35], v91 offset:24576
  s_waitcnt lgkmcnt(3)
  v_mfma_f32_16x16x32_bf16 v[4:7], a[28:31], v[36:39], v[4:7]
  v_mfma_f32_16x16x32_bf16 v[8:11], a[84:87], v[36:39], v[8:11]
  v_mfma_f32_16x16x32_bf16 v[12:15], a[140:143], v[36:39], v[12:15]
  v_mfma_f32_16x16x32_bf16 v[16:19], a[196:199], v[36:39], v[16:19]
  v_mfma_f32_16x16x32_bf16 v[20:23], a[252:255], v[36:39], v[20:23]
  v_mfma_f32_16x16x32_bf16 v[24:27], v[172:175], v[36:39], v[24:27]
  v_mfma_f32_16x16x32_bf16 v[28:31], v[228:231], v[36:39], v[28:31]
  ds_read_b128 v[36:39], v91 offset:25600
  s_waitcnt lgkmcnt(3)
  v_mfma_f32_16x16x32_bf16 v[4:7], a[32:35], v[40:43], v[4:7]
  v_mfma_f32_16x16x32_bf16 v[8:11], a[88:91], v[40:43], v[8:11]
  v_mfma_f32_16x16x32_bf16 v[12:15], a[144:147], v[40:43], v[12:15]
  v_mfma_f32_16x16x32_bf16 v[16:19], a[200:203], v[40:43], v[16:19]
  v_mfma_f32_16x16x32_bf16 v[20:23], v[120:123], v[40:43], v[20:23]
  v_mfma_f32_16x16x32_bf16 v[24:27], v[176:179], v[40:43], v[24:27]
  v_mfma_f32_16x16x32_bf16 v[28:31], v[232:235], v[40:43], v[28:31]
  ds_read_b128 v[40:43], v91 offset:26624
  s_waitcnt lgkmcnt(3)
  v_mfma_f32_16x16x32_bf16 v[4:7], a[36:39], v[44:47], v[4:7]
  v_mfma_f32_16x16x32_bf16 v[8:11], a[92:95], v[44:47], v[8:11]
  v_mfma_f32_16x16x32_bf16 v[12:15], a[148:151], v[44:47], v[12:15]
  v_mfma_f32_16x16x32_bf16 v[16:19], a[204:207], v[44:47], v[16:19]
  v_mfma_f32_16x16x32_bf16 v[20:23], v[124:127], v[44:47], v[20:23]
  v_mfma_f32_16x16x32_bf16 v[24:27], v[180:183], v[44:47], v[24:27]
  v_mfma_f32_16x16x32_bf16 v[28:31], v[236:239], v[44:47], v[28:31]
  ds_read_b128 v[44:47], v91 offset:27648
  s_waitcnt lgkmcnt(3)
  v_mfma_f32_16x16x32_bf16 v[4:7], a[40:43], v[32:35], v[4:7]
  v_mfma_f32_16x16x32_bf16 v[8:11], a[96:99], v[32:35], v[8:11]
  v_mfma_f32_16x16x32_bf16 v[12:15], a[152:155], v[32:35], v[12:15]
  v_mfma_f32_16x16x32_bf16 v[16:19], a[208:211], v[32:35], v[16:19]
  v_mfma_f32_16x16x32_bf16 v[20:23], v[128:131], v[32:35], v[20:23]
  v_mfma_f32_16x16x32_bf16 v[24:27], v[184:187], v[32:35], v[24:27]
  v_mfma_f32_16x16x32_bf16 v[28:31], v[240:243], v[32:35], v[28:31]
  s_waitcnt lgkmcnt(2)
  v_mfma_f32_16x16x32_bf16 v[4:7], a[44:47], v[36:39], v[4:7]
  v_mfma_f32_16x16x32_bf16 v[8:11], a[100:103], v[36:39], v[8:11]
  v_mfma_f32_16x16x32_bf16 v[12:15], a[156:159], v[36:39], v[12:15]
  v_mfma_f32_16x16x32_bf16 v[16:19], a[212:215], v[36:39], v[16:19]
  v_mfma_f32_16x16x32_bf16 v[20:23], v[132:135], v[36:39], v[20:23]
  v_mfma_f32_16x16x32_bf16 v[24:27], v[188:191], v[36:39], v[24:27]
  v_mfma_f32_16x16x32_bf16 v[28:31], v[244:247], v[36:39], v[28:31]
  s_waitcnt lgkmcnt(1)
  v_mfma_f32_16x16x32_bf16 v[4:7], a[48:51], v[40:43], v[4:7]
  v_mfma_f32_16x16x32_bf16 v[8:11], a[104:107], v[40:43], v[8:11]
  v_mfma_f32_16x16x32_bf16 v[12:15], a[160:163], v[40:43], v[12:15]
  v_mfma_f32_16x16x32_bf16 v[16:19], a[216:219], v[40:43], v[16:19]
  v_mfma_f32_16x16x32_bf16 v[20:23], v[136:139], v[40:43], v[20:23]
  v_mfma_f32_16x16x32_bf16 v[24:27], v[192:195], v[40:43], v[24:27]
  v_mfma_f32_16x16x32_bf16 v[28:31], v[248:251], v[40:43], v[28:31]
  s_waitcnt lgkmcnt(0)
  v_mfma_f32_16x16x32_bf16 v[4:7], a[52:55], v[44:47], v[4:7]
  v_mfma_f32_16x16x32_bf16 v[8:11], a[108:111], v[44:47], v[8:11]
  v_mfma_f32_16x16x32_bf16 v[12:15], a[164:167], v[44:47], v[12:15]
  v_mfma_f32_16x16x32_bf16 v[16:19], a[220:223], v[44:47], v[16:19]
  v_mfma_f32_16x16x32_bf16 v[20:23], v[140:143], v[44:47], v[20:23]
  v_mfma_f32_16x16x32_bf16 v[24:27], v[196:199], v[44:47], v[24:27]
  v_mfma_f32_16x16x32_bf16 v[28:31], v[252:255], v[44:47], v[28:31]
  s_nop 1
  v_cvt_pk_bf16_f32 v64, v4, v5
  v_cvt_pk_bf16_f32 v65, v6, v7
  v_cvt_pk_bf16_f32 v66, v8, v9
  v_cvt_pk_bf16_f32 v67, v10, v11
  v_cvt_pk_bf16_f32 v68, v12, v13
  v_cvt_pk_bf16_f32 v69, v14, v15
  v_cvt_pk_bf16_f32 v70, v16, v17
  v_cvt_pk_bf16_f32 v71, v18, v19
  v_cvt_pk_bf16_f32 v72, v20, v21
  v_cvt_pk_bf16_f32 v73, v22, v23
  v_cvt_pk_bf16_f32 v74, v24, v25
  v_cvt_pk_bf16_f32 v75, v26, v27
  v_cvt_pk_bf16_f32 v103, v28, v29
  v_cvt_pk_bf16_f32 v104, v30, v31
  v_cndmask_b32 v76, v103, v88, s[72:73]
  v_cndmask_b32 v78, v88, v103, s[72:73]
  v_cndmask_b32 v77, v104, v88, s[72:73]
  v_cndmask_b32 v79, v88, v104, s[72:73]
  ds_read_b128 v[32:35], v92 offset:0
  ds_read_b128 v[36:39], v93 offset:0
  ds_read_b128 v[40:43], v92 offset:1024
  ds_read_b128 v[44:47], v93 offset:1024
  s_waitcnt lgkmcnt(2)
  v_mfma_f32_16x16x32_bf16 v[4:7], v[32:35], v[48:51], 0
  v_mfma_f32_16x16x32_bf16 v[8:11], v[36:39], v[48:51], 0
  v_mfma_f32_16x16x32_bf16 v[12:15], v[32:35], v[64:67], 0
  v_mfma_f32_16x16x32_bf16 v[16:19], v[36:39], v[64:67], 0
  s_waitcnt lgkmcnt(0)
  v_mfma_f32_16x16x32_bf16 v[4:7], v[40:43], v[52:55], v[4:7]
  v_mfma_f32_16x16x32_bf16 v[8:11], v[44:47], v[52:55], v[8:11]
  v_mfma_f32_16x16x32_bf16 v[12:15], v[40:43], v[68:71], v[12:15]
  v_mfma_f32_16x16x32_bf16 v[16:19], v[44:47], v[68:71], v[16:19]
  ds_read_b128 v[32:35], v92 offset:2048
  ds_read_b128 v[36:39], v93 offset:2048
  ds_read_b128 v[40:43], v94 offset:0
  ds_read_b128 v[44:47], v95 offset:0
  s_waitcnt lgkmcnt(2)
  v_mfma_f32_16x16x32_bf16 v[4:7], v[32:35], v[56:59], v[4:7]
  v_mfma_f32_16x16x32_bf16 v[8:11], v[36:39], v[56:59], v[8:11]
  v_mfma_f32_16x16x32_bf16 v[12:15], v[32:35], v[72:75], v[12:15]
  v_mfma_f32_16x16x32_bf16 v[16:19], v[36:39], v[72:75], v[16:19]
  s_waitcnt lgkmcnt(0)
  v_mfma_f32_16x16x32_bf16 v[4:7], v[40:43], v[60:63], v[4:7]
  v_mfma_f32_16x16x32_bf16 v[8:11], v[44:47], v[60:63], v[8:11]
  v_mfma_f32_16x16x32_bf16 v[12:15], v[40:43], v[76:79], v[12:15]
  v_mfma_f32_16x16x32_bf16 v[16:19], v[44:47], v[76:79], v[16:19]
  v_xor_b32 v91, 0x18000, v91
  v_xor_b32 v92, 0x18000, v92
  v_xor_b32 v93, 0x18000, v93
  v_xor_b32 v94, 0x18000, v94
  v_xor_b32 v95, 0x18000, v95
  ds_write_b128 v99, v[4:7] offset:8192
  ds_write_b128 v99, v[8:11] offset:16384
  ds_write_b128 v99, v[12:15] offset:12288
  ds_write_b128 v99, v[16:19] offset:20480
L_x1_poll_169:
  buffer_load_dwordx4 v[80:83], v89, s[8:11], s47 offen sc1
  buffer_load_dwordx4 v[84:87], v90, s[8:11], s47 offen sc1
  s_add_u32 s6, s6, 1
  s_cmp_gt_u32 s6, 262144
  s_cbranch_scc1 L_timeout
  s_waitcnt vmcnt(0)
  ds_write_b128 v89, v[80:83]
  ds_write_b128 v90, v[84:87]
  v_max3_u32 v103, v80, v81, v82
  v_max3_u32 v104, v83, v84, v85
  v_max3_u32 v103, v103, v86, v87
  v_max_u32 v103, v103, v104
  v_cmp_eq_u32 vcc, -1, v103
  s_cbranch_vccz L_x1_ok_170
  s_sleep 2
  s_branch L_x1_poll_169
L_x1_ok_170:
  s_waitcnt lgkmcnt(0)
  s_barrier
  ds_read2_b32 v[32:33], v96 offset0:0 offset1:32
  ds_read2_b32 v[34:35], v96 offset0:1 offset1:33
  ds_read2_b32 v[36:37], v96 offset0:128 offset1:160
  ds_read2_b32 v[38:39], v96 offset0:129 offset1:161
  ds_read2_b32 v[40:41], v97 offset0:0 offset1:32
  ds_read2_b32 v[42:43], v97 offset0:1 offset1:33
  ds_read2_b32 v[44:45], v98 offset0:0 offset1:32
  ds_read2_b32 v[46:47], v98 offset0:1 offset1:33
  s_waitcnt lgkmcnt(6)
  v_mfma_f32_16x16x32_bf16 v[4:7], v[32:35], v[48:51], 0
  v_mfma_f32_16x16x32_bf16 v[8:11], v[32:35], v[64:67], 0
  s_waitcnt lgkmcnt(4)
  v_mfma_f32_16x16x32_bf16 v[4:7], v[36:39], v[52:55], v[4:7]
  v_mfma_f32_16x16x32_bf16 v[8:11], v[36:39], v[68:71], v[8:11]
  s_waitcnt lgkmcnt(2)
  v_mfma_f32_16x16x32_bf16 v[4:7], v[40:43], v[56:59], v[4:7]
  v_mfma_f32_16x16x32_bf16 v[8:11], v[40:43], v[72:75], v[8:11]
  s_waitcnt lgkmcnt(0)
  v_mfma_f32_16x16x32_bf16 v[4:7], v[44:47], v[60:63], v[4:7]
  v_mfma_f32_16x16x32_bf16 v[8:11], v[44:47], v[76:79], v[8:11]
  s_nop 6
  ds_write_b128 v99, v[4:7] offset:24576
  ds_write_b128 v99, v[8:11] offset:28672
  s_cmp_ge_u32 s3, 2
  s_waitcnt lgkmcnt(0)
  s_barrier
  s_cbranch_scc1 L_x1_next_168
  ds_read_b128 v[48:51], v100 offset:24576
  ds_read_b128 v[52:55], v100 offset:25600
  ds_read_b128 v[56:59], v100 offset:26624
  ds_read_b128 v[60:63], v100 offset:27648
  ds_read_b128 v[64:67], v100 offset:8192
  ds_read_b128 v[68:71], v100 offset:9216
  ds_read_b128 v[72:75], v100 offset:10240
  ds_read_b128 v[76:79], v100 offset:11264
  ds_read_b128 v[32:35], v100 offset:16384
  ds_read_b128 v[36:39], v100 offset:17408
  ds_read_b128 v[40:43], v100 offset:18432
  ds_read_b128 v[44:47], v100 offset:19456
  s_waitcnt lgkmcnt(8)
  v_pk_add_f32 v[48:49], v[48:49], v[52:53]
  v_pk_add_f32 v[56:57], v[56:57], v[60:61]
  v_pk_add_f32 v[50:51], v[50:51], v[54:55]
  v_pk_add_f32 v[58:59], v[58:59], v[62:63]
  v_pk_add_f32 v[12:13], v[48:49], v[56:57]
  v_pk_add_f32 v[14:15], v[50:51], v[58:59]
  s_waitcnt lgkmcnt(4)
  v_pk_add_f32 v[64:65], v[64:65], v[68:69]
  v_pk_add_f32 v[72:73], v[72:73], v[76:77]
  v_pk_add_f32 v[66:67], v[66:67], v[70:71]
  v_pk_add_f32 v[74:75], v[74:75], v[78:79]
  v_pk_add_f32 v[4:5], v[64:65], v[72:73]
  v_pk_add_f32 v[6:7], v[66:67], v[74:75]
  s_waitcnt lgkmcnt(0)
  v_pk_add_f32 v[32:33], v[32:33], v[36:37]
  v_pk_add_f32 v[40:41], v[40:41], v[44:45]
  v_pk_add_f32 v[34:35], v[34:35], v[38:39]
  v_pk_add_f32 v[42:43], v[42:43], v[46:47]
  v_pk_add_f32 v[8:9], v[32:33], v[40:41]
  v_pk_add_f32 v[10:11], v[34:35], v[42:43]
  v_cndmask_b32 v4, v102, v4, s[56:57]
  v_cndmask_b32 v5, v102, v5, s[58:59]
  v_cndmask_b32 v6, v102, v6, s[60:61]
  v_cndmask_b32 v7, v102, v7, s[62:63]
  v_cndmask_b32 v8, v102, v8, s[64:65]
  v_cndmask_b32 v9, v102, v9, s[66:67]
  v_cndmask_b32 v10, v102, v10, s[68:69]
  v_cndmask_b32 v11, v102, v11, s[70:71]
  v_max3_f32 v103, v4, v5, v6
  v_max3_f32 v103, v103, v7, v8
  v_max3_f32 v103, v103, v9, v10
  v_max3_f32 v103, v103, v11, v12
  v_max3_f32 v103, v103, v13, v14
  v_max_f32 v103, v103, v15
  v_mov_b32 v105, v103
  s_nop 1
  v_permlane16_swap_b32 v103, v105
  v_max_f32 v103, v103, v105
  v_mov_b32 v105, v103
  s_nop 1
  v_permlane32_swap_b32 v103, v105
  v_max_f32 v103, v103, v105
  v_sub_f32 v4, v4, v103
  v_sub_f32 v5, v5, v103
  v_sub_f32 v6, v6, v103
  v_sub_f32 v7, v7, v103
  v_sub_f32 v8, v8, v103
  v_sub_f32 v9, v9, v103
  v_sub_f32 v10, v10, v103
  v_sub_f32 v11, v11, v103
  v_sub_f32 v12, v12, v103
  v_sub_f32 v13, v13, v103
  v_sub_f32 v14, v14, v103
  v_sub_f32 v15, v15, v103
  v_exp_f32 v4, v4
  v_exp_f32 v5, v5
  v_exp_f32 v6, v6
  v_exp_f32 v7, v7
  v_exp_f32 v8, v8
  v_exp_f32 v9, v9
  v_exp_f32 v10, v10
  v_exp_f32 v11, v11
  v_exp_f32 v12, v12
  v_exp_f32 v13, v13
  v_exp_f32 v14, v14
  v_exp_f32 v15, v15
  v_add_f32 v104, v12, v13
  v_add_f32 v105, v14, v15
  v_add_f32 v104, v104, v105
  v_mul_f32 v104, 0.5, v104
  v_add_f32 v104, v104, v4
  v_add_f32 v104, v104, v5
  v_add_f32 v104, v104, v6
  v_add_f32 v104, v104, v7
  v_add_f32 v104, v104, v8
  v_add_f32 v104, v104, v9
  v_add_f32 v104, v104, v10
  v_add_f32 v104, v104, v11
  v_mov_b32 v105, v104
  s_nop 1
  v_permlane16_swap_b32 v104, v105
  v_add_f32 v104, v104, v105
  v_mov_b32 v105, v104
  s_nop 1
  v_permlane32_swap_b32 v104, v105
  v_add_f32 v104, v104, v105
  v_rcp_f32 v104, v104
  s_nop 0
  v_mul_f32 v4, v4, v104
  v_mul_f32 v5, v5, v104
  v_mul_f32 v6, v6, v104
  v_mul_f32 v7, v7, v104
  v_mul_f32 v8, v8, v104
  v_mul_f32 v9, v9, v104
  v_mul_f32 v10, v10, v104
  v_mul_f32 v11, v11, v104
  v_mul_f32 v12, v12, v104
  v_mul_f32 v13, v13, v104
  v_mul_f32 v14, v14, v104
  v_mul_f32 v15, v15, v104
  v_cvt_pk_bf16_f32 v80, v4, v5
  v_cvt_pk_bf16_f32 v81, v6, v7
  v_cvt_pk_bf16_f32 v82, v8, v9
  v_cvt_pk_bf16_f32 v83, v10, v11
  v_cvt_pk_bf16_f32 v84, v12, v13
  v_cvt_pk_bf16_f32 v85, v14, v15
  v_min_u32 v80, -2, v80
  v_min_u32 v81, -2, v81
  v_min_u32 v82, -2, v82
  v_min_u32 v83, -2, v83
  v_min_u32 v84, -2, v84
  v_min_u32 v85, -2, v85
  buffer_store_dwordx4 v[80:83], v3, s[8:11], s48 offen sc1
  buffer_store_dwordx2 v[84:85], v101, s[8:11], s48 offen offset:1024 sc1
  s_cmp_ge_u32 s44, 61
  s_cbranch_scc1 L_nd_171
  s_waitcnt vmcnt(0)
L_nd_171:
  v_mov_b32 v103, s98
  v_lshrrev_b32 v104, 2, v3
  v_and_b32 v104, 124, v104
  buffer_store_dword v103, v104, s[8:11], s49 offen sc1
L_x1_next_168:
  s_add_u32 s44, s44, 3
  s_add_u32 s47, s47, 24576
  s_add_u32 s48, s48, 147456
  s_add_u32 s49, s49, 86016
  s_cmp_lt_u32 s44, 64
  s_cbranch_scc1 L_x1_top_166
  s_endpgm
L_x2:
  s_load_dwordx2 s[40:41], s[0:1], 0
  s_cmp_eq_u32 s31, 63
  s_cselect_b32 s54, 0, 1
  s_mov_b32 s44, s31
  s_mov_b32 s53, 0xffff0000
  s_and_b32 s36, s3, 1
  v_lshlrev_b32 v160, 7, v1
  v_lshlrev_b32 v163, 3, v0
  v_and_b32 v4, 31, v0
  v_lshlrev_b32 v4, 7, v4
  v_add_u32 v4, 4096, v4
  v_add_u32 v5, 2048, v160
  v_cmp_gt_u32 vcc, 32, v0
  s_nop 1
  v_cndmask_b32 v161, v5, v4, vcc
  v_add_u32 v4, 57344, v160
  v_cmp_gt_u32 vcc, 48, v0
  s_nop 1
  v_cndmask_b32 v170, v4, v161, vcc
  s_lshl_b32 s33, s3, 12
  v_add_u32 v164, s33, v3
  s_lshl_b32 s33, s36, 11
  v_add_u32 v165, s33, v3
  v_mul_u32_u24 v4, 896, v1
  v_lshl_add_u32 v166, v2, 4, v4
  v_lshlrev_b32 v4, 3, v1
  v_mov_b32 v5, 1073741824
  v_cmp_gt_u32 vcc, 16, v0
  s_nop 1
  v_cndmask_b32 v167, v5, v4, vcc
  s_lshl_b32 s33, s31, 4
  s_lshl_b32 s34, s3, 2
  s_add_u32 s33, s33, s34
  s_mul_i32 s45, s33, 28672
  s_lshl_b32 s34, s30, 11
  s_add_u32 s45, s45, s34
  s_add_u32 s45, s45, 16515072
  s_mul_i32 s46, s33, 3072
  s_add_u32 s46, s46, 63307776
  s_mul_i32 s47, s33, 14336
  s_lshl_b32 s34, s30, 10
  s_add_u32 s47, s47, s34
  s_add_u32 s47, s47, 48627712
  s_mul_i32 s48, s31, 28672
  s_add_u32 s48, s48, 75857920
  s_lshl_b32 s33, s31, 1
  s_add_u32 s33, s33, s36
  s_mul_i32 s49, s33, 14336
  s_lshl_b32 s34, s30, 6
  s_add_u32 s49, s49, s34
  s_mul_i32 s33, s33, 14
  s_add_u32 s33, s33, s30
  s_lshl_b32 s50, s33, 10
  s_add_u32 s50, s50, 66453504
  s_lshl_b32 s51, s33, 7
  s_add_u32 s51, s51, 68288512
  s_lshl_b32 s33, s30, 1
  s_add_u32 s33, s33, s36
  s_lshl_b32 s33, s33, 7
  s_add_u32 s52, s48, s33
  s_add_u32 s52, s52, 8192
  s_waitcnt lgkmcnt(0)
  s_mov_b32 s16, s40
  s_and_b32 s17, s41, 0xffff
  s_mov_b32 s18, 1835008
  s_mov_b32 s19, 0x20000
L_wf_174:
  buffer_load_dwordx2 v[208:209], v160, s[8:11], s48 offen sc1
  s_add_u32 s6, s6, 1
  s_cmp_gt_u32 s6, 262144
  s_cbranch_scc1 L_timeout
  s_waitcnt vmcnt(0)
  v_cmp_ne_u32 vcc, s98, v208
  v_cmp_ne_u32 s[36:37], s98, v209
  s_or_b64 vcc, vcc, s[36:37]
  s_cbranch_vccz L_wfok_175
  s_sleep 2
  s_branch L_wf_174
L_wfok_175:
  s_add_u32 s33, s45, 0
  buffer_load_dwordx4 v[172:175], v3, s[8:11], s33 offen offset:0 sc1
  buffer_load_dwordx4 v[176:179], v3, s[8:11], s33 offen offset:1024 sc1
  s_add_u32 s33, s45, 28672
  buffer_load_dwordx4 v[180:183], v3, s[8:11], s33 offen offset:0 sc1
  buffer_load_dwordx4 v[184:187], v3, s[8:11], s33 offen offset:1024 sc1
  s_add_u32 s33, s45, 57344
  buffer_load_dwordx4 v[188:191], v3, s[8:11], s33 offen offset:0 sc1
  buffer_load_dwordx4 v[192:195], v3, s[8:11], s33 offen offset:1024 sc1
  s_add_u32 s33, s45, 86016
  buffer_load_dwordx4 v[196:199], v3, s[8:11], s33 offen offset:0 sc1
  buffer_load_dwordx4 v[200:203], v3, s[8:11], s33 offen offset:1024 sc1
  buffer_load_dwordx4 v[204:207], v166, s[16:19], s49 offen nt
  s_waitcnt vmcnt(0)
L_x2_top_172:
  s_cmp_lt_u32 s44, 62
  s_cselect_b64 vcc, -1, 0
  v_cndmask_b32 v171, v161, v170, vcc
  s_cselect_b32 s33, 917504, 0
  s_cselect_b32 s34, 57344, 0
  s_add_u32 s45, s45, s33
  s_add_u32 s49, s49, s34
  v_mov_b64 v[4:5], v[172:173]
  v_mov_b64 v[6:7], v[174:175]
  v_mov_b64 v[8:9], v[176:177]
  v_mov_b64 v[10:11], v[178:179]
  v_mov_b64 v[12:13], v[180:181]
  v_mov_b64 v[14:15], v[182:183]
  v_mov_b64 v[16:17], v[184:185]
  v_mov_b64 v[18:19], v[186:187]
  v_mov_b64 v[20:21], v[188:189]
  v_mov_b64 v[22:23], v[190:191]
  v_mov_b64 v[24:25], v[192:193]
  v_mov_b64 v[26:27], v[194:195]
  v_mov_b64 v[28:29], v[196:197]
  v_mov_b64 v[30:31], v[198:199]
  v_mov_b64 v[32:33], v[200:201]
  v_mov_b64 v[34:35], v[202:203]
  v_mov_b64 v[116:117], v[204:205]
  v_mov_b64 v[118:119], v[206:207]
  s_cmp_ge_u32 s44, 62
  s_cbranch_scc0 L_wi_norm_178
  s_cmp_eq_u32 s44, 63
  s_cbranch_scc0 L_wi_gate_179
  s_cmp_eq_u32 s31, 63
  s_cbranch_scc0 L_wi_go_176
L_wi_gate_179:
  s_lshl_b32 s33, s44, 13
  s_add_u32 s33, s33, 45875200
  v_mov_b32 v209, 0
L_wi_xm_177:
  buffer_load_dword v208, v209, s[8:11], s33 offen sc1
  s_add_u32 s6, s6, 1
  s_cmp_gt_u32 s6, 262144
  s_cbranch_scc1 L_timeout
  s_waitcnt vmcnt(0)
  v_cmp_eq_u32 vcc, -1, v208
  s_cbranch_vccz L_wi_go_176
  s_sleep 2
  s_branch L_wi_xm_177
L_wi_norm_178:
L_wf_180:
  buffer_load_dwordx2 v[208:209], v171, s[8:11], s48 offen sc1
  s_add_u32 s6, s6, 1
  s_cmp_gt_u32 s6, 262144
  s_cbranch_scc1 L_timeout
  s_waitcnt vmcnt(0)
  v_cmp_ne_u32 vcc, s98, v208
  v_cmp_ne_u32 s[36:37], s98, v209
  s_or_b64 vcc, vcc, s[36:37]
  s_cbranch_vccz L_wfok_181
  s_sleep 2
  s_branch L_wf_180
L_wfok_181:
L_wi_go_176:
  s_barrier
  s_cmp_eq_u32 s44, 63
  s_cbranch_scc1 L_x2_last_183
L_x2_again_182:
  s_add_u32 s33, s46, 0
  s_add_u32 s34, s47, 0
  buffer_load_dwordx4 v[36:39], v3, s[8:11], s33 offen offset:0 sc1
  buffer_load_dwordx4 v[40:43], v3, s[8:11], s33 offen offset:1536 sc1
  buffer_load_dwordx2 v[68:69], v163, s[8:11], s33 offen offset:1024 sc1
  buffer_load_dwordx2 v[72:73], v163, s[8:11], s33 offen offset:2560 sc1
  buffer_load_dwordx2 v[84:85], v163, s[8:11], s34 offen offset:0 sc1
  buffer_load_dwordx2 v[88:89], v163, s[8:11], s34 offen offset:512 sc1
  s_add_u32 s33, s46, 3072
  s_add_u32 s34, s47, 14336
  buffer_load_dwordx4 v[44:47], v3, s[8:11], s33 offen offset:0 sc1
  buffer_load_dwordx4 v[48:51], v3, s[8:11], s33 offen offset:1536 sc1
  buffer_load_dwordx2 v[70:71], v163, s[8:11], s33 offen offset:1024 sc1
  buffer_load_dwordx2 v[74:75], v163, s[8:11], s33 offen offset:2560 sc1
  buffer_load_dwordx2 v[86:87], v163, s[8:11], s34 offen offset:0 sc1
  buffer_load_dwordx2 v[90:91], v163, s[8:11], s34 offen offset:512 sc1
  s_add_u32 s33, s46, 6144
  s_add_u32 s34, s47, 28672
  buffer_load_dwordx4 v[52:55], v3, s[8:11], s33 offen offset:0 sc1
  buffer_load_dwordx4 v[56:59], v3, s[8:11], s33 offen offset:1536 sc1
  buffer_load_dwordx2 v[76:77], v163, s[8:11], s33 offen offset:1024 sc1
  buffer_load_dwordx2 v[80:81], v163, s[8:11], s33 offen offset:2560 sc1
  buffer_load_dwordx2 v[92:93], v163, s[8:11], s34 offen offset:0 sc1
  buffer_load_dwordx2 v[96:97], v163, s[8:11], s34 offen offset:512 sc1
  s_add_u32 s33, s46, 9216
  s_add_u32 s34, s47, 43008
  buffer_load_dwordx4 v[60:63], v3, s[8:11], s33 offen offset:0 sc1
  buffer_load_dwordx4 v[64:67], v3, s[8:11], s33 offen offset:1536 sc1
  buffer_load_dwordx2 v[78:79], v163, s[8:11], s33 offen offset:1024 sc1
  buffer_load_dwordx2 v[82:83], v163, s[8:11], s33 offen offset:2560 sc1
  buffer_load_dwordx2 v[94:95], v163, s[8:11], s34 offen offset:0 sc1
  buffer_load_dwordx2 v[98:99], v163, s[8:11], s34 offen offset:512 sc1
  s_add_u32 s33, s45, 0
  buffer_load_dwordx4 v[172:175], v3, s[8:11], s33 offen offset:0 sc1
  buffer_load_dwordx4 v[176:179], v3, s[8:11], s33 offen offset:1024 sc1
  s_add_u32 s33, s45, 28672
  buffer_load_dwordx4 v[180:183], v3, s[8:11], s33 offen offset:0 sc1
  buffer_load_dwordx4 v[184:187], v3, s[8:11], s33 offen offset:1024 sc1
  s_add_u32 s33, s45, 57344
  buffer_load_dwordx4 v[188:191], v3, s[8:11], s33 offen offset:0 sc1
  buffer_load_dwordx4 v[192:195], v3, s[8:11], s33 offen offset:1024 sc1
  s_add_u32 s33, s45, 86016
  buffer_load_dwordx4 v[196:199], v3, s[8:11], s33 offen offset:0 sc1
  buffer_load_dwordx4 v[200:203], v3, s[8:11], s33 offen offset:1024 sc1
  buffer_load_dwordx4 v[204:207], v166, s[16:19], s49 offen nt
  s_waitcnt vmcnt(31)
  v_mfma_f32_16x16x32_bf16 v[100:103], v[4:7], v[36:39], 0
  v_mfma_f32_16x16x32_bf16 v[104:107], v[8:11], v[36:39], 0
  v_mfma_f32_16x16x32_bf16 v[108:111], v[4:7], v[40:43], 0
  v_mfma_f32_16x16x32_bf16 v[112:115], v[8:11], v[40:43], 0
  s_waitcnt vmcnt(25)
  v_mfma_f32_16x16x32_bf16 v[100:103], v[12:15], v[44:47], v[100:103]
  v_mfma_f32_16x16x32_bf16 v[104:107], v[16:19], v[44:47], v[104:107]
  v_mfma_f32_16x16x32_bf16 v[108:111], v[12:15], v[48:51], v[108:111]
  v_mfma_f32_16x16x32_bf16 v[112:115], v[16:19], v[48:51], v[112:115]
  s_waitcnt vmcnt(21)
  v_mfma_f32_16x16x32_bf16 v[100:103], v[84:87], v[68:71], v[100:103]
  v_mfma_f32_16x16x32_bf16 v[104:107], v[88:91], v[68:71], v[104:107]
  v_mfma_f32_16x16x32_bf16 v[108:111], v[84:87], v[72:75], v[108:111]
  v_mfma_f32_16x16x32_bf16 v[112:115], v[88:91], v[72:75], v[112:115]
  s_waitcnt vmcnt(19)
  v_mfma_f32_16x16x32_bf16 v[100:103], v[20:23], v[52:55], v[100:103]
  v_mfma_f32_16x16x32_bf16 v[104:107], v[24:27], v[52:55], v[104:107]
  v_mfma_f32_16x16x32_bf16 v[108:111], v[20:23], v[56:59], v[108:111]
  v_mfma_f32_16x16x32_bf16 v[112:115], v[24:27], v[56:59], v[112:115]
  s_waitcnt vmcnt(13)
  v_mfma_f32_16x16x32_bf16 v[100:103], v[28:31], v[60:63], v[100:103]
  v_mfma_f32_16x16x32_bf16 v[104:107], v[32:35], v[60:63], v[104:107]
  v_mfma_f32_16x16x32_bf16 v[108:111], v[28:31], v[64:67], v[108:111]
  v_mfma_f32_16x16x32_bf16 v[112:115], v[32:35], v[64:67], v[112:115]
  s_waitcnt vmcnt(9)
  v_mfma_f32_16x16x32_bf16 v[100:103], v[92:95], v[76:79], v[100:103]
  v_mfma_f32_16x16x32_bf16 v[104:107], v[96:99], v[76:79], v[104:107]
  v_mfma_f32_16x16x32_bf16 v[108:111], v[92:95], v[80:83], v[108:111]
  v_mfma_f32_16x16x32_bf16 v[112:115], v[96:99], v[80:83], v[112:115]
  s_cmp_ge_u32 s44, 61
  s_cbranch_scc0 L_vl_186
  s_add_u32 s6, s6, 1
  s_cmp_gt_u32 s6, 262144
  s_cbranch_scc1 L_timeout
  s_waitcnt vmcnt(9)
  v_max3_u32 v168, v36, v37, v38
  v_max3_u32 v168, v168, v39, v40
  v_max3_u32 v168, v168, v41, v42
  v_max3_u32 v168, v168, v43, v44
  v_max3_u32 v168, v168, v45, v46
  v_max3_u32 v168, v168, v47, v48
  v_max3_u32 v168, v168, v49, v50
  v_max3_u32 v168, v168, v51, v52
  v_max3_u32 v168, v168, v53, v54
  v_max3_u32 v168, v168, v55, v56
  v_max3_u32 v168, v168, v57, v58
  v_max3_u32 v168, v168, v59, v60
  v_max3_u32 v168, v168, v61, v62
  v_max3_u32 v168, v168, v63, v64
  v_max3_u32 v168, v168, v65, v66
  v_max3_u32 v168, v168, v67, v68
  v_max3_u32 v168, v168, v69, v70
  v_max3_u32 v168, v168, v71, v72
  v_max3_u32 v168, v168, v73, v74
  v_max3_u32 v168, v168, v75, v76
  v_max3_u32 v168, v168, v77, v78
  v_max3_u32 v168, v168, v79, v80
  v_max3_u32 v168, v168, v81, v82
  v_max3_u32 v168, v168, v83, v84
  v_max3_u32 v168, v168, v85, v86
  v_max3_u32 v168, v168, v87, v88
  v_max3_u32 v168, v168, v89, v90
  v_max3_u32 v168, v168, v91, v92
  v_max3_u32 v168, v168, v93, v94
  v_max3_u32 v168, v168, v95, v96
  v_max3_u32 v168, v168, v97, v98
  v_max_u32 v168, v168, v99
  v_cmp_eq_u32 vcc, -1, v168
  s_cbranch_vccnz L_x2_again_182
L_vl_186:
  s_nop 2
  ds_write_b128 v164, v[100:103] offset:0
  ds_write_b128 v164, v[104:107] offset:1024
  ds_write_b128 v164, v[108:111] offset:2048
  ds_write_b128 v164, v[112:115] offset:3072
  s_cmp_ge_u32 s3, 2
L_x2_sums_184:
  s_waitcnt lgkmcnt(0)
  s_barrier
  s_cbranch_scc1 L_x2_other_185
  ds_read_b128 v[120:123], v165 offset:0
  ds_read_b128 v[124:127], v165 offset:4096
  ds_read_b128 v[128:131], v165 offset:8192
  ds_read_b128 v[132:135], v165 offset:12288
  ds_read_b128 v[136:139], v165 offset:1024
  ds_read_b128 v[140:143], v165 offset:5120
  ds_read_b128 v[144:147], v165 offset:9216
  ds_read_b128 v[148:151], v165 offset:13312
  s_waitcnt lgkmcnt(4)
  v_pk_add_f32 v[120:121], v[120:121], v[124:125]
  v_pk_add_f32 v[128:129], v[128:129], v[132:133]
  v_pk_add_f32 v[122:123], v[122:123], v[126:127]
  v_pk_add_f32 v[130:131], v[130:131], v[134:135]
  v_pk_add_f32 v[152:153], v[120:121], v[128:129]
  v_pk_add_f32 v[154:155], v[122:123], v[130:131]
  s_waitcnt lgkmcnt(0)
  v_pk_add_f32 v[136:137], v[136:137], v[140:141]
  v_pk_add_f32 v[144:145], v[144:145], v[148:149]
  v_pk_add_f32 v[138:139], v[138:139], v[142:143]
  v_pk_add_f32 v[146:147], v[146:147], v[150:151]
  v_pk_add_f32 v[156:157], v[136:137], v[144:145]
  v_pk_add_f32 v[158:159], v[138:139], v[146:147]
  v_cvt_pk_bf16_f32 v120, v152, v153
  v_cvt_pk_bf16_f32 v121, v154, v155
  v_cvt_pk_bf16_f32 v122, v156, v157
  v_cvt_pk_bf16_f32 v123, v158, v159
  v_lshlrev_b32 v152, 16, v120
  v_and_b32 v153, s53, v120
  v_lshlrev_b32 v154, 16, v121
  v_and_b32 v155, s53, v121
  v_lshlrev_b32 v156, 16, v122
  v_and_b32 v157, s53, v122
  v_lshlrev_b32 v158, 16, v123
  v_and_b32 v159, s53, v123
  v_lshlrev_b32 v128, 16, v116
  v_and_b32 v129, s53, v116
  v_lshlrev_b32 v130, 16, v117
  v_and_b32 v131, s53, v117
  v_lshlrev_b32 v132, 16, v118
  v_and_b32 v133, s53, v118
  v_lshlrev_b32 v134, 16, v119
  v_and_b32 v135, s53, v119
  v_add_f32 v152, v152, v128
  v_add_f32 v153, v153, v129
  v_add_f32 v154, v154, v130
  v_add_f32 v155, v155, v131
  v_add_f32 v156, v156, v132
  v_add_f32 v157, v157, v133
  v_add_f32 v158, v158, v134
  v_add_f32 v159, v159, v135
  v_cvt_pk_bf16_f32 v120, v152, v153
  v_cvt_pk_bf16_f32 v121, v154, v155
  v_cvt_pk_bf16_f32 v122, v156, v157
  v_cvt_pk_bf16_f32 v123, v158, v159
  v_min_u32 v120, -2, v120
  v_min_u32 v121, -2, v121
  v_min_u32 v122, -2, v122
  v_min_u32 v123, -2, v123
  buffer_store_dwordx4 v[120:123], v3, s[8:11], s50 offen sc1
  v_lshlrev_b32 v152, 16, v120
  v_and_b32 v153, s53, v120
  v_lshlrev_b32 v154, 16, v121
  v_and_b32 v155, s53, v121
  v_lshlrev_b32 v156, 16, v122
  v_and_b32 v157, s53, v122
  v_lshlrev_b32 v158, 16, v123
  v_and_b32 v159, s53, v123
  v_add_f32 v128, v152, v153
  v_add_f32 v128, v128, v154
  v_add_f32 v128, v128, v155
  v_add_f32 v128, v128, v156
  v_add_f32 v128, v128, v157
  v_add_f32 v128, v128, v158
  v_add_f32 v128, v128, v159
  v_mov_b32 v168, v128
  s_nop 1
  v_permlane16_swap_b32 v128, v168
  v_add_f32 v128, v128, v168
  v_mov_b32 v168, v128
  s_nop 1
  v_permlane32_swap_b32 v128, v168
  v_add_f32 v128, v128, v168
  v_mul_f32 v128, 0x3d000000, v128
  v_sub_f32 v152, v152, v128
  v_sub_f32 v153, v153, v128
  v_sub_f32 v154, v154, v128
  v_sub_f32 v155, v155, v128
  v_sub_f32 v156, v156, v128
  v_sub_f32 v157, v157, v128
  v_sub_f32 v158, v158, v128
  v_sub_f32 v159, v159, v128
  v_mul_f32 v129, v152, v152
  v_fmac_f32 v129, v153, v153
  v_fmac_f32 v129, v154, v154
  v_fmac_f32 v129, v155, v155
  v_fmac_f32 v129, v156, v156
  v_fmac_f32 v129, v157, v157
  v_fmac_f32 v129, v158, v158
  v_fmac_f32 v129, v159, v159
  v_mov_b32 v168, v129
  s_nop 1
  v_permlane16_swap_b32 v129, v168
  v_add_f32 v129, v129, v168
  v_mov_b32 v168, v129
  s_nop 1
  v_permlane32_swap_b32 v129, v168
  v_add_f32 v129, v129, v168
  v_min_u32 v128, -2, v128
  v_min_u32 v129, -2, v129
  buffer_store_dwordx2 v[128:129], v167, s[8:11], s51 offen sc1
  s_cmp_ge_u32 s44, 61
  s_cbranch_scc1 L_nd_187
  s_waitcnt vmcnt(0)
L_nd_187:
  v_mov_b32 v168, s98
  v_lshrrev_b32 v169, 2, v3
  v_and_b32 v169, 124, v169
  buffer_store_dword v168, v169, s[8:11], s52 offen sc1
  s_waitcnt vmcnt(3)
L_x2_next_173:
  s_add_u32 s44, s44, 2
  s_add_u32 s46, s46, 98304
  s_add_u32 s47, s47, 458752
  s_add_u32 s48, s48, 57344
  s_add_u32 s50, s50, 57344
  s_add_u32 s51, s51, 7168
  s_add_u32 s52, s52, 57344
  s_cmp_lt_u32 s44, 64
  s_cbranch_scc1 L_x2_top_172
  s_endpgm
L_x2_other_185:
  s_waitcnt vmcnt(0)
  s_branch L_x2_next_173
L_x2_last_183:
  s_mul_i32 s35, s54, 1536
  s_add_u32 s46, s46, s35
  s_lshl_b32 s35, s54, 11
  v_add_u32 v164, s35, v164
L_x2_rep_188:
  s_add_u32 s33, s46, 0
  s_add_u32 s34, s47, 0
  buffer_load_dwordx4 v[36:39], v3, s[8:11], s33 offen sc1
  buffer_load_dwordx2 v[68:69], v163, s[8:11], s33 offen offset:1024 sc1
  buffer_load_dwordx2 v[84:85], v163, s[8:11], s34 offen offset:0 sc1
  buffer_load_dwordx2 v[88:89], v163, s[8:11], s34 offen offset:512 sc1
  s_add_u32 s33, s46, 3072
  s_add_u32 s34, s47, 14336
  buffer_load_dwordx4 v[44:47], v3, s[8:11], s33 offen sc1
  buffer_load_dwordx2 v[70:71], v163, s[8:11], s33 offen offset:1024 sc1
  buffer_load_dwordx2 v[86:87], v163, s[8:11], s34 offen offset:0 sc1
  buffer_load_dwordx2 v[90:91], v163, s[8:11], s34 offen offset:512 sc1
  s_add_u32 s33, s46, 6144
  s_add_u32 s34, s47, 28672
  buffer_load_dwordx4 v[52:55], v3, s[8:11], s33 offen sc1
  buffer_load_dwordx2 v[76:77], v163, s[8:11], s33 offen offset:1024 sc1
  buffer_load_dwordx2 v[92:93], v163, s[8:11], s34 offen offset:0 sc1
  buffer_load_dwordx2 v[96:97], v163, s[8:11], s34 offen offset:512 sc1
  s_add_u32 s33, s46, 9216
  s_add_u32 s34, s47, 43008
  buffer_load_dwordx4 v[60:63], v3, s[8:11], s33 offen sc1
  buffer_load_dwordx2 v[78:79], v163, s[8:11], s33 offen offset:1024 sc1
  buffer_load_dwordx2 v[94:95], v163, s[8:11], s34 offen offset:0 sc1
  buffer_load_dwordx2 v[98:99], v163, s[8:11], s34 offen offset:512 sc1
  s_waitcnt vmcnt(15)
  v_mfma_f32_16x16x32_bf16 v[100:103], v[4:7], v[36:39], 0
  v_mfma_f32_16x16x32_bf16 v[104:107], v[8:11], v[36:39], 0
  s_waitcnt vmcnt(11)
  v_mfma_f32_16x16x32_bf16 v[100:103], v[12:15], v[44:47], v[100:103]
  v_mfma_f32_16x16x32_bf16 v[104:107], v[16:19], v[44:47], v[104:107]
  s_waitcnt vmcnt(8)
  v_mfma_f32_16x16x32_bf16 v[100:103], v[84:87], v[68:71], v[100:103]
  v_mfma_f32_16x16x32_bf16 v[104:107], v[88:91], v[68:71], v[104:107]
  s_waitcnt vmcnt(7)
  v_mfma_f32_16x16x32_bf16 v[100:103], v[20:23], v[52:55], v[100:103]
  v_mfma_f32_16x16x32_bf16 v[104:107], v[24:27], v[52:55], v[104:107]
  s_waitcnt vmcnt(3)
  v_mfma_f32_16x16x32_bf16 v[100:103], v[28:31], v[60:63], v[100:103]
  v_mfma_f32_16x16x32_bf16 v[104:107], v[32:35], v[60:63], v[104:107]
  s_waitcnt vmcnt(0)
  v_mfma_f32_16x16x32_bf16 v[100:103], v[92:95], v[76:79], v[100:103]
  v_mfma_f32_16x16x32_bf16 v[104:107], v[96:99], v[76:79], v[104:107]
  s_add_u32 s6, s6, 1
  s_cmp_gt_u32 s6, 262144
  s_cbranch_scc1 L_timeout
  v_max3_u32 v168, v36, v37, v38
  v_max3_u32 v168, v168, v39, v68
  v_max3_u32 v168, v168, v69, v44
  v_max3_u32 v168, v168, v45, v46
  v_max3_u32 v168, v168, v47, v70
  v_max3_u32 v168, v168, v71, v52
  v_max3_u32 v168, v168, v53, v54
  v_max3_u32 v168, v168, v55, v76
  v_max3_u32 v168, v168, v77, v60
  v_max3_u32 v168, v168, v61, v62
  v_max3_u32 v168, v168, v63, v78
  v_max3_u32 v168, v168, v79, v84
  v_max3_u32 v168, v168, v85, v86
  v_max3_u32 v168, v168, v87, v88
  v_max3_u32 v168, v168, v89, v90
  v_max3_u32 v168, v168, v91, v92
  v_max3_u32 v168, v168, v93, v94
  v_max3_u32 v168, v168, v95, v96
  v_max3_u32 v168, v168, v97, v98
  v_max_u32 v168, v168, v99
  v_cmp_eq_u32 vcc, -1, v168
  s_cbranch_vccnz L_x2_rep_188
  ds_write_b128 v164, v[100:103] offset:0
  ds_write_b128 v164, v[104:107] offset:1024
  s_cmp_lg_u32 s3, s54
  s_branch L_x2_sums_184
L_f1:
  s_cmp_eq_u32 s3, 0
  s_cbranch_scc0 L_afy_189
  v_lshlrev_b32 v4, 7, v1
  s_mov_b32 s34, 75857920
L_wf_190:
  buffer_load_dwordx2 v[6:7], v4, s[8:11], s34 offen sc1
  s_add_u32 s6, s6, 1
  s_cmp_gt_u32 s6, 262144
  s_cbranch_scc1 L_timeout
  s_waitcnt vmcnt(0)
  v_cmp_ne_u32 vcc, s98, v6
  v_cmp_ne_u32 s[36:37], s98, v7
  s_or_b64 vcc, vcc, s[36:37]
  s_cbranch_vccz L_wfok_191
  s_sleep 16
  s_branch L_wf_190
L_wfok_191:
L_afy_189:
  s_barrier
  s_load_dwordx2 s[40:41], s[0:1], 64
  s_load_dwordx2 s[42:43], s[0:1], 72
  s_lshr_b32 s34, s3, 1
  s_and_b32 s35, s3, 1
  s_lshl_b32 s51, s30, 1
  s_add_u32 s51, s51, s34
  v_lshrrev_b32 v4, 2, v0
  v_mov_b32 v6, 3584
  v_mul_lo_u32 v4, v4, v6
  v_and_b32 v5, 3, v0
  v_lshl_add_u32 v111, v5, 4, v4
  s_mul_i32 s36, s34, 28672
  v_lshrrev_b32 v4, 2, v1
  v_lshlrev_b32 v4, 6, v4
  v_and_b32 v5, 3, v0
  v_lshl_add_u32 v4, v5, 4, v4
  v_lshl_add_u32 v4, v2, 9, v4
  v_add_u32 v112, s36, v4
  s_mul_i32 s37, s35, 14336
  s_add_u32 s36, s36, s37
  s_mul_i32 s37, s35, 802816
  s_lshl_b32 s38, s51, 6
  s_add_u32 s37, s37, s38
  v_lshlrev_b32 v7, 4, v2
  s_mov_b32 s50, 0xffff0000
  s_waitcnt lgkmcnt(0)
  s_mov_b32 s16, s40
  s_and_b32 s17, s41, 0xffff
  s_mov_b32 s18, 1605632
  s_mov_b32 s19, 0x20000
  s_mov_b32 s20, s42
  s_and_b32 s21, s43, 0xffff
  s_mov_b32 s22, 3584
  s_mov_b32 s23, 0x20000
  s_mov_b32 m0, s36
  s_add_u32 s36, s36, 1024
  buffer_load_dwordx4 v111, s[16:19], s37 offen nt lds
  s_add_u32 s37, s37, 57344
  s_mov_b32 m0, s36
  s_add_u32 s36, s36, 1024
  buffer_load_dwordx4 v111, s[16:19], s37 offen nt lds
  s_add_u32 s37, s37, 57344
  s_mov_b32 m0, s36
  s_add_u32 s36, s36, 1024
  buffer_load_dwordx4 v111, s[16:19], s37 offen nt lds
  s_add_u32 s37, s37, 57344
  s_mov_b32 m0, s36
  s_add_u32 s36, s36, 1024
  buffer_load_dwordx4 v111, s[16:19], s37 offen nt lds
  s_add_u32 s37, s37, 57344
  s_mov_b32 m0, s36
  s_add_u32 s36, s36, 1024
  buffer_load_dwordx4 v111, s[16:19], s37 offen nt lds
  s_add_u32 s37, s37, 57344
  s_mov_b32 m0, s36
  s_add_u32 s36, s36, 1024
  buffer_load_dwordx4 v111, s[16:19], s37 offen nt lds
  s_add_u32 s37, s37, 57344
  s_mov_b32 m0, s36
  s_add_u32 s36, s36, 1024
  buffer_load_dwordx4 v111, s[16:19], s37 offen nt lds
  s_add_u32 s37, s37, 57344
  s_mov_b32 m0, s36
  s_add_u32 s36, s36, 1024
  buffer_load_dwordx4 v111, s[16:19], s37 offen nt lds
  s_add_u32 s37, s37, 57344
  s_mov_b32 m0, s36
  s_add_u32 s36, s36, 1024
  buffer_load_dwordx4 v111, s[16:19], s37 offen nt lds
  s_add_u32 s37, s37, 57344
  s_mov_b32 m0, s36
  s_add_u32 s36, s36, 1024
  buffer_load_dwordx4 v111, s[16:19], s37 offen nt lds
  s_add_u32 s37, s37, 57344
  s_mov_b32 m0, s36
  s_add_u32 s36, s36, 1024
  buffer_load_dwordx4 v111, s[16:19], s37 offen nt lds
  s_add_u32 s37, s37, 57344
  s_mov_b32 m0, s36
  s_add_u32 s36, s36, 1024
  buffer_load_dwordx4 v111, s[16:19], s37 offen nt lds
  s_add_u32 s37, s37, 57344
  s_mov_b32 m0, s36
  s_add_u32 s36, s36, 1024
  buffer_load_dwordx4 v111, s[16:19], s37 offen nt lds
  s_add_u32 s37, s37, 57344
  s_mov_b32 m0, s36
  s_add_u32 s36, s36, 1024
  buffer_load_dwordx4 v111, s[16:19], s37 offen nt lds
  s_add_u32 s37, s37, 57344
  buffer_load_dwordx4 v[100:103], v7, s[20:23], s38 offen
  s_mov_b32 s44, s31
  s_lshl_b32 s33, s31, 1
  s_add_u32 s33, s33, s35
  s_mul_i32 s45, s33, 14336
  s_add_u32 s45, s45, 66453504
  s_mul_i32 s46, s33, 1792
  s_add_u32 s46, s46, 68288512
  s_mul_i32 s34, s33, 56
  s_add_u32 s34, s34, s51
  s_lshl_b32 s47, s34, 10
  s_add_u32 s47, s47, 68517888
  s_mul_i32 s48, s31, 28672
  s_lshl_b32 s49, s35, 13
  s_lshl_b32 s34, s51, 7
  s_add_u32 s49, s49, s34
  s_add_u32 s49, s49, s48
  s_add_u32 s49, s49, 75870208
  s_add_u32 s48, s48, 75866112
  v_min_u32 v108, 13, v1
  v_lshlrev_b32 v108, 8, v108
  s_lshl_b32 s34, s35, 7
  v_add_u32 v108, s34, v108
  v_lshlrev_b32 v110, 7, v2
  v_lshl_add_u32 v110, v1, 3, v110
  v_add_u32 v4, 1536, v110
  v_mov_b32 v5, 1073741824
  v_cmp_gt_u32 vcc, 32, v0
  s_nop 1
  v_cndmask_b32 v118, v5, v4, vcc
  s_waitcnt vmcnt(0)
  s_barrier
  v_lshlrev_b32 v76, 16, v100
  v_and_b32 v77, s50, v100
  v_lshlrev_b32 v78, 16, v101
  v_and_b32 v79, s50, v101
  v_lshlrev_b32 v80, 16, v102
  v_and_b32 v81, s50, v102
  v_lshlrev_b32 v82, 16, v103
  v_and_b32 v83, s50, v103
  ds_read_b64_tr_b16 a[0:1], v112 offset:0
  ds_read_b64_tr_b16 a[2:3], v112 offset:256
  ds_read_b64_tr_b16 a[4:5], v112 offset:2048
  ds_read_b64_tr_b16 a[6:7], v112 offset:2304
  ds_read_b64_tr_b16 a[8:9], v112 offset:4096
  ds_read_b64_tr_b16 a[10:11], v112 offset:4352
  ds_read_b64_tr_b16 a[12:13], v112 offset:6144
  ds_read_b64_tr_b16 a[14:15], v112 offset:6400
  ds_read_b64_tr_b16 a[16:17], v112 offset:8192
  ds_read_b64_tr_b16 a[18:19], v112 offset:8448
  ds_read_b64_tr_b16 a[20:21], v112 offset:10240
  ds_read_b64_tr_b16 a[22:23], v112 offset:10496
  ds_read_b64_tr_b16 a[24:25], v112 offset:12288
  ds_read_b64_tr_b16 a[26:27], v112 offset:12544
  ds_read_b64_tr_b16 a[28:29], v112 offset:14336
  s_waitcnt lgkmcnt(14)
  ds_read_b64_tr_b16 a[30:31], v112 offset:14592
  s_waitcnt lgkmcnt(14)
  ds_read_b64_tr_b16 a[32:33], v112 offset:16384
  s_waitcnt lgkmcnt(14)
  ds_read_b64_tr_b16 a[34:35], v112 offset:16640
  s_waitcnt lgkmcnt(14)
  ds_read_b64_tr_b16 a[36:37], v112 offset:18432
  s_waitcnt lgkmcnt(14)
  ds_read_b64_tr_b16 a[38:39], v112 offset:18688
  s_waitcnt lgkmcnt(14)
  ds_read_b64_tr_b16 a[40:41], v112 offset:20480
  s_waitcnt lgkmcnt(14)
  ds_read_b64_tr_b16 a[42:43], v112 offset:20736
  s_waitcnt lgkmcnt(14)
  ds_read_b64_tr_b16 a[44:45], v112 offset:22528
  s_waitcnt lgkmcnt(14)
  ds_read_b64_tr_b16 a[46:47], v112 offset:22784
  s_waitcnt lgkmcnt(14)
  ds_read_b64_tr_b16 a[48:49], v112 offset:24576
  s_waitcnt lgkmcnt(14)
  ds_read_b64_tr_b16 a[50:51], v112 offset:24832
  s_waitcnt lgkmcnt(14)
  ds_read_b64_tr_b16 a[52:53], v112 offset:26624
  s_waitcnt lgkmcnt(14)
  ds_read_b64_tr_b16 a[54:55], v112 offset:26880
  s_waitcnt lgkmcnt(14)
  ds_read_b64_tr_b16 a[56:57], v112 offset:8
  s_waitcnt lgkmcnt(14)
  ds_read_b64_tr_b16 a[58:59], v112 offset:264
  s_waitcnt lgkmcnt(14)
  ds_read_b64_tr_b16 a[60:61], v112 offset:2056
  s_waitcnt lgkmcnt(14)
  ds_read_b64_tr_b16 a[62:63], v112 offset:2312
  s_waitcnt lgkmcnt(14)
  ds_read_b64_tr_b16 a[64:65], v112 offset:4104
  s_waitcnt lgkmcnt(14)
  ds_read_b64_tr_b16 a[66:67], v112 offset:4360
  s_waitcnt lgkmcnt(14)
  ds_read_b64_tr_b16 a[68:69], v112 offset:6152
  s_waitcnt lgkmcnt(14)
  ds_read_b64_tr_b16 a[70:71], v112 offset:6408
  s_waitcnt lgkmcnt(14)
  ds_read_b64_tr_b16 a[72:73], v112 offset:8200
  s_waitcnt lgkmcnt(14)
  ds_read_b64_tr_b16 a[74:75], v112 offset:8456
  s_waitcnt lgkmcnt(14)
  ds_read_b64_tr_b16 a[76:77], v112 offset:10248
  s_waitcnt lgkmcnt(14)
  ds_read_b64_tr_b16 a[78:79], v112 offset:10504
  s_waitcnt lgkmcnt(14)
  ds_read_b64_tr_b16 a[80:81], v112 offset:12296
  s_waitcnt lgkmcnt(14)
  ds_read_b64_tr_b16 a[82:83], v112 offset:12552
  s_waitcnt lgkmcnt(14)
  ds_read_b64_tr_b16 a[84:85], v112 offset:14344
  s_waitcnt lgkmcnt(14)
  ds_read_b64_tr_b16 a[86:87], v112 offset:14600
  s_waitcnt lgkmcnt(14)
  ds_read_b64_tr_b16 a[88:89], v112 offset:16392
  s_waitcnt lgkmcnt(14)
  ds_read_b64_tr_b16 a[90:91], v112 offset:16648
  s_waitcnt lgkmcnt(14)
  ds_read_b64_tr_b16 a[92:93], v112 offset:18440
  s_waitcnt lgkmcnt(14)
  ds_read_b64_tr_b16 a[94:95], v112 offset:18696
  s_waitcnt lgkmcnt(14)
  ds_read_b64_tr_b16 a[96:97], v112 offset:20488
  s_waitcnt lgkmcnt(14)
  ds_read_b64_tr_b16 a[98:99], v112 offset:20744
  s_waitcnt lgkmcnt(14)
  ds_read_b64_tr_b16 a[100:101], v112 offset:22536
  s_waitcnt lgkmcnt(14)
  ds_read_b64_tr_b16 a[102:103], v112 offset:22792
  s_waitcnt lgkmcnt(14)
  ds_read_b64_tr_b16 a[104:105], v112 offset:24584
  s_waitcnt lgkmcnt(14)
  ds_read_b64_tr_b16 a[106:107], v112 offset:24840
  s_waitcnt lgkmcnt(14)
  ds_read_b64_tr_b16 a[108:109], v112 offset:26632
  s_waitcnt lgkmcnt(14)
  ds_read_b64_tr_b16 a[110:111], v112 offset:26888
  v_mov_b32 v4, 0x3f803f80
  v_mov_b32 v5, 0x3f803f80
  v_mov_b32 v6, 0x3f803f80
  v_mov_b32 v7, 0x3f803f80
  s_waitcnt lgkmcnt(0)
  s_nop 0
  v_mfma_f32_16x16x32_bf16 v[68:71], a[0:3], v[4:7], 0
  v_mfma_f32_16x16x32_bf16 v[72:75], a[56:59], v[4:7], 0
  v_mfma_f32_16x16x32_bf16 v[68:71], a[4:7], v[4:7], v[68:71]
  v_mfma_f32_16x16x32_bf16 v[72:75], a[60:63], v[4:7], v[72:75]
  v_mfma_f32_16x16x32_bf16 v[68:71], a[8:11], v[4:7], v[68:71]
  v_mfma_f32_16x16x32_bf16 v[72:75], a[64:67], v[4:7], v[72:75]
  v_mfma_f32_16x16x32_bf16 v[68:71], a[12:15], v[4:7], v[68:71]
  v_mfma_f32_16x16x32_bf16 v[72:75], a[68:71], v[4:7], v[72:75]
  v_mfma_f32_16x16x32_bf16 v[68:71], a[16:19], v[4:7], v[68:71]
  v_mfma_f32_16x16x32_bf16 v[72:75], a[72:75], v[4:7], v[72:75]
  v_mfma_f32_16x16x32_bf16 v[68:71], a[20:23], v[4:7], v[68:71]
  v_mfma_f32_16x16x32_bf16 v[72:75], a[76:79], v[4:7], v[72:75]
  v_mfma_f32_16x16x32_bf16 v[68:71], a[24:27], v[4:7], v[68:71]
  v_mfma_f32_16x16x32_bf16 v[72:75], a[80:83], v[4:7], v[72:75]
  v_mfma_f32_16x16x32_bf16 v[68:71], a[28:31], v[4:7], v[68:71]
  v_mfma_f32_16x16x32_bf16 v[72:75], a[84:87], v[4:7], v[72:75]
  v_mfma_f32_16x16x32_bf16 v[68:71], a[32:35], v[4:7], v[68:71]
  v_mfma_f32_16x16x32_bf16 v[72:75], a[88:91], v[4:7], v[72:75]
  v_mfma_f32_16x16x32_bf16 v[68:71], a[36:39], v[4:7], v[68:71]
  v_mfma_f32_16x16x32_bf16 v[72:75], a[92:95], v[4:7], v[72:75]
  v_mfma_f32_16x16x32_bf16 v[68:71], a[40:43], v[4:7], v[68:71]
  v_mfma_f32_16x16x32_bf16 v[72:75], a[96:99], v[4:7], v[72:75]
  v_mfma_f32_16x16x32_bf16 v[68:71], a[44:47], v[4:7], v[68:71]
  v_mfma_f32_16x16x32_bf16 v[72:75], a[100:103], v[4:7], v[72:75]
  v_mfma_f32_16x16x32_bf16 v[68:71], a[48:51], v[4:7], v[68:71]
  v_mfma_f32_16x16x32_bf16 v[72:75], a[104:107], v[4:7], v[72:75]
  v_mfma_f32_16x16x32_bf16 v[68:71], a[52:55], v[4:7], v[68:71]
  v_mfma_f32_16x16x32_bf16 v[72:75], a[108:111], v[4:7], v[72:75]
  s_mov_b32 s54, 0xbdd2d3e8
  v_mov_b32 v117, 0xc0135761
L_f1_top_192:
  s_cmp_ge_u32 s44, 62
  s_cbranch_scc1 L_wi_go_193
L_wf_194:
  buffer_load_dwordx2 v[120:121], v108, s[8:11], s48 offen sc1
  s_add_u32 s6, s6, 1
  s_cmp_gt_u32 s6, 262144
  s_cbranch_scc1 L_timeout
  s_waitcnt vmcnt(0)
  v_cmp_ne_u32 vcc, s98, v120
  v_cmp_ne_u32 s[36:37], s98, v121
  s_or_b64 vcc, vcc, s[36:37]
  s_cbranch_vccz L_wfok_195
  s_sleep 2
  s_branch L_wf_194
L_wfok_195:
L_wi_go_193:
L_f1_again_196:
  buffer_load_dwordx2 v[84:85], v110, s[8:11], s46 offen offset:0 sc1
  buffer_load_dwordx2 v[86:87], v110, s[8:11], s46 offen offset:512 sc1
  buffer_load_dwordx2 v[88:89], v110, s[8:11], s46 offen offset:1024 sc1
  buffer_load_dwordx2 v[90:91], v118, s[8:11], s46 offen sc1
  s_mov_b32 s33, s45
  buffer_load_dwordx4 v[4:7], v3, s[8:11], s33 offen offset:0 sc1
  buffer_load_dwordx4 v[8:11], v3, s[8:11], s33 offen offset:1024 sc1
  buffer_load_dwordx4 v[12:15], v3, s[8:11], s33 offen offset:2048 sc1
  buffer_load_dwordx4 v[16:19], v3, s[8:11], s33 offen offset:3072 sc1
  s_add_u32 s33, s33, 4096
  buffer_load_dwordx4 v[20:23], v3, s[8:11], s33 offen offset:0 sc1
  buffer_load_dwordx4 v[24:27], v3, s[8:11], s33 offen offset:1024 sc1
  buffer_load_dwordx4 v[28:31], v3, s[8:11], s33 offen offset:2048 sc1
  buffer_load_dwordx4 v[32:35], v3, s[8:11], s33 offen offset:3072 sc1
  s_add_u32 s33, s33, 4096
  buffer_load_dwordx4 v[36:39], v3, s[8:11], s33 offen offset:0 sc1
  buffer_load_dwordx4 v[40:43], v3, s[8:11], s33 offen offset:1024 sc1
  buffer_load_dwordx4 v[44:47], v3, s[8:11], s33 offen offset:2048 sc1
  buffer_load_dwordx4 v[48:51], v3, s[8:11], s33 offen offset:3072 sc1
  s_add_u32 s33, s33, 4096
  buffer_load_dwordx4 v[52:55], v3, s[8:11], s33 offen offset:0 sc1
  buffer_load_dwordx4 v[56:59], v3, s[8:11], s33 offen offset:1024 sc1
  s_waitcnt vmcnt(14)
  v_add_f32 v113, v84, v86
  v_add_f32 v114, v85, v87
  v_mul_f32 v115, v84, v84
  v_fmac_f32 v115, v86, v86
  v_add_f32 v113, v113, v88
  v_add_f32 v114, v114, v89
  v_fmac_f32 v115, v88, v88
  v_add_f32 v113, v113, v90
  v_add_f32 v114, v114, v91
  v_fmac_f32 v115, v90, v90
  v_fmac_f32 v114, 0x42000000, v115
  v_mov_b32 v116, v113
  s_nop 1
  v_permlane16_swap_b32 v113, v116
  v_add_f32 v113, v113, v116
  v_mov_b32 v116, v113
  s_nop 1
  v_permlane32_swap_b32 v113, v116
  v_add_f32 v113, v113, v116
  v_mov_b32 v116, v114
  s_nop 1
  v_permlane16_swap_b32 v114, v116
  v_add_f32 v114, v114, v116
  v_mov_b32 v116, v114
  s_nop 1
  v_permlane32_swap_b32 v114, v116
  v_add_f32 v114, v114, v116
  v_mul_f32 v113, 0x3d924925, v113
  v_mul_f32 v115, v113, v113
  v_mul_f32 v114, 0x3b124925, v114
  v_sub_f32 v114, v114, v115
  v_max_f32 v114, 0, v114
  v_add_f32 v114, 0x3727c5ac, v114
  v_rsq_f32 v114, v114
  s_waitcnt vmcnt(13)
  v_mfma_f32_16x16x32_bf16 v[60:63], a[0:3], v[4:7], 0
  v_mfma_f32_16x16x32_bf16 v[64:67], a[56:59], v[4:7], 0
  s_waitcnt vmcnt(12)
  v_mfma_f32_16x16x32_bf16 v[60:63], a[4:7], v[8:11], v[60:63]
  v_mfma_f32_16x16x32_bf16 v[64:67], a[60:63], v[8:11], v[64:67]
  s_waitcnt vmcnt(11)
  v_mfma_f32_16x16x32_bf16 v[60:63], a[8:11], v[12:15], v[60:63]
  v_mfma_f32_16x16x32_bf16 v[64:67], a[64:67], v[12:15], v[64:67]
  s_waitcnt vmcnt(10)
  v_mfma_f32_16x16x32_bf16 v[60:63], a[12:15], v[16:19], v[60:63]
  v_mfma_f32_16x16x32_bf16 v[64:67], a[68:71], v[16:19], v[64:67]
  s_waitcnt vmcnt(9)
  v_mfma_f32_16x16x32_bf16 v[60:63], a[16:19], v[20:23], v[60:63]
  v_mfma_f32_16x16x32_bf16 v[64:67], a[72:75], v[20:23], v[64:67]
  s_waitcnt vmcnt(8)
  v_mfma_f32_16x16x32_bf16 v[60:63], a[20:23], v[24:27], v[60:63]
  v_mfma_f32_16x16x32_bf16 v[64:67], a[76:79], v[24:27], v[64:67]
  s_waitcnt vmcnt(7)
  v_mfma_f32_16x16x32_bf16 v[60:63], a[24:27], v[28:31], v[60:63]
  v_mfma_f32_16x16x32_bf16 v[64:67], a[80:83], v[28:31], v[64:67]
  s_waitcnt vmcnt(6)
  v_mfma_f32_16x16x32_bf16 v[60:63], a[28:31], v[32:35], v[60:63]
  v_mfma_f32_16x16x32_bf16 v[64:67], a[84:87], v[32:35], v[64:67]
  s_waitcnt vmcnt(5)
  v_mfma_f32_16x16x32_bf16 v[60:63], a[32:35], v[36:39], v[60:63]
  v_mfma_f32_16x16x32_bf16 v[64:67], a[88:91], v[36:39], v[64:67]
  s_waitcnt vmcnt(4)
  v_mfma_f32_16x16x32_bf16 v[60:63], a[36:39], v[40:43], v[60:63]
  v_mfma_f32_16x16x32_bf16 v[64:67], a[92:95], v[40:43], v[64:67]
  s_waitcnt vmcnt(3)
  v_mfma_f32_16x16x32_bf16 v[60:63], a[40:43], v[44:47], v[60:63]
  v_mfma_f32_16x16x32_bf16 v[64:67], a[96:99], v[44:47], v[64:67]
  s_waitcnt vmcnt(2)
  v_mfma_f32_16x16x32_bf16 v[60:63], a[44:47], v[48:51], v[60:63]
  v_mfma_f32_16x16x32_bf16 v[64:67], a[100:103], v[48:51], v[64:67]
  s_waitcnt vmcnt(1)
  v_mfma_f32_16x16x32_bf16 v[60:63], a[48:51], v[52:55], v[60:63]
  v_mfma_f32_16x16x32_bf16 v[64:67], a[104:107], v[52:55], v[64:67]
  s_waitcnt vmcnt(0)
  v_mfma_f32_16x16x32_bf16 v[60:63], a[52:55], v[56:59], v[60:63]
  v_mfma_f32_16x16x32_bf16 v[64:67], a[108:111], v[56:59], v[64:67]
  s_cmp_ge_u32 s44, 61
  s_cbranch_scc0 L_vl_197
  s_add_u32 s6, s6, 1
  s_cmp_gt_u32 s6, 262144
  s_cbranch_scc1 L_timeout
  s_waitcnt vmcnt(0)
  v_max3_u32 v92, v4, v5, v6
  v_max3_u32 v92, v92, v7, v8
  v_max3_u32 v92, v92, v9, v10
  v_max3_u32 v92, v92, v11, v12
  v_max3_u32 v92, v92, v13, v14
  v_max3_u32 v92, v92, v15, v16
  v_max3_u32 v92, v92, v17, v18
  v_max3_u32 v92, v92, v19, v20
  v_max3_u32 v92, v92, v21, v22
  v_max3_u32 v92, v92, v23, v24
  v_max3_u32 v92, v92, v25, v26
  v_max3_u32 v92, v92, v27, v28
  v_max3_u32 v92, v92, v29, v30
  v_max3_u32 v92, v92, v31, v32
  v_max3_u32 v92, v92, v33, v34
  v_max3_u32 v92, v92, v35, v36
  v_max3_u32 v92, v92, v37, v38
  v_max3_u32 v92, v92, v39, v40
  v_max3_u32 v92, v92, v41, v42
  v_max3_u32 v92, v92, v43, v44
  v_max3_u32 v92, v92, v45, v46
  v_max3_u32 v92, v92, v47, v48
  v_max3_u32 v92, v92, v49, v50
  v_max3_u32 v92, v92, v51, v52
  v_max3_u32 v92, v92, v53, v54
  v_max3_u32 v92, v92, v55, v56
  v_max3_u32 v92, v92, v57, v58
  v_max3_u32 v92, v92, v59, v84
  v_max3_u32 v92, v92, v85, v86
  v_max3_u32 v92, v92, v87, v88
  v_max3_u32 v92, v92, v89, v90
  v_max_u32 v92, v92, v91
  v_cmp_eq_u32 vcc, -1, v92
  s_cbranch_vccnz L_f1_again_196
L_vl_197:
  s_nop 4
  v_fma_f32 v92, -v113, v68, v60
  v_fma_f32 v93, -v113, v69, v61
  v_fma_f32 v94, -v113, v70, v62
  v_fma_f32 v95, -v113, v71, v63
  v_fma_f32 v96, -v113, v72, v64
  v_fma_f32 v97, -v113, v73, v65
  v_fma_f32 v98, -v113, v74, v66
  v_fma_f32 v99, -v113, v75, v67
  v_fma_f32 v92, v114, v92, v76
  v_fma_f32 v93, v114, v93, v77
  v_fma_f32 v94, v114, v94, v78
  v_fma_f32 v95, v114, v95, v79
  v_fma_f32 v96, v114, v96, v80
  v_fma_f32 v97, v114, v97, v81
  v_fma_f32 v98, v114, v98, v82
  v_fma_f32 v99, v114, v99, v83
  v_mul_f32 v60, v92, v92
  v_mul_f32 v61, v93, v93
  v_mul_f32 v62, v94, v94
  v_mul_f32 v63, v95, v95
  v_mul_f32 v64, v96, v96
  v_mul_f32 v65, v97, v97
  v_mul_f32 v66, v98, v98
  v_mul_f32 v67, v99, v99
  v_fma_f32 v60, v60, s54, v117
  v_fma_f32 v61, v61, s54, v117
  v_fma_f32 v62, v62, s54, v117
  v_fma_f32 v63, v63, s54, v117
  v_fma_f32 v64, v64, s54, v117
  v_fma_f32 v65, v65, s54, v117
  v_fma_f32 v66, v66, s54, v117
  v_fma_f32 v67, v67, s54, v117
  v_mul_f32 v60, v60, v92
  v_mul_f32 v61, v61, v93
  v_mul_f32 v62, v62, v94
  v_mul_f32 v63, v63, v95
  v_mul_f32 v64, v64, v96
  v_mul_f32 v65, v65, v97
  v_mul_f32 v66, v66, v98
  v_mul_f32 v67, v67, v99
  v_exp_f32 v60, v60
  v_exp_f32 v61, v61
  v_exp_f32 v62, v62
  v_exp_f32 v63, v63
  v_exp_f32 v64, v64
  v_exp_f32 v65, v65
  v_exp_f32 v66, v66
  v_exp_f32 v67, v67
  v_add_f32 v60, 1.0, v60
  v_add_f32 v61, 1.0, v61
  v_add_f32 v62, 1.0, v62
  v_add_f32 v63, 1.0, v63
  v_add_f32 v64, 1.0, v64
  v_add_f32 v65, 1.0, v65
  v_add_f32 v66, 1.0, v66
  v_add_f32 v67, 1.0, v67
  v_rcp_f32 v60, v60
  v_rcp_f32 v61, v61
  v_rcp_f32 v62, v62
  v_rcp_f32 v63, v63
  v_rcp_f32 v64, v64
  v_rcp_f32 v65, v65
  v_rcp_f32 v66, v66
  v_rcp_f32 v67, v67
  v_mul_f32 v92, v92, v60
  v_mul_f32 v93, v93, v61
  v_mul_f32 v94, v94, v62
  v_mul_f32 v95, v95, v63
  v_mul_f32 v96, v96, v64
  v_mul_f32 v97, v97, v65
  v_mul_f32 v98, v98, v66
  v_mul_f32 v99, v99, v67
  v_cvt_pk_bf16_f32 v100, v92, v93
  v_cvt_pk_bf16_f32 v101, v94, v95
  v_cvt_pk_bf16_f32 v102, v96, v97
  v_cvt_pk_bf16_f32 v103, v98, v99
  v_min_u32 v100, -2, v100
  v_min_u32 v101, -2, v101
  v_min_u32 v102, -2, v102
  v_min_u32 v103, -2, v103
  buffer_store_dwordx4 v[100:103], v3, s[8:11], s47 offen sc1
  s_cmp_ge_u32 s44, 61
  s_cbranch_scc1 L_nd_198
  s_waitcnt vmcnt(0)
L_nd_198:
  v_mov_b32 v84, s98
  v_lshrrev_b32 v85, 2, v3
  v_and_b32 v85, 124, v85
  buffer_store_dword v84, v85, s[8:11], s49 offen sc1
  s_add_u32 s44, s44, 2
  s_add_u32 s45, s45, 57344
  s_add_u32 s46, s46, 7168
  s_add_u32 s47, s47, 229376
  s_add_u32 s48, s48, 57344
  s_add_u32 s49, s49, 57344
  s_cmp_lt_u32 s44, 64
  s_cbranch_scc1 L_f1_top_192
  s_endpgm
L_f2:
  s_cmp_eq_u32 s3, 0
  s_cbranch_scc0 L_afy_199
  v_lshlrev_b32 v4, 7, v1
  s_mov_b32 s34, 75857920
L_wf_200:
  buffer_load_dwordx2 v[6:7], v4, s[8:11], s34 offen sc1
  s_add_u32 s6, s6, 1
  s_cmp_gt_u32 s6, 262144
  s_cbranch_scc1 L_timeout
  s_waitcnt vmcnt(0)
  v_cmp_ne_u32 vcc, s98, v6
  v_cmp_ne_u32 s[36:37], s98, v7
  s_or_b64 vcc, vcc, s[36:37]
  s_cbranch_vccz L_wfok_201
  s_sleep 16
  s_branch L_wf_200
L_wfok_201:
L_afy_199:
  s_barrier
  s_load_dwordx2 s[40:41], s[0:1], 80
  s_load_dwordx2 s[42:43], s[0:1], 88
  s_load_dwordx2 s[38:39], s[0:1], 96
  s_lshr_b32 s34, s30, 1
  s_and_b32 s35, s30, 1
  s_and_b32 s29, s3, 1
  v_lshrrev_b32 v4, 2, v0
  v_mov_b32 v6, 896
  v_mul_lo_u32 v4, v4, v6
  v_and_b32 v5, 3, v0
  v_lshl_add_u32 v130, v5, 4, v4
  s_mul_i32 s28, s3, 28672
  v_lshrrev_b32 v4, 2, v1
  v_lshlrev_b32 v4, 6, v4
  v_and_b32 v5, 3, v0
  v_lshl_add_u32 v4, v5, 4, v4
  v_lshl_add_u32 v4, v2, 9, v4
  v_add_u32 v131, s28, v4
  v_lshlrev_b32 v7, 4, v2
  s_mov_b32 s49, 0xffff0000
  s_lshl_b32 s52, s34, 7
  s_lshl_b32 s53, s29, 6
  s_add_u32 s53, s53, s52
  s_waitcnt lgkmcnt(0)
  s_mov_b32 s16, s40
  s_and_b32 s17, s41, 0xffff
  s_mov_b32 s18, 1605632
  s_mov_b32 s19, 0x20000
  s_mov_b32 s20, s42
  s_and_b32 s21, s43, 0xffff
  s_mov_b32 s22, 896
  s_mov_b32 s23, 0x20000
  s_mov_b32 s24, s38
  s_and_b32 s25, s39, 0xffff
  s_mov_b32 s26, 1835008
  s_mov_b32 s27, 0x20000
  buffer_load_dwordx4 v[76:79], v7, s[20:23], s53 offen
  s_mul_i32 s37, s3, 401408
  s_add_u32 s37, s37, s52
  s_add_u32 s37, s37, 0
  s_mov_b32 s36, s28
  s_mov_b32 m0, s36
  s_add_u32 s36, s36, 1024
  buffer_load_dwordx4 v130, s[16:19], s37 offen nt lds
  s_add_u32 s37, s37, 14336
  s_mov_b32 m0, s36
  s_add_u32 s36, s36, 1024
  buffer_load_dwordx4 v130, s[16:19], s37 offen nt lds
  s_add_u32 s37, s37, 14336
  s_mov_b32 m0, s36
  s_add_u32 s36, s36, 1024
  buffer_load_dwordx4 v130, s[16:19], s37 offen nt lds
  s_add_u32 s37, s37, 14336
  s_mov_b32 m0, s36
  s_add_u32 s36, s36, 1024
  buffer_load_dwordx4 v130, s[16:19], s37 offen nt lds
  s_add_u32 s37, s37, 14336
  s_mov_b32 m0, s36
  s_add_u32 s36, s36, 1024
  buffer_load_dwordx4 v130, s[16:19], s37 offen nt lds
  s_add_u32 s37, s37, 14336
  s_mov_b32 m0, s36
  s_add_u32 s36, s36, 1024
  buffer_load_dwordx4 v130, s[16:19], s37 offen nt lds
  s_add_u32 s37, s37, 14336
  s_mov_b32 m0, s36
  s_add_u32 s36, s36, 1024
  buffer_load_dwordx4 v130, s[16:19], s37 offen nt lds
  s_add_u32 s37, s37, 14336
  s_mov_b32 m0, s36
  s_add_u32 s36, s36, 1024
  buffer_load_dwordx4 v130, s[16:19], s37 offen nt lds
  s_add_u32 s37, s37, 14336
  s_mov_b32 m0, s36
  s_add_u32 s36, s36, 1024
  buffer_load_dwordx4 v130, s[16:19], s37 offen nt lds
  s_add_u32 s37, s37, 14336
  s_mov_b32 m0, s36
  s_add_u32 s36, s36, 1024
  buffer_load_dwordx4 v130, s[16:19], s37 offen nt lds
  s_add_u32 s37, s37, 14336
  s_mov_b32 m0, s36
  s_add_u32 s36, s36, 1024
  buffer_load_dwordx4 v130, s[16:19], s37 offen nt lds
  s_add_u32 s37, s37, 14336
  s_mov_b32 m0, s36
  s_add_u32 s36, s36, 1024
  buffer_load_dwordx4 v130, s[16:19], s37 offen nt lds
  s_add_u32 s37, s37, 14336
  s_mov_b32 m0, s36
  s_add_u32 s36, s36, 1024
  buffer_load_dwordx4 v130, s[16:19], s37 offen nt lds
  s_add_u32 s37, s37, 14336
  s_mov_b32 m0, s36
  s_add_u32 s36, s36, 1024
  buffer_load_dwordx4 v130, s[16:19], s37 offen nt lds
  s_add_u32 s37, s37, 14336
  s_mov_b32 m0, s36
  s_add_u32 s36, s36, 1024
  buffer_load_dwordx4 v130, s[16:19], s37 offen nt lds
  s_add_u32 s37, s37, 14336
  s_mov_b32 m0, s36
  s_add_u32 s36, s36, 1024
  buffer_load_dwordx4 v130, s[16:19], s37 offen nt lds
  s_add_u32 s37, s37, 14336
  s_mov_b32 m0, s36
  s_add_u32 s36, s36, 1024
  buffer_load_dwordx4 v130, s[16:19], s37 offen nt lds
  s_add_u32 s37, s37, 14336
  s_mov_b32 m0, s36
  s_add_u32 s36, s36, 1024
  buffer_load_dwordx4 v130, s[16:19], s37 offen nt lds
  s_add_u32 s37, s37, 14336
  s_mov_b32 m0, s36
  s_add_u32 s36, s36, 1024
  buffer_load_dwordx4 v130, s[16:19], s37 offen nt lds
  s_add_u32 s37, s37, 14336
  s_mov_b32 m0, s36
  s_add_u32 s36, s36, 1024
  buffer_load_dwordx4 v130, s[16:19], s37 offen nt lds
  s_add_u32 s37, s37, 14336
  s_mov_b32 m0, s36
  s_add_u32 s36, s36, 1024
  buffer_load_dwordx4 v130, s[16:19], s37 offen nt lds
  s_add_u32 s37, s37, 14336
  s_mov_b32 m0, s36
  s_add_u32 s36, s36, 1024
  buffer_load_dwordx4 v130, s[16:19], s37 offen nt lds
  s_add_u32 s37, s37, 14336
  s_mov_b32 m0, s36
  s_add_u32 s36, s36, 1024
  buffer_load_dwordx4 v130, s[16:19], s37 offen nt lds
  s_add_u32 s37, s37, 14336
  s_mov_b32 m0, s36
  s_add_u32 s36, s36, 1024
  buffer_load_dwordx4 v130, s[16:19], s37 offen nt lds
  s_add_u32 s37, s37, 14336
  s_mov_b32 m0, s36
  s_add_u32 s36, s36, 1024
  buffer_load_dwordx4 v130, s[16:19], s37 offen nt lds
  s_add_u32 s37, s37, 14336
  s_mov_b32 m0, s36
  s_add_u32 s36, s36, 1024
  buffer_load_dwordx4 v130, s[16:19], s37 offen nt lds
  s_add_u32 s37, s37, 14336
  s_mov_b32 m0, s36
  s_add_u32 s36, s36, 1024
  buffer_load_dwordx4 v130, s[16:19], s37 offen nt lds
  s_add_u32 s37, s37, 14336
  s_mov_b32 m0, s36
  s_add_u32 s36, s36, 1024
  buffer_load_dwordx4 v130, s[16:19], s37 offen nt lds
  s_add_u32 s37, s37, 14336
  s_waitcnt vmcnt(0)
  ds_read_b64_tr_b16 a[0:1], v131 offset:0
  ds_read_b64_tr_b16 a[2:3], v131 offset:256
  ds_read_b64_tr_b16 a[4:5], v131 offset:2048
  ds_read_b64_tr_b16 a[6:7], v131 offset:2304
  ds_read_b64_tr_b16 a[8:9], v131 offset:4096
  ds_read_b64_tr_b16 a[10:11], v131 offset:4352
  ds_read_b64_tr_b16 a[12:13], v131 offset:6144
  ds_read_b64_tr_b16 a[14:15], v131 offset:6400
  ds_read_b64_tr_b16 a[16:17], v131 offset:8192
  ds_read_b64_tr_b16 a[18:19], v131 offset:8448
  ds_read_b64_tr_b16 a[20:21], v131 offset:10240
  ds_read_b64_tr_b16 a[22:23], v131 offset:10496
  ds_read_b64_tr_b16 a[24:25], v131 offset:12288
  ds_read_b64_tr_b16 a[26:27], v131 offset:12544
  ds_read_b64_tr_b16 a[28:29], v131 offset:14336
  s_waitcnt lgkmcnt(14)
  ds_read_b64_tr_b16 a[30:31], v131 offset:14592
  s_waitcnt lgkmcnt(14)
  ds_read_b64_tr_b16 a[32:33], v131 offset:16384
  s_waitcnt lgkmcnt(14)
  ds_read_b64_tr_b16 a[34:35], v131 offset:16640
  s_waitcnt lgkmcnt(14)
  ds_read_b64_tr_b16 a[36:37], v131 offset:18432
  s_waitcnt lgkmcnt(14)
  ds_read_b64_tr_b16 a[38:39], v131 offset:18688
  s_waitcnt lgkmcnt(14)
  ds_read_b64_tr_b16 a[40:41], v131 offset:20480
  s_waitcnt lgkmcnt(14)
  ds_read_b64_tr_b16 a[42:43], v131 offset:20736
  s_waitcnt lgkmcnt(14)
  ds_read_b64_tr_b16 a[44:45], v131 offset:22528
  s_waitcnt lgkmcnt(14)
  ds_read_b64_tr_b16 a[46:47], v131 offset:22784
  s_waitcnt lgkmcnt(14)
  ds_read_b64_tr_b16 a[48:49], v131 offset:24576
  s_waitcnt lgkmcnt(14)
  ds_read_b64_tr_b16 a[50:51], v131 offset:24832
  s_waitcnt lgkmcnt(14)
  ds_read_b64_tr_b16 a[52:53], v131 offset:26624
  s_waitcnt lgkmcnt(14)
  ds_read_b64_tr_b16 a[54:55], v131 offset:26880
  s_waitcnt lgkmcnt(14)
  ds_read_b64_tr_b16 a[56:57], v131 offset:8
  s_waitcnt lgkmcnt(14)
  ds_read_b64_tr_b16 a[58:59], v131 offset:264
  s_waitcnt lgkmcnt(14)
  ds_read_b64_tr_b16 a[60:61], v131 offset:2056
  s_waitcnt lgkmcnt(14)
  ds_read_b64_tr_b16 a[62:63], v131 offset:2312
  s_waitcnt lgkmcnt(14)
  ds_read_b64_tr_b16 a[64:65], v131 offset:4104
  s_waitcnt lgkmcnt(14)
  ds_read_b64_tr_b16 a[66:67], v131 offset:4360
  s_waitcnt lgkmcnt(14)
  ds_read_b64_tr_b16 a[68:69], v131 offset:6152
  s_waitcnt lgkmcnt(14)
  ds_read_b64_tr_b16 a[70:71], v131 offset:6408
  s_waitcnt lgkmcnt(14)
  ds_read_b64_tr_b16 a[72:73], v131 offset:8200
  s_waitcnt lgkmcnt(14)
  ds_read_b64_tr_b16 a[74:75], v131 offset:8456
  s_waitcnt lgkmcnt(14)
  ds_read_b64_tr_b16 a[76:77], v131 offset:10248
  s_waitcnt lgkmcnt(14)
  ds_read_b64_tr_b16 a[78:79], v131 offset:10504
  s_waitcnt lgkmcnt(14)
  ds_read_b64_tr_b16 a[80:81], v131 offset:12296
  s_waitcnt lgkmcnt(14)
  ds_read_b64_tr_b16 a[82:83], v131 offset:12552
  s_waitcnt lgkmcnt(14)
  ds_read_b64_tr_b16 a[84:85], v131 offset:14344
  s_waitcnt lgkmcnt(14)
  ds_read_b64_tr_b16 a[86:87], v131 offset:14600
  s_waitcnt lgkmcnt(14)
  ds_read_b64_tr_b16 a[88:89], v131 offset:16392
  s_waitcnt lgkmcnt(14)
  ds_read_b64_tr_b16 a[90:91], v131 offset:16648
  s_waitcnt lgkmcnt(14)
  ds_read_b64_tr_b16 a[92:93], v131 offset:18440
  s_waitcnt lgkmcnt(14)
  ds_read_b64_tr_b16 a[94:95], v131 offset:18696
  s_waitcnt lgkmcnt(14)
  ds_read_b64_tr_b16 a[96:97], v131 offset:20488
  s_waitcnt lgkmcnt(14)
  ds_read_b64_tr_b16 a[98:99], v131 offset:20744
  s_waitcnt lgkmcnt(14)
  ds_read_b64_tr_b16 a[100:101], v131 offset:22536
  s_waitcnt lgkmcnt(14)
  ds_read_b64_tr_b16 a[102:103], v131 offset:22792
  s_waitcnt lgkmcnt(14)
  ds_read_b64_tr_b16 a[104:105], v131 offset:24584
  s_waitcnt lgkmcnt(14)
  ds_read_b64_tr_b16 a[106:107], v131 offset:24840
  s_waitcnt lgkmcnt(14)
  ds_read_b64_tr_b16 a[108:109], v131 offset:26632
  s_waitcnt lgkmcnt(14)
  ds_read_b64_tr_b16 a[110:111], v131 offset:26888
  s_waitcnt lgkmcnt(0)
  s_mul_i32 s37, s3, 401408
  s_add_u32 s37, s37, s52
  s_add_u32 s37, s37, 64
  s_mov_b32 s36, s28
  s_mov_b32 m0, s36
  s_add_u32 s36, s36, 1024
  buffer_load_dwordx4 v130, s[16:19], s37 offen nt lds
  s_add_u32 s37, s37, 14336
  s_mov_b32 m0, s36
  s_add_u32 s36, s36, 1024
  buffer_load_dwordx4 v130, s[16:19], s37 offen nt lds
  s_add_u32 s37, s37, 14336
  s_mov_b32 m0, s36
  s_add_u32 s36, s36, 1024
  buffer_load_dwordx4 v130, s[16:19], s37 offen nt lds
  s_add_u32 s37, s37, 14336
  s_mov_b32 m0, s36
  s_add_u32 s36, s36, 1024
  buffer_load_dwordx4 v130, s[16:19], s37 offen nt lds
  s_add_u32 s37, s37, 14336
  s_mov_b32 m0, s36
  s_add_u32 s36, s36, 1024
  buffer_load_dwordx4 v130, s[16:19], s37 offen nt lds
  s_add_u32 s37, s37, 14336
  s_mov_b32 m0, s36
  s_add_u32 s36, s36, 1024
  buffer_load_dwordx4 v130, s[16:19], s37 offen nt lds
  s_add_u32 s37, s37, 14336
  s_mov_b32 m0, s36
  s_add_u32 s36, s36, 1024
  buffer_load_dwordx4 v130, s[16:19], s37 offen nt lds
  s_add_u32 s37, s37, 14336
  s_mov_b32 m0, s36
  s_add_u32 s36, s36, 1024
  buffer_load_dwordx4 v130, s[16:19], s37 offen nt lds
  s_add_u32 s37, s37, 14336
  s_mov_b32 m0, s36
  s_add_u32 s36, s36, 1024
  buffer_load_dwordx4 v130, s[16:19], s37 offen nt lds
  s_add_u32 s37, s37, 14336
  s_mov_b32 m0, s36
  s_add_u32 s36, s36, 1024
  buffer_load_dwordx4 v130, s[16:19], s37 offen nt lds
  s_add_u32 s37, s37, 14336
  s_mov_b32 m0, s36
  s_add_u32 s36, s36, 1024
  buffer_load_dwordx4 v130, s[16:19], s37 offen nt lds
  s_add_u32 s37, s37, 14336
  s_mov_b32 m0, s36
  s_add_u32 s36, s36, 1024
  buffer_load_dwordx4 v130, s[16:19], s37 offen nt lds
  s_add_u32 s37, s37, 14336
  s_mov_b32 m0, s36
  s_add_u32 s36, s36, 1024
  buffer_load_dwordx4 v130, s[16:19], s37 offen nt lds
  s_add_u32 s37, s37, 14336
  s_mov_b32 m0, s36
  s_add_u32 s36, s36, 1024
  buffer_load_dwordx4 v130, s[16:19], s37 offen nt lds
  s_add_u32 s37, s37, 14336
  s_mov_b32 m0, s36
  s_add_u32 s36, s36, 1024
  buffer_load_dwordx4 v130, s[16:19], s37 offen nt lds
  s_add_u32 s37, s37, 14336
  s_mov_b32 m0, s36
  s_add_u32 s36, s36, 1024
  buffer_load_dwordx4 v130, s[16:19], s37 offen nt lds
  s_add_u32 s37, s37, 14336
  s_mov_b32 m0, s36
  s_add_u32 s36, s36, 1024
  buffer_load_dwordx4 v130, s[16:19], s37 offen nt lds
  s_add_u32 s37, s37, 14336
  s_mov_b32 m0, s36
  s_add_u32 s36, s36, 1024
  buffer_load_dwordx4 v130, s[16:19], s37 offen nt lds
  s_add_u32 s37, s37, 14336
  s_mov_b32 m0, s36
  s_add_u32 s36, s36, 1024
  buffer_load_dwordx4 v130, s[16:19], s37 offen nt lds
  s_add_u32 s37, s37, 14336
  s_mov_b32 m0, s36
  s_add_u32 s36, s36, 1024
  buffer_load_dwordx4 v130, s[16:19], s37 offen nt lds
  s_add_u32 s37, s37, 14336
  s_mov_b32 m0, s36
  s_add_u32 s36, s36, 1024
  buffer_load_dwordx4 v130, s[16:19], s37 offen nt lds
  s_add_u32 s37, s37, 14336
  s_mov_b32 m0, s36
  s_add_u32 s36, s36, 1024
  buffer_load_dwordx4 v130, s[16:19], s37 offen nt lds
  s_add_u32 s37, s37, 14336
  s_mov_b32 m0, s36
  s_add_u32 s36, s36, 1024
  buffer_load_dwordx4 v130, s[16:19], s37 offen nt lds
  s_add_u32 s37, s37, 14336
  s_mov_b32 m0, s36
  s_add_u32 s36, s36, 1024
  buffer_load_dwordx4 v130, s[16:19], s37 offen nt lds
  s_add_u32 s37, s37, 14336
  s_mov_b32 m0, s36
  s_add_u32 s36, s36, 1024
  buffer_load_dwordx4 v130, s[16:19], s37 offen nt lds
  s_add_u32 s37, s37, 14336
  s_mov_b32 m0, s36
  s_add_u32 s36, s36, 1024
  buffer_load_dwordx4 v130, s[16:19], s37 offen nt lds
  s_add_u32 s37, s37, 14336
  s_mov_b32 m0, s36
  s_add_u32 s36, s36, 1024
  buffer_load_dwordx4 v130, s[16:19], s37 offen nt lds
  s_add_u32 s37, s37, 14336
  s_mov_b32 m0, s36
  s_add_u32 s36, s36, 1024
  buffer_load_dwordx4 v130, s[16:19], s37 offen nt lds
  s_add_u32 s37, s37, 14336
  s_waitcnt vmcnt(0)
  ds_read_b64_tr_b16 a[112:113], v131 offset:0
  ds_read_b64_tr_b16 a[114:115], v131 offset:256
  ds_read_b64_tr_b16 a[116:117], v131 offset:2048
  ds_read_b64_tr_b16 a[118:119], v131 offset:2304
  ds_read_b64_tr_b16 a[120:121], v131 offset:4096
  ds_read_b64_tr_b16 a[122:123], v131 offset:4352
  ds_read_b64_tr_b16 a[124:125], v131 offset:6144
  ds_read_b64_tr_b16 a[126:127], v131 offset:6400
  ds_read_b64_tr_b16 a[128:129], v131 offset:8192
  ds_read_b64_tr_b16 a[130:131], v131 offset:8448
  ds_read_b64_tr_b16 a[132:133], v131 offset:10240
  ds_read_b64_tr_b16 a[134:135], v131 offset:10496
  ds_read_b64_tr_b16 a[136:137], v131 offset:12288
  ds_read_b64_tr_b16 a[138:139], v131 offset:12544
  ds_read_b64_tr_b16 a[140:141], v131 offset:14336
  s_waitcnt lgkmcnt(14)
  ds_read_b64_tr_b16 a[142:143], v131 offset:14592
  s_waitcnt lgkmcnt(14)
  ds_read_b64_tr_b16 a[144:145], v131 offset:16384
  s_waitcnt lgkmcnt(14)
  ds_read_b64_tr_b16 a[146:147], v131 offset:16640
  s_waitcnt lgkmcnt(14)
  ds_read_b64_tr_b16 a[148:149], v131 offset:18432
  s_waitcnt lgkmcnt(14)
  ds_read_b64_tr_b16 a[150:151], v131 offset:18688
  s_waitcnt lgkmcnt(14)
  ds_read_b64_tr_b16 a[152:153], v131 offset:20480
  s_waitcnt lgkmcnt(14)
  ds_read_b64_tr_b16 a[154:155], v131 offset:20736
  s_waitcnt lgkmcnt(14)
  ds_read_b64_tr_b16 a[156:157], v131 offset:22528
  s_waitcnt lgkmcnt(14)
  ds_read_b64_tr_b16 a[158:159], v131 offset:22784
  s_waitcnt lgkmcnt(14)
  ds_read_b64_tr_b16 a[160:161], v131 offset:24576
  s_waitcnt lgkmcnt(14)
  ds_read_b64_tr_b16 a[162:163], v131 offset:24832
  s_waitcnt lgkmcnt(14)
  ds_read_b64_tr_b16 a[164:165], v131 offset:26624
  s_waitcnt lgkmcnt(14)
  ds_read_b64_tr_b16 a[166:167], v131 offset:26880
  s_waitcnt lgkmcnt(14)
  ds_read_b64_tr_b16 a[168:169], v131 offset:8
  s_waitcnt lgkmcnt(14)
  ds_read_b64_tr_b16 a[170:171], v131 offset:264
  s_waitcnt lgkmcnt(14)
  ds_read_b64_tr_b16 a[172:173], v131 offset:2056
  s_waitcnt lgkmcnt(14)
  ds_read_b64_tr_b16 a[174:175], v131 offset:2312
  s_waitcnt lgkmcnt(14)
  ds_read_b64_tr_b16 a[176:177], v131 offset:4104
  s_waitcnt lgkmcnt(14)
  ds_read_b64_tr_b16 a[178:179], v131 offset:4360
  s_waitcnt lgkmcnt(14)
  ds_read_b64_tr_b16 a[180:181], v131 offset:6152
  s_waitcnt lgkmcnt(14)
  ds_read_b64_tr_b16 a[182:183], v131 offset:6408
  s_waitcnt lgkmcnt(14)
  ds_read_b64_tr_b16 a[184:185], v131 offset:8200
  s_waitcnt lgkmcnt(14)
  ds_read_b64_tr_b16 a[186:187], v131 offset:8456
  s_waitcnt lgkmcnt(14)
  ds_read_b64_tr_b16 a[188:189], v131 offset:10248
  s_waitcnt lgkmcnt(14)
  ds_read_b64_tr_b16 a[190:191], v131 offset:10504
  s_waitcnt lgkmcnt(14)
  ds_read_b64_tr_b16 a[192:193], v131 offset:12296
  s_waitcnt lgkmcnt(14)
  ds_read_b64_tr_b16 a[194:195], v131 offset:12552
  s_waitcnt lgkmcnt(14)
  ds_read_b64_tr_b16 a[196:197], v131 offset:14344
  s_waitcnt lgkmcnt(14)
  ds_read_b64_tr_b16 a[198:199], v131 offset:14600
  s_waitcnt lgkmcnt(14)
  ds_read_b64_tr_b16 a[200:201], v131 offset:16392
  s_waitcnt lgkmcnt(14)
  ds_read_b64_tr_b16 a[202:203], v131 offset:16648
  s_waitcnt lgkmcnt(14)
  ds_read_b64_tr_b16 a[204:205], v131 offset:18440
  s_waitcnt lgkmcnt(14)
  ds_read_b64_tr_b16 a[206:207], v131 offset:18696
  s_waitcnt lgkmcnt(14)
  ds_read_b64_tr_b16 a[208:209], v131 offset:20488
  s_waitcnt lgkmcnt(14)
  ds_read_b64_tr_b16 a[210:211], v131 offset:20744
  s_waitcnt lgkmcnt(14)
  ds_read_b64_tr_b16 a[212:213], v131 offset:22536
  s_waitcnt lgkmcnt(14)
  ds_read_b64_tr_b16 a[214:215], v131 offset:22792
  s_waitcnt lgkmcnt(14)
  ds_read_b64_tr_b16 a[216:217], v131 offset:24584
  s_waitcnt lgkmcnt(14)
  ds_read_b64_tr_b16 a[218:219], v131 offset:24840
  s_waitcnt lgkmcnt(14)
  ds_read_b64_tr_b16 a[220:221], v131 offset:26632
  s_waitcnt lgkmcnt(14)
  ds_read_b64_tr_b16 a[222:223], v131 offset:26888
  s_waitcnt lgkmcnt(0)
  v_lshlrev_b32 v80, 16, v76
  v_and_b32 v81, s49, v76
  v_lshlrev_b32 v82, 16, v77
  v_and_b32 v83, s49, v77
  v_lshlrev_b32 v84, 16, v78
  v_and_b32 v85, s49, v78
  v_lshlrev_b32 v86, 16, v79
  v_and_b32 v87, s49, v79
  s_mov_b32 s44, s31
  s_lshl_b32 s33, s31, 1
  s_add_u32 s33, s33, s35
  s_mul_i32 s36, s33, 56
  s_mul_i32 s37, s3, 14
  s_add_u32 s36, s36, s37
  s_lshl_b32 s45, s36, 10
  s_add_u32 s45, s45, 68517888
  s_mul_i32 s36, s33, 14
  s_lshl_b32 s37, s34, 1
  s_add_u32 s36, s36, s37
  s_add_u32 s36, s36, s29
  s_lshl_b32 s46, s36, 10
  s_add_u32 s46, s46, 66453504
  s_mul_i32 s47, s33, 14336
  s_add_u32 s47, s47, s53
  s_mul_i32 s48, s31, 28672
  s_lshl_b32 s36, s35, 13
  s_add_u32 s48, s48, s36
  s_add_u32 s48, s48, 75870208
  v_min_u32 v128, 55, v0
  v_lshlrev_b32 v128, 7, v128
  s_lshl_b32 s33, s3, 12
  v_add_u32 v132, s33, v3
  s_lshl_b32 s33, s29, 11
  v_add_u32 v133, s33, v3
  v_mul_u32_u24 v4, 896, v1
  v_lshl_add_u32 v134, v2, 4, v4
L_f2_top_202:
  s_cmp_ge_u32 s44, 62
  s_cbranch_scc1 L_wi_go_204
L_wf_205:
  buffer_load_dwordx2 v[138:139], v128, s[8:11], s48 offen sc1
  s_add_u32 s6, s6, 1
  s_cmp_gt_u32 s6, 262144
  s_cbranch_scc1 L_timeout
  s_waitcnt vmcnt(0)
  v_cmp_ne_u32 vcc, s98, v138
  v_cmp_ne_u32 s[36:37], s98, v139
  s_or_b64 vcc, vcc, s[36:37]
  s_cbranch_vccz L_wfok_206
  s_sleep 2
  s_branch L_wf_205
L_wfok_206:
L_wi_go_204:
  s_barrier
L_f2_again_207:
  s_mov_b32 s33, s45
  buffer_load_dwordx4 v[4:7], v3, s[8:11], s33 offen offset:0 sc1
  buffer_load_dwordx4 v[8:11], v3, s[8:11], s33 offen offset:1024 sc1
  buffer_load_dwordx4 v[12:15], v3, s[8:11], s33 offen offset:2048 sc1
  buffer_load_dwordx4 v[16:19], v3, s[8:11], s33 offen offset:3072 sc1
  s_add_u32 s33, s33, 4096
  buffer_load_dwordx4 v[20:23], v3, s[8:11], s33 offen offset:0 sc1
  buffer_load_dwordx4 v[24:27], v3, s[8:11], s33 offen offset:1024 sc1
  buffer_load_dwordx4 v[28:31], v3, s[8:11], s33 offen offset:2048 sc1
  buffer_load_dwordx4 v[32:35], v3, s[8:11], s33 offen offset:3072 sc1
  s_add_u32 s33, s33, 4096
  buffer_load_dwordx4 v[36:39], v3, s[8:11], s33 offen offset:0 sc1
  buffer_load_dwordx4 v[40:43], v3, s[8:11], s33 offen offset:1024 sc1
  buffer_load_dwordx4 v[44:47], v3, s[8:11], s33 offen offset:2048 sc1
  buffer_load_dwordx4 v[48:51], v3, s[8:11], s33 offen offset:3072 sc1
  s_add_u32 s33, s33, 4096
  buffer_load_dwordx4 v[52:55], v3, s[8:11], s33 offen offset:0 sc1
  buffer_load_dwordx4 v[56:59], v3, s[8:11], s33 offen offset:1024 sc1
  buffer_load_dwordx4 v[76:79], v3, s[8:11], s46 offen sc1
  s_waitcnt vmcnt(14)
  v_mfma_f32_16x16x32_bf16 v[60:63], a[0:3], v[4:7], 0
  v_mfma_f32_16x16x32_bf16 v[64:67], a[56:59], v[4:7], 0
  v_mfma_f32_16x16x32_bf16 v[68:71], a[112:115], v[4:7], 0
  v_mfma_f32_16x16x32_bf16 v[72:75], a[168:171], v[4:7], 0
  s_waitcnt vmcnt(13)
  v_mfma_f32_16x16x32_bf16 v[60:63], a[4:7], v[8:11], v[60:63]
  v_mfma_f32_16x16x32_bf16 v[64:67], a[60:63], v[8:11], v[64:67]
  v_mfma_f32_16x16x32_bf16 v[68:71], a[116:119], v[8:11], v[68:71]
  v_mfma_f32_16x16x32_bf16 v[72:75], a[172:175], v[8:11], v[72:75]
  s_waitcnt vmcnt(12)
  v_mfma_f32_16x16x32_bf16 v[60:63], a[8:11], v[12:15], v[60:63]
  v_mfma_f32_16x16x32_bf16 v[64:67], a[64:67], v[12:15], v[64:67]
  v_mfma_f32_16x16x32_bf16 v[68:71], a[120:123], v[12:15], v[68:71]
  v_mfma_f32_16x16x32_bf16 v[72:75], a[176:179], v[12:15], v[72:75]
  s_waitcnt vmcnt(11)
  v_mfma_f32_16x16x32_bf16 v[60:63], a[12:15], v[16:19], v[60:63]
  v_mfma_f32_16x16x32_bf16 v[64:67], a[68:71], v[16:19], v[64:67]
  v_mfma_f32_16x16x32_bf16 v[68:71], a[124:127], v[16:19], v[68:71]
  v_mfma_f32_16x16x32_bf16 v[72:75], a[180:183], v[16:19], v[72:75]
  s_waitcnt vmcnt(10)
  v_mfma_f32_16x16x32_bf16 v[60:63], a[16:19], v[20:23], v[60:63]
  v_mfma_f32_16x16x32_bf16 v[64:67], a[72:75], v[20:23], v[64:67]
  v_mfma_f32_16x16x32_bf16 v[68:71], a[128:131], v[20:23], v[68:71]
  v_mfma_f32_16x16x32_bf16 v[72:75], a[184:187], v[20:23], v[72:75]
  s_waitcnt vmcnt(9)
  v_mfma_f32_16x16x32_bf16 v[60:63], a[20:23], v[24:27], v[60:63]
  v_mfma_f32_16x16x32_bf16 v[64:67], a[76:79], v[24:27], v[64:67]
  v_mfma_f32_16x16x32_bf16 v[68:71], a[132:135], v[24:27], v[68:71]
  v_mfma_f32_16x16x32_bf16 v[72:75], a[188:191], v[24:27], v[72:75]
  s_waitcnt vmcnt(8)
  v_mfma_f32_16x16x32_bf16 v[60:63], a[24:27], v[28:31], v[60:63]
  v_mfma_f32_16x16x32_bf16 v[64:67], a[80:83], v[28:31], v[64:67]
  v_mfma_f32_16x16x32_bf16 v[68:71], a[136:139], v[28:31], v[68:71]
  v_mfma_f32_16x16x32_bf16 v[72:75], a[192:195], v[28:31], v[72:75]
  s_waitcnt vmcnt(7)
  v_mfma_f32_16x16x32_bf16 v[60:63], a[28:31], v[32:35], v[60:63]
  v_mfma_f32_16x16x32_bf16 v[64:67], a[84:87], v[32:35], v[64:67]
  v_mfma_f32_16x16x32_bf16 v[68:71], a[140:143], v[32:35], v[68:71]
  v_mfma_f32_16x16x32_bf16 v[72:75], a[196:199], v[32:35], v[72:75]
  s_waitcnt vmcnt(6)
  v_mfma_f32_16x16x32_bf16 v[60:63], a[32:35], v[36:39], v[60:63]
  v_mfma_f32_16x16x32_bf16 v[64:67], a[88:91], v[36:39], v[64:67]
  v_mfma_f32_16x16x32_bf16 v[68:71], a[144:147], v[36:39], v[68:71]
  v_mfma_f32_16x16x32_bf16 v[72:75], a[200:203], v[36:39], v[72:75]
  s_waitcnt vmcnt(5)
  v_mfma_f32_16x16x32_bf16 v[60:63], a[36:39], v[40:43], v[60:63]
  v_mfma_f32_16x16x32_bf16 v[64:67], a[92:95], v[40:43], v[64:67]
  v_mfma_f32_16x16x32_bf16 v[68:71], a[148:151], v[40:43], v[68:71]
  v_mfma_f32_16x16x32_bf16 v[72:75], a[204:207], v[40:43], v[72:75]
  s_waitcnt vmcnt(4)
  v_mfma_f32_16x16x32_bf16 v[60:63], a[40:43], v[44:47], v[60:63]
  v_mfma_f32_16x16x32_bf16 v[64:67], a[96:99], v[44:47], v[64:67]
  v_mfma_f32_16x16x32_bf16 v[68:71], a[152:155], v[44:47], v[68:71]
  v_mfma_f32_16x16x32_bf16 v[72:75], a[208:211], v[44:47], v[72:75]
  s_waitcnt vmcnt(3)
  v_mfma_f32_16x16x32_bf16 v[60:63], a[44:47], v[48:51], v[60:63]
  v_mfma_f32_16x16x32_bf16 v[64:67], a[100:103], v[48:51], v[64:67]
  v_mfma_f32_16x16x32_bf16 v[68:71], a[156:159], v[48:51], v[68:71]
  v_mfma_f32_16x16x32_bf16 v[72:75], a[212:215], v[48:51], v[72:75]
  s_waitcnt vmcnt(2)
  v_mfma_f32_16x16x32_bf16 v[60:63], a[48:51], v[52:55], v[60:63]
  v_mfma_f32_16x16x32_bf16 v[64:67], a[104:107], v[52:55], v[64:67]
  v_mfma_f32_16x16x32_bf16 v[68:71], a[160:163], v[52:55], v[68:71]
  v_mfma_f32_16x16x32_bf16 v[72:75], a[216:219], v[52:55], v[72:75]
  s_waitcnt vmcnt(1)
  v_mfma_f32_16x16x32_bf16 v[60:63], a[52:55], v[56:59], v[60:63]
  v_mfma_f32_16x16x32_bf16 v[64:67], a[108:111], v[56:59], v[64:67]
  v_mfma_f32_16x16x32_bf16 v[68:71], a[164:167], v[56:59], v[68:71]
  v_mfma_f32_16x16x32_bf16 v[72:75], a[220:223], v[56:59], v[72:75]
  s_cmp_ge_u32 s44, 61
  s_cbranch_scc0 L_vl_208
  s_add_u32 s6, s6, 1
  s_cmp_gt_u32 s6, 262144
  s_cbranch_scc1 L_timeout
  s_waitcnt vmcnt(0)
  v_max3_u32 v135, v4, v5, v6
  v_max3_u32 v135, v135, v7, v8
  v_max3_u32 v135, v135, v9, v10
  v_max3_u32 v135, v135, v11, v12
  v_max3_u32 v135, v135, v13, v14
  v_max3_u32 v135, v135, v15, v16
  v_max3_u32 v135, v135, v17, v18
  v_max3_u32 v135, v135, v19, v20
  v_max3_u32 v135, v135, v21, v22
  v_max3_u32 v135, v135, v23, v24
  v_max3_u32 v135, v135, v25, v26
  v_max3_u32 v135, v135, v27, v28
  v_max3_u32 v135, v135, v29, v30
  v_max3_u32 v135, v135, v31, v32
  v_max3_u32 v135, v135, v33, v34
  v_max3_u32 v135, v135, v35, v36
  v_max3_u32 v135, v135, v37, v38
  v_max3_u32 v135, v135, v39, v40
  v_max3_u32 v135, v135, v41, v42
  v_max3_u32 v135, v135, v43, v44
  v_max3_u32 v135, v135, v45, v46
  v_max3_u32 v135, v135, v47, v48
  v_max3_u32 v135, v135, v49, v50
  v_max3_u32 v135, v135, v51, v52
  v_max3_u32 v135, v135, v53, v54
  v_max3_u32 v135, v135, v55, v56
  v_max3_u32 v135, v135, v57, v58
  v_max3_u32 v135, v135, v59, v76
  v_max3_u32 v135, v135, v77, v78
  v_max_u32 v135, v135, v79
  v_cmp_eq_u32 vcc, -1, v135
  s_cbranch_vccnz L_f2_again_207
L_vl_208:
  s_nop 2
  ds_write_b128 v132, v[60:63] offset:0
  ds_write_b128 v132, v[64:67] offset:1024
  ds_write_b128 v132, v[68:71] offset:2048
  ds_write_b128 v132, v[72:75] offset:3072
  s_cmp_ge_u32 s3, 2
  s_waitcnt vmcnt(0) lgkmcnt(0)
  s_barrier
  s_cbranch_scc1 L_f2_next_203
  ds_read_b128 v[88:91], v133 offset:0
  ds_read_b128 v[92:95], v133 offset:4096
  ds_read_b128 v[96:99], v133 offset:8192
  ds_read_b128 v[100:103], v133 offset:12288
  ds_read_b128 v[104:107], v133 offset:1024
  ds_read_b128 v[108:111], v133 offset:5120
  ds_read_b128 v[112:115], v133 offset:9216
  ds_read_b128 v[116:119], v133 offset:13312
  s_waitcnt lgkmcnt(4)
  v_pk_add_f32 v[88:89], v[88:89], v[92:93]
  v_pk_add_f32 v[96:97], v[96:97], v[100:101]
  v_pk_add_f32 v[90:91], v[90:91], v[94:95]
  v_pk_add_f32 v[98:99], v[98:99], v[102:103]
  v_pk_add_f32 v[120:121], v[88:89], v[96:97]
  v_pk_add_f32 v[122:123], v[90:91], v[98:99]
  s_waitcnt lgkmcnt(0)
  v_pk_add_f32 v[104:105], v[104:105], v[108:109]
  v_pk_add_f32 v[112:113], v[112:113], v[116:117]
  v_pk_add_f32 v[106:107], v[106:107], v[110:111]
  v_pk_add_f32 v[114:115], v[114:115], v[118:119]
  v_pk_add_f32 v[124:125], v[104:105], v[112:113]
  v_pk_add_f32 v[126:127], v[106:107], v[114:115]
  v_lshlrev_b32 v88, 16, v76
  v_and_b32 v89, s49, v76
  v_lshlrev_b32 v90, 16, v77
  v_and_b32 v91, s49, v77
  v_lshlrev_b32 v92, 16, v78
  v_and_b32 v93, s49, v78
  v_lshlrev_b32 v94, 16, v79
  v_and_b32 v95, s49, v79
  v_add_f32 v120, v120, v80
  v_add_f32 v121, v121, v81
  v_add_f32 v122, v122, v82
  v_add_f32 v123, v123, v83
  v_add_f32 v124, v124, v84
  v_add_f32 v125, v125, v85
  v_add_f32 v126, v126, v86
  v_add_f32 v127, v127, v87
  v_add_f32 v120, v120, v88
  v_add_f32 v121, v121, v89
  v_add_f32 v122, v122, v90
  v_add_f32 v123, v123, v91
  v_add_f32 v124, v124, v92
  v_add_f32 v125, v125, v93
  v_add_f32 v126, v126, v94
  v_add_f32 v127, v127, v95
  v_cvt_pk_bf16_f32 v96, v120, v121
  v_cvt_pk_bf16_f32 v97, v122, v123
  v_cvt_pk_bf16_f32 v98, v124, v125
  v_cvt_pk_bf16_f32 v99, v126, v127
  buffer_store_dwordx4 v[96:99], v134, s[24:27], s47 offen
L_f2_next_203:
  s_add_u32 s44, s44, 2
  s_add_u32 s45, s45, 229376
  s_add_u32 s46, s46, 57344
  s_add_u32 s47, s47, 57344
  s_add_u32 s48, s48, 57344
  s_cmp_lt_u32 s44, 64
  s_cbranch_scc1 L_f2_top_202
  s_endpgm
.section .rodata,"a"
.p2align 6
.amdhsa_kernel sequential_preLN__memory_aug_recurrent_mem_tr__dense_activation_gelu__prompt_kernel
  .amdhsa_next_free_vgpr 512
  .amdhsa_next_free_sgpr 102
  .amdhsa_accum_offset 256
  .amdhsa_group_segment_fixed_size 0
  .amdhsa_kernarg_size 120
  .amdhsa_user_sgpr_count 2
  .amdhsa_user_sgpr_kernarg_segment_ptr 1
  .amdhsa_system_sgpr_workgroup_id_x 1
.end_amdhsa_kernel
```
